```python
import torch

def _softmax(x, axis=-1):
    return torch.softmax(x, dim=axis)

def _gelu(x):
    return torch.nn.functional.gelu(x, approximate='tanh')

def _silu(x):
    return torch.nn.functional.silu(x)

def _sigmoid(x):
    return torch.sigmoid(x)

def _layernorm(x, axis=-1, eps=1e-05):
    m = x.mean(dim=axis, keepdim=True)
    v = x.var(dim=axis, keepdim=True, unbiased=False)
    return (x - m) / torch.sqrt(v + eps)

def _scatter_add(tgt, idx, src, axis=0):
    return tgt.clone().index_add_(axis, idx, src)

def _segment_sum(src, seg, n):
    out = torch.zeros((n,) + src.shape[1:], dtype=src.dtype)
    return out.index_add_(0, seg, src)

def _pad(x, pw):
    flat = tuple((v for pair in reversed(pw) for v in pair))
    return torch.nn.functional.pad(x, flat)
kernel_name = 'interleave_layers__ssm_conv_h3__memory_aug_recurrent_mem_tr__prompt'

def setup_inputs():

    _w = lambda a: (lambda t: t.to(torch.bfloat16) if t.is_floating_point() else t)(torch.as_tensor(a))

    def _A_setup():
        B, S, D = (1, 2048, 576)
        ks = 4
        return {'q': _w((lambda *s: torch.randn(*s, dtype=torch.bfloat16) * 0.05)(B, S, D)), 'k': _w((lambda *s: torch.randn(*s, dtype=torch.bfloat16) * 0.2)(B, S, D)), 'v': _w((lambda *s: torch.randn(*s, dtype=torch.bfloat16) * 0.2)(B, S, D)), 'shift_k': _w((lambda *s: torch.randn(*s, dtype=torch.bfloat16) * 0.2)(D, ks) * 0.5), 'ssm_k': _w((lambda *s: torch.randn(*s, dtype=torch.bfloat16) * 0.4)(D, S) * (1.0 / S ** 0.5)), 'ssm_D': _w((lambda *s: torch.randn(*s, dtype=torch.bfloat16) * 0.2)(D))}
    _A_in = _A_setup()

    def _B_setup():
        B, S, Dm = (1, 2048, 576)
        H, Dh = (32, 128)
        M, seg = (8, 32)
        seg = min(seg, S)
        S = S // seg * seg
        return {'x': _w((lambda *s: torch.randn(*s, dtype=torch.bfloat16) * 0.05)(B, S, Dm)), 'mem0': _w((lambda *s: torch.randn(*s, dtype=torch.bfloat16) * 0.2)(B, M, Dm)), 'Wq': _w((lambda *s: torch.randn(*s, dtype=torch.bfloat16) * 1.6)(Dm, H, Dh) * Dm ** (-0.5)), 'Wk': _w((lambda *s: torch.randn(*s, dtype=torch.bfloat16) * 1.6)(Dm, H, Dh) * Dm ** (-0.5)), 'Wv': _w((lambda *s: torch.randn(*s, dtype=torch.bfloat16) * 0.2)(Dm, H, Dh) * Dm ** (-0.5)), 'Wo': _w((lambda *s: torch.randn(*s, dtype=torch.bfloat16) * 0.2)(H, Dh, Dm) * (H * Dh) ** (-0.5)), 'seg_len': seg}
    _B_in = _B_setup()
    return {'A_q': _A_in['q'], 'A_k': _A_in['k'], 'A_v': _A_in['v'], 'A_shift_k': _A_in['shift_k'], 'A_ssm_k': _A_in['ssm_k'], 'A_ssm_D': _A_in['ssm_D'], 'B_x': _B_in['x'], 'B_mem0': _B_in['mem0'], 'B_Wq': _B_in['Wq'], 'B_Wk': _B_in['Wk'], 'B_Wv': _B_in['Wv'], 'B_Wo': _B_in['Wo'], 'B_seg_len': _B_in['seg_len']}

def reference(A_q, A_k, A_v, A_shift_k, A_ssm_k, A_ssm_D, B_x, B_mem0, B_Wq, B_Wk, B_Wv, B_Wo, B_seg_len):

    def _A_ref(q, k, v, shift_k, ssm_k, ssm_D):
        B, S, D = q.shape
        ks = shift_k.shape[-1]
        k_pad = _pad(k, ((0, 0), (ks - 1, 0), (0, 0)))
        k_shift = torch.zeros_like(k)
        for t in range(ks):
            k_shift = k_shift + k_pad[:, t:t + S, :] * shift_k[:, ks - 1 - t][None, None, :]
        kv = k_shift * v
        L = 2 * S
        kv_pad = _pad(kv, ((0, 0), (0, S), (0, 0)))
        kf_pad = _pad(ssm_k, ((0, 0), (0, S)))
        kv_f = (lambda x, axes=(-2, -1): torch.fft.rfft2(x.float(), dim=axes))(kv_pad[:, None, :, :], axes=(1, 2))
        kf_f = (lambda x, axes=(-2, -1): torch.fft.rfft2(x.float(), dim=axes))(kf_pad[:, None, :], axes=(1, 2))
        kf_f = (lambda x, *d: x.permute(*d))(kf_f, 1, 2, 0)
        y_f = kv_f * kf_f[None, :, :, :]
        y = (lambda x, s, axes=(-2, -1): torch.fft.irfft2(x, s=s, dim=axes).to(torch.bfloat16))(y_f, (1, L), axes=(1, 2))[:, 0, :S, :]
        y = y + kv * ssm_D[None, None, :]
        return q * y

    def _B_ref(x, mem0, Wq, Wk, Wv, Wo, seg_len):
        B, S, Dm = x.shape
        H, Dh = (Wq.shape[1], Wq.shape[2])
        M = mem0.shape[1]
        scale = Dh ** (-0.5)
        n_seg = S // seg_len
        L = M + seg_len
        idx = torch.arange(L)
        mask = (idx[:, None] < M) | (idx[:, None] >= idx[None, :])
        mem = mem0
        outs = []
        for s in range(n_seg):
            xs = x[:, s * seg_len:(s + 1) * seg_len, :].clone()
            h = torch.concatenate([mem, xs], axis=1)
            q = torch.einsum('btd,dhe->bhte', h, Wq)
            k = torch.einsum('btd,dhe->bhte', h, Wk)
            v = torch.einsum('btd,dhe->bhte', h, Wv)
            scores = torch.einsum('bhqe,bhke->bhqk', q, k) * scale
            scores = torch.where(mask[None, None], scores, -1000000000.0)
            p = _softmax(scores, axis=-1)
            o = torch.einsum('bhqk,bhke->bhqe', p, v)
            o = torch.einsum('bhte,hed->btd', o, Wo)
            mem = o[:, :M, :].clone()
            outs.append(o[:, M:, :])
        return torch.concatenate(outs, axis=1)
    x = A_q
    x = x + _A_ref(_layernorm(x, axis=-1), A_k, A_v, A_shift_k, A_ssm_k, A_ssm_D)
    x = x + _B_ref(_layernorm(x, axis=-1), B_mem0, B_Wq, B_Wk, B_Wv, B_Wo, B_seg_len)
    x = x + _A_ref(_layernorm(x, axis=-1), A_k, A_v, A_shift_k, A_ssm_k, A_ssm_D)
    x = x + _B_ref(_layernorm(x, axis=-1), B_mem0, B_Wq, B_Wk, B_Wv, B_Wo, B_seg_len)
    return x
```

```asm
; @launch grid=(256,1,1) block=(256,1,1) lds=163840
.amdgcn_target "amdgcn-amd-amdhsa--gfx950"
.text
.globl interleave_layers__ssm_conv_h3__memory_aug_recurrent_mem_tr__prompt_kernel
.type interleave_layers__ssm_conv_h3__memory_aug_recurrent_mem_tr__prompt_kernel,@function
.p2align 8
interleave_layers__ssm_conv_h3__memory_aug_recurrent_mem_tr__prompt_kernel:
  s_cmp_ge_u32 s2, 256
  s_cbranch_scc1 .mega_end
  s_load_dwordx16 s[16:31], s[0:1], 64
  v_lshrrev_b32 v1, 6, v0
  v_and_b32 v0, 63, v0
  v_readfirstlane_b32 s3, v1
  s_getreg_b32 s8, hwreg(HW_REG_XCC_ID)
  s_and_b32 s8, s8, 7
  s_mov_b32 s10, 200000
  s_waitcnt lgkmcnt(0)
  s_mov_b32 s4, s30
  s_mov_b32 s5, s31
  s_mov_b32 s6, 0x10000000
  s_mov_b32 s7, 0x20000
  s_mov_b32 s32, s16
  s_mov_b32 s33, s17
  s_mov_b32 s34, 0x480000
  s_mov_b32 s35, 0x20000
  s_mov_b32 s36, s18
  s_mov_b32 s37, s19
  s_mov_b32 s38, 0x480000
  s_mov_b32 s39, 0x20000
  s_mov_b32 s40, s20
  s_mov_b32 s41, s21
  s_mov_b32 s42, 0x480000
  s_mov_b32 s43, 0x20000
  s_mov_b32 s44, s22
  s_mov_b32 s45, s23
  s_mov_b32 s46, 0x480000
  s_mov_b32 s47, 0x20000
  s_mov_b32 s48, s26
  s_mov_b32 s49, s27
  s_mov_b32 s50, 0x240000
  s_mov_b32 s51, 0x20000
  v_mov_b32 v4, 0
  s_cmp_lg_u32 s3, 0
  s_cbranch_scc1 .tk
  s_cmp_lt_u32 s2, 16
  s_cselect_b32 s12, -1, 0
  v_and_b32 v5, 7, v0
  v_cmp_gt_u32 vcc, 1, v5
  v_mov_b32 v14, s12
  v_mov_b32 v15, s12
  v_cndmask_b32 v12, v14, v4, vcc
  v_mov_b32 v13, v12
  v_lshlrev_b32 v6, 4, v0
  s_lshl_b32 s12, s2, 10
  buffer_store_dwordx4 v[12:15], v6, s[4:7], s12 offen sc1
  s_lshl_b32 s11, s8, 5
  v_mov_b32 v1, s11
  v_mov_b32 v2, 1
  s_mov_b64 exec, 1
  global_atomic_add v3, v1, v2, s[28:29] sc0 sc1
  s_waitcnt vmcnt(0)
  ds_write_b32 v4, v3
  global_atomic_add v1, v2, s[28:29] offset:4 sc1
  s_mov_b64 exec, -1
.tk:
  s_waitcnt lgkmcnt(0)
  s_barrier
  ds_read_b32 v3, v4
  s_waitcnt lgkmcnt(0)
  v_readfirstlane_b32 s9, v3
  s_barrier
  s_cmp_ge_u32 s9, 32
  s_cbranch_scc1 .mega_end
  s_getpc_b64 s[100:101]
.wm_1:
  s_sub_u32 s100, s100, .wm_1-interleave_layers__ssm_conv_h3__memory_aug_recurrent_mem_tr__prompt_kernel
  s_subb_u32 s101, s101, 0
  s_lshl_b32 s99, s9, 2
  s_add_u32 s99, s99, s3
  s_lshl_b32 s99, s99, 10
  v_lshlrev_b32 v8, 4, v0
  v_add_u32 v8, s99, v8
  v_min_u32 v8, .code_end-interleave_layers__ssm_conv_h3__memory_aug_recurrent_mem_tr__prompt_kernel-16, v8
  global_load_dwordx4 v[8:11], v8, s[100:101]
  s_cmp_lt_u32 s8, 2
  s_cbranch_scc1 chain
  s_sub_u32 s11, s8, 6
  s_lshl_b32 s11, s11, 5
  s_add_u32 s11, s11, s9
  s_add_u32 s80, s11, 80
  s_sub_u32 s11, s8, 6
  s_mul_i32 s81, s11, 20
  s_add_u32 s81, s81, s9
  s_add_u32 s81, s81, 52
  s_mul_i32 s82, s11, 12
  s_add_u32 s82, s82, s9
  s_add_u32 s82, s82, 92
  s_cmp_lt_u32 s9, 12
  s_cselect_b32 s81, -1, s81
  s_cmp_lt_u32 s9, 24
  s_cselect_b32 s82, s82, -1
  s_cmp_ge_u32 s8, 6
  s_cbranch_scc1 conv
  s_mov_b32 s82, -1
  s_sub_u32 s11, s8, 2
  s_mul_i32 s80, s11, 20
  s_add_u32 s80, s80, s9
  s_sub_u32 s80, s80, 12
  s_lshl_b32 s81, s11, 4
  s_add_u32 s81, s81, s9
  s_sub_u32 s81, s81, 16
  s_cmp_lt_u32 s9, 16
  s_cselect_b32 s81, -1, s81
  s_cmp_ge_u32 s9, 12
  s_cbranch_scc1 conv
roles:
  s_cmp_lt_u32 s8, 6
  s_cbranch_scc1 qkv
  s_cmp_lt_u32 s9, 24
  s_cbranch_scc1 op
  s_branch red
.mega_end:
  s_endpgm
chain:
  s_mov_b32 s11, s8
  s_mov_b32 s12, s9
  s_mul_i32 s13, s3, 36864
  v_lshrrev_b32 v20, 4, v0
  v_lshlrev_b32 v20, 9, v20
  v_bfe_u32 v24, v0, 2, 2
  v_lshl_add_u32 v20, v24, 6, v20
  v_and_b32 v24, 3, v0
  v_lshl_add_u32 v20, v24, 3, v20
  v_add_u32 v20, s13, v20
  v_bfe_u32 v2, v0, 0, 6
  v_lshlrev_b32 v2, 4, v2
  v_add_u32 v2, s13, v2
  v_bfe_u32 v19, v0, 1, 1
  v_lshlrev_b32 v19, 11, v19
  v_bfe_u32 v24, v0, 4, 2
  v_lshl_add_u32 v19, v24, 8, v19
  v_bfe_u32 v24, v0, 2, 2
  v_lshl_add_u32 v19, v24, 6, v19
  v_bfe_u32 v24, v0, 0, 1
  v_lshl_add_u32 v19, v24, 5, v19
  v_add_u32 v19, s13, v19
  v_bfe_u32 v21, v0, 0, 2
  v_lshlrev_b32 v21, 4, v21
  v_bfe_u32 v24, v0, 2, 1
  v_lshl_add_u32 v21, v24, 17, v21
  v_bfe_u32 v24, v0, 3, 1
  v_lshl_add_u32 v21, v24, 16, v21
  v_bfe_u32 v24, v0, 4, 2
  v_lshl_add_u32 v21, v24, 14, v21
  v_bfe_u32 v22, v0, 0, 2
  v_lshlrev_b32 v22, 4, v22
  v_bfe_u32 v24, v0, 2, 1
  v_lshl_add_u32 v22, v24, 13, v22
  v_bfe_u32 v24, v0, 4, 2
  v_lshl_add_u32 v22, v24, 15, v22
  v_bfe_u32 v24, v0, 3, 1
  v_lshl_add_u32 v22, v24, 17, v22
  v_bfe_u32 v23, v0, 3, 1
  v_lshlrev_b32 v23, 5, v23
  v_bfe_u32 v24, v0, 5, 1
  v_lshl_add_u32 v23, v24, 4, v23
  v_bfe_u32 v24, v0, 4, 1
  v_lshl_add_u32 v23, v24, 1, v23
  v_bfe_u32 v24, v0, 2, 1
  v_lshl_add_u32 v23, v24, 0, v23
  v_mul_u32_u24 v23, 1152, v23
  v_and_b32 v24, 3, v0
  v_lshl_add_u32 v23, v24, 4, v23
  s_lshl_b32 s15, s12, 8
  s_lshl_b32 s14, s3, 6
  s_add_u32 s15, s15, s14
  s_mul_i32 s16, s12, 147456
  s_lshl_b32 s14, s3, 5
  s_add_u32 s76, s16, s14
  s_lshl_b32 s14, s3, 8
  s_add_u32 s16, s16, s14
  v_and_b32 v24, 2, v0
  v_mul_u32_u24 v24, 36848, v24
  v_add_u32 v18, v23, v24
  s_mul_i32 s56, s11, 0xe0000
  s_add_u32 s56, s56, 0x1c80000
  s_cmp_eq_u32 s11, 0
  s_cbranch_scc1 .c1_2z
  s_mul_i32 s23, s12, 9216
  s_mul_i32 s31, s3, 2304
  s_add_u32 s23, s23, s31
  v_mov_b64 v[68:69], -1
  v_mov_b64 v[70:71], -1
  v_lshlrev_b32 v72, 4, v0
  s_mov_b32 exec_hi, 0xffff
  s_add_u32 s73, s23, 0x1c82400
  buffer_store_dwordx4 v[68:71], v72, s[4:7], s73 offen offset:0 sc1
  buffer_store_dwordx4 v[68:71], v72, s[4:7], s73 offen offset:768 sc1
  buffer_store_dwordx4 v[68:71], v72, s[4:7], s73 offen offset:1536 sc1
  s_add_u32 s73, s23, 0x1ccc800
  buffer_store_dwordx4 v[68:71], v72, s[4:7], s73 offen offset:0 sc1
  buffer_store_dwordx4 v[68:71], v72, s[4:7], s73 offen offset:768 sc1
  buffer_store_dwordx4 v[68:71], v72, s[4:7], s73 offen offset:1536 sc1
  s_add_u32 s73, s23, 0x1d16c00
  buffer_store_dwordx4 v[68:71], v72, s[4:7], s73 offen offset:0 sc1
  buffer_store_dwordx4 v[68:71], v72, s[4:7], s73 offen offset:768 sc1
  buffer_store_dwordx4 v[68:71], v72, s[4:7], s73 offen offset:1536 sc1
  s_add_u32 s73, s23, 0x1d62400
  buffer_store_dwordx4 v[68:71], v72, s[4:7], s73 offen offset:0 sc1
  buffer_store_dwordx4 v[68:71], v72, s[4:7], s73 offen offset:768 sc1
  buffer_store_dwordx4 v[68:71], v72, s[4:7], s73 offen offset:1536 sc1
  s_add_u32 s73, s23, 0x1dac800
  buffer_store_dwordx4 v[68:71], v72, s[4:7], s73 offen offset:0 sc1
  buffer_store_dwordx4 v[68:71], v72, s[4:7], s73 offen offset:768 sc1
  buffer_store_dwordx4 v[68:71], v72, s[4:7], s73 offen offset:1536 sc1
  s_add_u32 s73, s23, 0x1df6c00
  buffer_store_dwordx4 v[68:71], v72, s[4:7], s73 offen offset:0 sc1
  buffer_store_dwordx4 v[68:71], v72, s[4:7], s73 offen offset:768 sc1
  buffer_store_dwordx4 v[68:71], v72, s[4:7], s73 offen offset:1536 sc1
  s_sub_u32 s73, s12, 1
  s_cmp_gt_u32 s73, 1
  s_cbranch_scc1 .c1_2
  s_mul_i32 s73, s12, 304128
  s_add_u32 s73, s73, s31
  s_add_u32 s75, s73, 0x1c80000
  buffer_store_dwordx4 v[68:71], v72, s[4:7], s75 offen offset:0 sc1
  buffer_store_dwordx4 v[68:71], v72, s[4:7], s75 offen offset:768 sc1
  buffer_store_dwordx4 v[68:71], v72, s[4:7], s75 offen offset:1536 sc1
  s_add_u32 s75, s73, 0x1d60000
  buffer_store_dwordx4 v[68:71], v72, s[4:7], s75 offen offset:0 sc1
  buffer_store_dwordx4 v[68:71], v72, s[4:7], s75 offen offset:768 sc1
  buffer_store_dwordx4 v[68:71], v72, s[4:7], s75 offen offset:1536 sc1
.c1_2:
  s_mov_b64 exec, -1
  s_sub_u32 s73, s12, 3
  s_cmp_gt_u32 s73, 1
  s_cbranch_scc1 .c1_2x
  s_load_dwordx2 s[64:65], s[0:1], 56
  s_mul_i32 s73, s73, 0xe0000
  s_add_u32 s73, s73, 0x1c80000
  v_bfe_u32 v25, v0, 4, 2
  v_mul_u32_u24 v25, 2304, v25
  v_and_b32 v29, 15, v0
  v_lshl_add_u32 v25, v29, 1, v25
  s_lshl_b32 s70, s3, 8
  s_lshl_b32 s77, s3, 5
  v_bfe_u32 v26, v0, 4, 2
  v_lshlrev_b32 v26, 8, v26
  v_bfe_u32 v29, v0, 0, 1
  v_lshl_add_u32 v26, v29, 5, v26
  v_bfe_u32 v29, v0, 1, 3
  v_lshl_add_u32 v26, v29, 2, v26
  v_bfe_u32 v29, v0, 5, 1
  v_lshl_add_u32 v26, v29, 6, v26
  v_bfe_u32 v27, v0, 4, 2
  v_lshlrev_b32 v27, 8, v27
  v_bfe_u32 v29, v0, 0, 1
  v_lshl_add_u32 v27, v29, 1, v27
  v_bfe_u32 v29, v0, 1, 1
  v_lshl_add_u32 v27, v29, 5, v27
  v_bfe_u32 v29, v0, 2, 2
  v_lshl_add_u32 v27, v29, 2, v27
  v_bfe_u32 v29, v0, 5, 1
  v_lshl_add_u32 v27, v29, 6, v27
  s_lshr_b32 s71, s3, 1
  s_lshl_b32 s71, s71, 6
  s_and_b32 s72, s3, 1
  s_lshl_b32 s72, s72, 4
  s_or_b32 s71, s71, s72
  v_xor_b32 v27, s71, v27
  s_lshl_b32 s72, s72, 2
  v_xor_b32 v26, s72, v26
  v_add_u32 v28, 4096, v26
  s_lshr_b32 s71, s3, 1
  s_lshl_b32 s71, s71, 10
  s_add_u32 s71, s71, s73
  s_cmp_lt_u32 s3, 2
  s_cselect_b32 s74, 8192, 0
  s_add_u32 s74, s74, s71
  s_waitcnt lgkmcnt(0)
  s_mov_b32 s66, 9216
  s_mov_b32 s67, 0x20000
  buffer_load_ushort v32, v25, s[64:67], s70 offen offset:0
  buffer_load_ushort v33, v25, s[64:67], s70 offen offset:1152
  buffer_load_ushort v34, v25, s[64:67], s70 offen offset:32
  buffer_load_ushort v35, v25, s[64:67], s70 offen offset:1184
  buffer_load_ushort v36, v25, s[64:67], s70 offen offset:64
  buffer_load_ushort v37, v25, s[64:67], s70 offen offset:1216
  buffer_load_ushort v38, v25, s[64:67], s70 offen offset:96
  buffer_load_ushort v39, v25, s[64:67], s70 offen offset:1248
  buffer_load_ushort v40, v25, s[64:67], s70 offen offset:128
  buffer_load_ushort v41, v25, s[64:67], s70 offen offset:1280
  buffer_load_ushort v42, v25, s[64:67], s70 offen offset:160
  buffer_load_ushort v43, v25, s[64:67], s70 offen offset:1312
  buffer_load_ushort v44, v25, s[64:67], s70 offen offset:192
  buffer_load_ushort v45, v25, s[64:67], s70 offen offset:1344
  buffer_load_ushort v46, v25, s[64:67], s70 offen offset:224
  buffer_load_ushort v47, v25, s[64:67], s70 offen offset:1376
  buffer_load_ushort v48, v25, s[64:67], s77 offen offset:1024
  buffer_load_ushort v49, v25, s[64:67], s77 offen offset:2176
  s_waitcnt vmcnt(17)
  buffer_store_short v32, v28, s[4:7], s71 offen offset:0 sc1
  s_waitcnt vmcnt(17)
  buffer_store_short v33, v28, s[4:7], s71 offen offset:128 sc1
  s_waitcnt vmcnt(17)
  buffer_store_short v34, v28, s[4:7], s71 offen offset:2 sc1
  s_waitcnt vmcnt(17)
  buffer_store_short v35, v28, s[4:7], s71 offen offset:130 sc1
  s_waitcnt vmcnt(17)
  buffer_store_short v36, v28, s[4:7], s71 offen offset:2048 sc1
  s_waitcnt vmcnt(17)
  buffer_store_short v37, v28, s[4:7], s71 offen offset:2176 sc1
  s_waitcnt vmcnt(17)
  buffer_store_short v38, v28, s[4:7], s71 offen offset:2050 sc1
  s_waitcnt vmcnt(17)
  buffer_store_short v39, v28, s[4:7], s71 offen offset:2178 sc1
  s_waitcnt vmcnt(17)
  buffer_store_short v40, v26, s[4:7], s74 offen offset:0 sc1
  s_waitcnt vmcnt(17)
  buffer_store_short v41, v26, s[4:7], s74 offen offset:128 sc1
  s_waitcnt vmcnt(17)
  buffer_store_short v42, v26, s[4:7], s74 offen offset:2 sc1
  s_waitcnt vmcnt(17)
  buffer_store_short v43, v26, s[4:7], s74 offen offset:130 sc1
  s_waitcnt vmcnt(17)
  buffer_store_short v44, v26, s[4:7], s71 offen offset:2048 sc1
  s_waitcnt vmcnt(17)
  buffer_store_short v45, v26, s[4:7], s71 offen offset:2176 sc1
  s_waitcnt vmcnt(17)
  buffer_store_short v46, v26, s[4:7], s71 offen offset:2050 sc1
  s_waitcnt vmcnt(17)
  buffer_store_short v47, v26, s[4:7], s71 offen offset:2178 sc1
  s_waitcnt vmcnt(17)
  buffer_store_short v48, v27, s[4:7], s73 offen offset:0 sc1
  s_waitcnt vmcnt(17)
  buffer_store_short v49, v27, s[4:7], s73 offen offset:128 sc1
.c1_2x:
  s_waitcnt vmcnt(0)
  s_barrier
  s_cmp_lg_u32 s3, 0
  s_cbranch_scc1 .ar_3
  s_load_dwordx2 s[100:101], s[0:1], 112
  v_mov_b32 v10, s8
  v_lshlrev_b32 v10, 5, v10
  v_mov_b32 v11, 1
  s_mov_b64 exec, 1
  s_waitcnt lgkmcnt(0)
  global_atomic_add v10, v11, s[100:101] offset:8 sc1
  s_mov_b64 exec, -1
.ar_3:
.c1_2z:
  s_add_u32 m0, s13, 0
  s_add_u32 s14, s15, 0xc0000
  buffer_load_dwordx4 v21, s[32:35], s14 offen lds
  s_add_u32 m0, s13, 1024
  s_add_u32 s14, s15, 0xc2000
  buffer_load_dwordx4 v21, s[32:35], s14 offen lds
  s_add_u32 m0, s13, 2048
  s_add_u32 s14, s15, 0x1c0000
  buffer_load_dwordx4 v21, s[32:35], s14 offen lds
  s_add_u32 m0, s13, 3072
  s_add_u32 s14, s15, 0x1c2000
  buffer_load_dwordx4 v21, s[32:35], s14 offen lds
  s_add_u32 m0, s13, 4096
  s_add_u32 s14, s15, 0x2c0000
  buffer_load_dwordx4 v21, s[32:35], s14 offen lds
  s_add_u32 m0, s13, 5120
  s_add_u32 s14, s15, 0x2c2000
  buffer_load_dwordx4 v21, s[32:35], s14 offen lds
  s_add_u32 m0, s13, 6144
  s_add_u32 s14, s15, 0x3c0000
  buffer_load_dwordx4 v21, s[32:35], s14 offen lds
  s_add_u32 m0, s13, 7168
  s_add_u32 s14, s15, 0x3c2000
  buffer_load_dwordx4 v21, s[32:35], s14 offen lds
  s_waitcnt lgkmcnt(0)
  s_add_u32 m0, s13, 8192
  s_add_u32 s14, s15, 0x0
  buffer_load_dwordx4 v21, s[32:35], s14 offen lds
  s_waitcnt vmcnt(5)
  ds_read_b64_tr_b16 v[32:33], v20 offset:0
  ds_read_b64_tr_b16 v[34:35], v20 offset:256
  ds_read_b64_tr_b16 v[36:37], v20 offset:2048
  ds_read_b64_tr_b16 v[38:39], v20 offset:2304
  ds_read_b64_tr_b16 v[40:41], v20 offset:32
  ds_read_b64_tr_b16 v[42:43], v20 offset:288
  ds_read_b64_tr_b16 v[44:45], v20 offset:2080
  ds_read_b64_tr_b16 v[46:47], v20 offset:2336
  s_add_u32 m0, s13, 9216
  s_add_u32 s14, s15, 0x2000
  buffer_load_dwordx4 v21, s[32:35], s14 offen lds
  s_waitcnt lgkmcnt(0)
  ds_write_b128 v2, v[32:35] offset:0
  ds_write_b128 v2, v[36:39] offset:1024
  ds_write_b128 v2, v[40:43] offset:2048
  ds_write_b128 v2, v[44:47] offset:3072
  s_add_u32 m0, s13, 10240
  s_add_u32 s14, s15, 0x100000
  buffer_load_dwordx4 v21, s[32:35], s14 offen lds
  ds_read_b128 a[0:3], v19 offset:0
  ds_read_b128 a[4:7], v19 offset:1024
  ds_read_b128 a[8:11], v19 offset:16
  ds_read_b128 a[12:15], v19 offset:1040
  s_add_u32 m0, s13, 11264
  s_add_u32 s14, s15, 0x102000
  buffer_load_dwordx4 v21, s[32:35], s14 offen lds
  s_waitcnt lgkmcnt(0)
  s_add_u32 m0, s13, 12288
  s_add_u32 s14, s15, 0x200000
  buffer_load_dwordx4 v21, s[32:35], s14 offen lds
  s_waitcnt vmcnt(5)
  ds_read_b64_tr_b16 v[32:33], v20 offset:4096
  ds_read_b64_tr_b16 v[34:35], v20 offset:4352
  ds_read_b64_tr_b16 v[36:37], v20 offset:6144
  ds_read_b64_tr_b16 v[38:39], v20 offset:6400
  ds_read_b64_tr_b16 v[40:41], v20 offset:4128
  ds_read_b64_tr_b16 v[42:43], v20 offset:4384
  ds_read_b64_tr_b16 v[44:45], v20 offset:6176
  ds_read_b64_tr_b16 v[46:47], v20 offset:6432
  s_add_u32 m0, s13, 13312
  s_add_u32 s14, s15, 0x202000
  buffer_load_dwordx4 v21, s[32:35], s14 offen lds
  s_waitcnt lgkmcnt(0)
  ds_write_b128 v2, v[32:35] offset:4096
  ds_write_b128 v2, v[36:39] offset:5120
  ds_write_b128 v2, v[40:43] offset:6144
  ds_write_b128 v2, v[44:47] offset:7168
  s_add_u32 m0, s13, 14336
  s_add_u32 s14, s15, 0x300000
  buffer_load_dwordx4 v21, s[32:35], s14 offen lds
  ds_read_b128 a[16:19], v19 offset:4096
  ds_read_b128 a[20:23], v19 offset:5120
  ds_read_b128 a[24:27], v19 offset:4112
  ds_read_b128 a[28:31], v19 offset:5136
  s_add_u32 m0, s13, 15360
  s_add_u32 s14, s15, 0x302000
  buffer_load_dwordx4 v21, s[32:35], s14 offen lds
  s_waitcnt lgkmcnt(0)
  s_add_u32 m0, s13, 16384
  s_add_u32 s14, s15, 0x40000
  buffer_load_dwordx4 v21, s[32:35], s14 offen lds
  s_waitcnt vmcnt(5)
  ds_read_b64_tr_b16 v[32:33], v20 offset:8192
  ds_read_b64_tr_b16 v[34:35], v20 offset:8448
  ds_read_b64_tr_b16 v[36:37], v20 offset:10240
  ds_read_b64_tr_b16 v[38:39], v20 offset:10496
  ds_read_b64_tr_b16 v[40:41], v20 offset:8224
  ds_read_b64_tr_b16 v[42:43], v20 offset:8480
  ds_read_b64_tr_b16 v[44:45], v20 offset:10272
  ds_read_b64_tr_b16 v[46:47], v20 offset:10528
  s_add_u32 m0, s13, 17408
  s_add_u32 s14, s15, 0x42000
  buffer_load_dwordx4 v21, s[32:35], s14 offen lds
  s_waitcnt lgkmcnt(0)
  ds_write_b128 v2, v[32:35] offset:8192
  ds_write_b128 v2, v[36:39] offset:9216
  ds_write_b128 v2, v[40:43] offset:10240
  ds_write_b128 v2, v[44:47] offset:11264
  s_add_u32 m0, s13, 18432
  s_add_u32 s14, s15, 0x140000
  buffer_load_dwordx4 v21, s[32:35], s14 offen lds
  ds_read_b128 a[32:35], v19 offset:8192
  ds_read_b128 a[36:39], v19 offset:9216
  ds_read_b128 a[40:43], v19 offset:8208
  ds_read_b128 a[44:47], v19 offset:9232
  s_add_u32 m0, s13, 19456
  s_add_u32 s14, s15, 0x142000
  buffer_load_dwordx4 v21, s[32:35], s14 offen lds
  s_waitcnt lgkmcnt(0)
  s_add_u32 m0, s13, 20480
  s_add_u32 s14, s15, 0x80000
  buffer_load_dwordx4 v21, s[32:35], s14 offen lds
  s_waitcnt vmcnt(5)
  ds_read_b64_tr_b16 v[32:33], v20 offset:12288
  ds_read_b64_tr_b16 v[34:35], v20 offset:12544
  ds_read_b64_tr_b16 v[36:37], v20 offset:14336
  ds_read_b64_tr_b16 v[38:39], v20 offset:14592
  ds_read_b64_tr_b16 v[40:41], v20 offset:12320
  ds_read_b64_tr_b16 v[42:43], v20 offset:12576
  ds_read_b64_tr_b16 v[44:45], v20 offset:14368
  ds_read_b64_tr_b16 v[46:47], v20 offset:14624
  s_add_u32 m0, s13, 21504
  s_add_u32 s14, s15, 0x82000
  buffer_load_dwordx4 v21, s[32:35], s14 offen lds
  s_waitcnt lgkmcnt(0)
  ds_write_b128 v2, v[32:35] offset:12288
  ds_write_b128 v2, v[36:39] offset:13312
  ds_write_b128 v2, v[40:43] offset:14336
  ds_write_b128 v2, v[44:47] offset:15360
  s_add_u32 m0, s13, 22528
  s_add_u32 s14, s15, 0x180000
  buffer_load_dwordx4 v21, s[32:35], s14 offen lds
  ds_read_b128 a[48:51], v19 offset:12288
  ds_read_b128 a[52:55], v19 offset:13312
  ds_read_b128 a[56:59], v19 offset:12304
  ds_read_b128 a[60:63], v19 offset:13328
  s_add_u32 m0, s13, 23552
  s_add_u32 s14, s15, 0x182000
  buffer_load_dwordx4 v21, s[32:35], s14 offen lds
  s_waitcnt lgkmcnt(0)
  s_add_u32 m0, s13, 24576
  s_add_u32 s14, s15, 0x400000
  buffer_load_dwordx4 v22, s[36:39], s14 offen lds
  s_waitcnt vmcnt(5)
  ds_read_b64_tr_b16 v[32:33], v20 offset:16384
  ds_read_b64_tr_b16 v[34:35], v20 offset:16640
  ds_read_b64_tr_b16 v[36:37], v20 offset:18432
  ds_read_b64_tr_b16 v[38:39], v20 offset:18688
  ds_read_b64_tr_b16 v[40:41], v20 offset:16416
  ds_read_b64_tr_b16 v[42:43], v20 offset:16672
  ds_read_b64_tr_b16 v[44:45], v20 offset:18464
  ds_read_b64_tr_b16 v[46:47], v20 offset:18720
  s_add_u32 m0, s13, 25600
  s_add_u32 s14, s15, 0x404000
  buffer_load_dwordx4 v22, s[36:39], s14 offen lds
  s_waitcnt lgkmcnt(0)
  ds_write_b128 v2, v[32:35] offset:16384
  ds_write_b128 v2, v[36:39] offset:17408
  ds_write_b128 v2, v[40:43] offset:18432
  ds_write_b128 v2, v[44:47] offset:19456
  s_add_u32 m0, s13, 26624
  s_add_u32 s14, s15, 0x440000
  buffer_load_dwordx4 v22, s[36:39], s14 offen lds
  ds_read_b128 a[64:67], v19 offset:16384
  ds_read_b128 a[68:71], v19 offset:17408
  ds_read_b128 a[72:75], v19 offset:16400
  ds_read_b128 a[76:79], v19 offset:17424
  s_add_u32 m0, s13, 27648
  s_add_u32 s14, s15, 0x444000
  buffer_load_dwordx4 v22, s[36:39], s14 offen lds
  s_waitcnt lgkmcnt(0)
  s_add_u32 m0, s13, 28672
  s_add_u32 s14, s15, 0x280000
  buffer_load_dwordx4 v21, s[36:39], s14 offen lds
  s_waitcnt vmcnt(5)
  ds_read_b64_tr_b16 v[32:33], v20 offset:20480
  ds_read_b64_tr_b16 v[34:35], v20 offset:20736
  ds_read_b64_tr_b16 v[36:37], v20 offset:22528
  ds_read_b64_tr_b16 v[38:39], v20 offset:22784
  ds_read_b64_tr_b16 v[40:41], v20 offset:20512
  ds_read_b64_tr_b16 v[42:43], v20 offset:20768
  ds_read_b64_tr_b16 v[44:45], v20 offset:22560
  ds_read_b64_tr_b16 v[46:47], v20 offset:22816
  s_add_u32 m0, s13, 29696
  s_add_u32 s14, s15, 0x282000
  buffer_load_dwordx4 v21, s[36:39], s14 offen lds
  s_waitcnt lgkmcnt(0)
  ds_write_b128 v2, v[32:35] offset:20480
  ds_write_b128 v2, v[36:39] offset:21504
  ds_write_b128 v2, v[40:43] offset:22528
  ds_write_b128 v2, v[44:47] offset:23552
  s_add_u32 m0, s13, 30720
  s_add_u32 s14, s15, 0x380000
  buffer_load_dwordx4 v21, s[36:39], s14 offen lds
  ds_read_b128 a[80:83], v19 offset:20480
  ds_read_b128 a[84:87], v19 offset:21504
  ds_read_b128 a[88:91], v19 offset:20496
  ds_read_b128 a[92:95], v19 offset:21520
  s_add_u32 m0, s13, 31744
  s_add_u32 s14, s15, 0x382000
  buffer_load_dwordx4 v21, s[36:39], s14 offen lds
  s_waitcnt lgkmcnt(0)
  s_add_u32 m0, s13, 32768
  s_add_u32 s14, s15, 0xc0000
  buffer_load_dwordx4 v21, s[36:39], s14 offen lds
  s_waitcnt vmcnt(5)
  ds_read_b64_tr_b16 v[32:33], v20 offset:24576
  ds_read_b64_tr_b16 v[34:35], v20 offset:24832
  ds_read_b64_tr_b16 v[36:37], v20 offset:26624
  ds_read_b64_tr_b16 v[38:39], v20 offset:26880
  ds_read_b64_tr_b16 v[40:41], v20 offset:24608
  ds_read_b64_tr_b16 v[42:43], v20 offset:24864
  ds_read_b64_tr_b16 v[44:45], v20 offset:26656
  ds_read_b64_tr_b16 v[46:47], v20 offset:26912
  s_add_u32 m0, s13, 33792
  s_add_u32 s14, s15, 0xc2000
  buffer_load_dwordx4 v21, s[36:39], s14 offen lds
  s_waitcnt lgkmcnt(0)
  ds_write_b128 v2, v[32:35] offset:24576
  ds_write_b128 v2, v[36:39] offset:25600
  ds_write_b128 v2, v[40:43] offset:26624
  ds_write_b128 v2, v[44:47] offset:27648
  s_add_u32 m0, s13, 34816
  s_add_u32 s14, s15, 0x1c0000
  buffer_load_dwordx4 v21, s[36:39], s14 offen lds
  ds_read_b128 a[96:99], v19 offset:24576
  ds_read_b128 a[100:103], v19 offset:25600
  ds_read_b128 a[104:107], v19 offset:24592
  ds_read_b128 a[108:111], v19 offset:25616
  s_add_u32 m0, s13, 35840
  s_add_u32 s14, s15, 0x1c2000
  buffer_load_dwordx4 v21, s[36:39], s14 offen lds
  s_waitcnt lgkmcnt(0)
  s_add_u32 m0, s13, 0
  s_add_u32 s14, s15, 0x0
  buffer_load_dwordx4 v21, s[36:39], s14 offen lds
  s_waitcnt vmcnt(5)
  ds_read_b64_tr_b16 v[32:33], v20 offset:28672
  ds_read_b64_tr_b16 v[34:35], v20 offset:28928
  ds_read_b64_tr_b16 v[36:37], v20 offset:30720
  ds_read_b64_tr_b16 v[38:39], v20 offset:30976
  ds_read_b64_tr_b16 v[40:41], v20 offset:28704
  ds_read_b64_tr_b16 v[42:43], v20 offset:28960
  ds_read_b64_tr_b16 v[44:45], v20 offset:30752
  ds_read_b64_tr_b16 v[46:47], v20 offset:31008
  s_add_u32 m0, s13, 1024
  s_add_u32 s14, s15, 0x2000
  buffer_load_dwordx4 v21, s[36:39], s14 offen lds
  s_waitcnt lgkmcnt(0)
  ds_write_b128 v2, v[32:35] offset:28672
  ds_write_b128 v2, v[36:39] offset:29696
  ds_write_b128 v2, v[40:43] offset:30720
  ds_write_b128 v2, v[44:47] offset:31744
  s_add_u32 m0, s13, 2048
  s_add_u32 s14, s15, 0x100000
  buffer_load_dwordx4 v21, s[36:39], s14 offen lds
  ds_read_b128 a[112:115], v19 offset:28672
  ds_read_b128 a[116:119], v19 offset:29696
  ds_read_b128 a[120:123], v19 offset:28688
  ds_read_b128 a[124:127], v19 offset:29712
  s_add_u32 m0, s13, 3072
  s_add_u32 s14, s15, 0x102000
  buffer_load_dwordx4 v21, s[36:39], s14 offen lds
  s_waitcnt lgkmcnt(0)
  s_add_u32 m0, s13, 4096
  s_add_u32 s14, s15, 0x200000
  buffer_load_dwordx4 v21, s[36:39], s14 offen lds
  s_waitcnt vmcnt(5)
  ds_read_b64_tr_b16 v[32:33], v20 offset:32768
  ds_read_b64_tr_b16 v[34:35], v20 offset:33024
  ds_read_b64_tr_b16 v[36:37], v20 offset:34816
  ds_read_b64_tr_b16 v[38:39], v20 offset:35072
  ds_read_b64_tr_b16 v[40:41], v20 offset:32800
  ds_read_b64_tr_b16 v[42:43], v20 offset:33056
  ds_read_b64_tr_b16 v[44:45], v20 offset:34848
  ds_read_b64_tr_b16 v[46:47], v20 offset:35104
  s_add_u32 m0, s13, 5120
  s_add_u32 s14, s15, 0x202000
  buffer_load_dwordx4 v21, s[36:39], s14 offen lds
  s_waitcnt lgkmcnt(0)
  ds_write_b128 v2, v[32:35] offset:32768
  ds_write_b128 v2, v[36:39] offset:33792
  ds_write_b128 v2, v[40:43] offset:34816
  ds_write_b128 v2, v[44:47] offset:35840
  s_add_u32 m0, s13, 6144
  s_add_u32 s14, s15, 0x300000
  buffer_load_dwordx4 v21, s[36:39], s14 offen lds
  ds_read_b128 a[128:131], v19 offset:32768
  ds_read_b128 a[132:135], v19 offset:33792
  ds_read_b128 a[136:139], v19 offset:32784
  ds_read_b128 a[140:143], v19 offset:33808
  s_add_u32 m0, s13, 7168
  s_add_u32 s14, s15, 0x302000
  buffer_load_dwordx4 v21, s[36:39], s14 offen lds
  s_waitcnt lgkmcnt(0)
  s_add_u32 m0, s13, 8192
  s_add_u32 s14, s15, 0x40000
  buffer_load_dwordx4 v21, s[36:39], s14 offen lds
  s_waitcnt vmcnt(5)
  ds_read_b64_tr_b16 v[32:33], v20 offset:0
  ds_read_b64_tr_b16 v[34:35], v20 offset:256
  ds_read_b64_tr_b16 v[36:37], v20 offset:2048
  ds_read_b64_tr_b16 v[38:39], v20 offset:2304
  ds_read_b64_tr_b16 v[40:41], v20 offset:32
  ds_read_b64_tr_b16 v[42:43], v20 offset:288
  ds_read_b64_tr_b16 v[44:45], v20 offset:2080
  ds_read_b64_tr_b16 v[46:47], v20 offset:2336
  s_add_u32 m0, s13, 9216
  s_add_u32 s14, s15, 0x42000
  buffer_load_dwordx4 v21, s[36:39], s14 offen lds
  s_waitcnt lgkmcnt(0)
  ds_write_b128 v2, v[32:35] offset:0
  ds_write_b128 v2, v[36:39] offset:1024
  ds_write_b128 v2, v[40:43] offset:2048
  ds_write_b128 v2, v[44:47] offset:3072
  s_add_u32 m0, s13, 10240
  s_add_u32 s14, s15, 0x140000
  buffer_load_dwordx4 v21, s[36:39], s14 offen lds
  ds_read_b128 a[144:147], v19 offset:0
  ds_read_b128 a[148:151], v19 offset:1024
  ds_read_b128 a[152:155], v19 offset:16
  ds_read_b128 a[156:159], v19 offset:1040
  s_add_u32 m0, s13, 11264
  s_add_u32 s14, s15, 0x142000
  buffer_load_dwordx4 v21, s[36:39], s14 offen lds
  s_waitcnt lgkmcnt(0)
  s_add_u32 m0, s13, 12288
  s_add_u32 s14, s15, 0x80000
  buffer_load_dwordx4 v21, s[36:39], s14 offen lds
  s_waitcnt vmcnt(5)
  ds_read_b64_tr_b16 v[32:33], v20 offset:4096
  ds_read_b64_tr_b16 v[34:35], v20 offset:4352
  ds_read_b64_tr_b16 v[36:37], v20 offset:6144
  ds_read_b64_tr_b16 v[38:39], v20 offset:6400
  ds_read_b64_tr_b16 v[40:41], v20 offset:4128
  ds_read_b64_tr_b16 v[42:43], v20 offset:4384
  ds_read_b64_tr_b16 v[44:45], v20 offset:6176
  ds_read_b64_tr_b16 v[46:47], v20 offset:6432
  s_add_u32 m0, s13, 13312
  s_add_u32 s14, s15, 0x82000
  buffer_load_dwordx4 v21, s[36:39], s14 offen lds
  s_waitcnt lgkmcnt(0)
  ds_write_b128 v2, v[32:35] offset:4096
  ds_write_b128 v2, v[36:39] offset:5120
  ds_write_b128 v2, v[40:43] offset:6144
  ds_write_b128 v2, v[44:47] offset:7168
  s_add_u32 m0, s13, 14336
  s_add_u32 s14, s15, 0x180000
  buffer_load_dwordx4 v21, s[36:39], s14 offen lds
  ds_read_b128 a[160:163], v19 offset:4096
  ds_read_b128 a[164:167], v19 offset:5120
  ds_read_b128 a[168:171], v19 offset:4112
  ds_read_b128 a[172:175], v19 offset:5136
  s_add_u32 m0, s13, 15360
  s_add_u32 s14, s15, 0x182000
  buffer_load_dwordx4 v21, s[36:39], s14 offen lds
  s_waitcnt lgkmcnt(0)
  s_add_u32 m0, s13, 16384
  s_add_u32 s14, s15, 0x400000
  buffer_load_dwordx4 v22, s[40:43], s14 offen lds
  s_waitcnt vmcnt(5)
  ds_read_b64_tr_b16 v[32:33], v20 offset:8192
  ds_read_b64_tr_b16 v[34:35], v20 offset:8448
  ds_read_b64_tr_b16 v[36:37], v20 offset:10240
  ds_read_b64_tr_b16 v[38:39], v20 offset:10496
  ds_read_b64_tr_b16 v[40:41], v20 offset:8224
  ds_read_b64_tr_b16 v[42:43], v20 offset:8480
  ds_read_b64_tr_b16 v[44:45], v20 offset:10272
  ds_read_b64_tr_b16 v[46:47], v20 offset:10528
  s_add_u32 m0, s13, 17408
  s_add_u32 s14, s15, 0x404000
  buffer_load_dwordx4 v22, s[40:43], s14 offen lds
  s_waitcnt lgkmcnt(0)
  ds_write_b128 v2, v[32:35] offset:8192
  ds_write_b128 v2, v[36:39] offset:9216
  ds_write_b128 v2, v[40:43] offset:10240
  ds_write_b128 v2, v[44:47] offset:11264
  s_add_u32 m0, s13, 18432
  s_add_u32 s14, s15, 0x440000
  buffer_load_dwordx4 v22, s[40:43], s14 offen lds
  ds_read_b128 a[176:179], v19 offset:8192
  ds_read_b128 a[180:183], v19 offset:9216
  ds_read_b128 a[184:187], v19 offset:8208
  ds_read_b128 a[188:191], v19 offset:9232
  s_add_u32 m0, s13, 19456
  s_add_u32 s14, s15, 0x444000
  buffer_load_dwordx4 v22, s[40:43], s14 offen lds
  s_waitcnt lgkmcnt(0)
  s_add_u32 m0, s13, 20480
  s_add_u32 s14, s15, 0xc0000
  buffer_load_dwordx4 v21, s[40:43], s14 offen lds
  s_waitcnt vmcnt(5)
  ds_read_b64_tr_b16 v[32:33], v20 offset:12288
  ds_read_b64_tr_b16 v[34:35], v20 offset:12544
  ds_read_b64_tr_b16 v[36:37], v20 offset:14336
  ds_read_b64_tr_b16 v[38:39], v20 offset:14592
  ds_read_b64_tr_b16 v[40:41], v20 offset:12320
  ds_read_b64_tr_b16 v[42:43], v20 offset:12576
  ds_read_b64_tr_b16 v[44:45], v20 offset:14368
  ds_read_b64_tr_b16 v[46:47], v20 offset:14624
  s_add_u32 m0, s13, 21504
  s_add_u32 s14, s15, 0xc2000
  buffer_load_dwordx4 v21, s[40:43], s14 offen lds
  s_waitcnt lgkmcnt(0)
  ds_write_b128 v2, v[32:35] offset:12288
  ds_write_b128 v2, v[36:39] offset:13312
  ds_write_b128 v2, v[40:43] offset:14336
  ds_write_b128 v2, v[44:47] offset:15360
  s_add_u32 m0, s13, 22528
  s_add_u32 s14, s15, 0x1c0000
  buffer_load_dwordx4 v21, s[40:43], s14 offen lds
  ds_read_b128 a[192:195], v19 offset:12288
  ds_read_b128 a[196:199], v19 offset:13312
  ds_read_b128 a[200:203], v19 offset:12304
  ds_read_b128 a[204:207], v19 offset:13328
  s_add_u32 m0, s13, 23552
  s_add_u32 s14, s15, 0x1c2000
  buffer_load_dwordx4 v21, s[40:43], s14 offen lds
  s_waitcnt lgkmcnt(0)
  s_add_u32 m0, s13, 24576
  s_add_u32 s14, s15, 0x2c0000
  buffer_load_dwordx4 v21, s[40:43], s14 offen lds
  s_waitcnt vmcnt(5)
  ds_read_b64_tr_b16 a[208:209], v20 offset:16384
  ds_read_b64_tr_b16 a[210:211], v20 offset:16640
  ds_read_b64_tr_b16 a[212:213], v20 offset:18432
  ds_read_b64_tr_b16 a[214:215], v20 offset:18688
  ds_read_b64_tr_b16 a[216:217], v20 offset:16416
  ds_read_b64_tr_b16 a[218:219], v20 offset:16672
  ds_read_b64_tr_b16 a[220:221], v20 offset:18464
  ds_read_b64_tr_b16 a[222:223], v20 offset:18720
  s_add_u32 m0, s13, 25600
  s_add_u32 s14, s15, 0x2c2000
  buffer_load_dwordx4 v21, s[40:43], s14 offen lds
  s_add_u32 m0, s13, 26624
  s_add_u32 s14, s15, 0x3c0000
  buffer_load_dwordx4 v21, s[40:43], s14 offen lds
  s_add_u32 m0, s13, 27648
  s_add_u32 s14, s15, 0x3c2000
  buffer_load_dwordx4 v21, s[40:43], s14 offen lds
  s_waitcnt lgkmcnt(0)
  s_add_u32 m0, s13, 28672
  s_add_u32 s14, s15, 0x0
  buffer_load_dwordx4 v21, s[40:43], s14 offen lds
  s_waitcnt vmcnt(5)
  ds_read_b64_tr_b16 a[224:225], v20 offset:20480
  ds_read_b64_tr_b16 a[226:227], v20 offset:20736
  ds_read_b64_tr_b16 a[228:229], v20 offset:22528
  ds_read_b64_tr_b16 a[230:231], v20 offset:22784
  ds_read_b64_tr_b16 a[232:233], v20 offset:20512
  ds_read_b64_tr_b16 a[234:235], v20 offset:20768
  ds_read_b64_tr_b16 a[236:237], v20 offset:22560
  ds_read_b64_tr_b16 a[238:239], v20 offset:22816
  s_add_u32 m0, s13, 29696
  s_add_u32 s14, s15, 0x2000
  buffer_load_dwordx4 v21, s[40:43], s14 offen lds
  s_add_u32 m0, s13, 30720
  s_add_u32 s14, s15, 0x100000
  buffer_load_dwordx4 v21, s[40:43], s14 offen lds
  s_add_u32 m0, s13, 31744
  s_add_u32 s14, s15, 0x102000
  buffer_load_dwordx4 v21, s[40:43], s14 offen lds
  s_waitcnt lgkmcnt(0)
  s_add_u32 m0, s13, 32768
  s_add_u32 s14, s15, 0x200000
  buffer_load_dwordx4 v21, s[40:43], s14 offen lds
  s_waitcnt vmcnt(5)
  ds_read_b64_tr_b16 a[240:241], v20 offset:24576
  ds_read_b64_tr_b16 a[242:243], v20 offset:24832
  ds_read_b64_tr_b16 a[244:245], v20 offset:26624
  ds_read_b64_tr_b16 a[246:247], v20 offset:26880
  ds_read_b64_tr_b16 a[248:249], v20 offset:24608
  ds_read_b64_tr_b16 a[250:251], v20 offset:24864
  ds_read_b64_tr_b16 a[252:253], v20 offset:26656
  ds_read_b64_tr_b16 a[254:255], v20 offset:26912
  s_add_u32 m0, s13, 33792
  s_add_u32 s14, s15, 0x202000
  buffer_load_dwordx4 v21, s[40:43], s14 offen lds
  s_add_u32 m0, s13, 34816
  s_add_u32 s14, s15, 0x300000
  buffer_load_dwordx4 v21, s[40:43], s14 offen lds
  s_add_u32 m0, s13, 35840
  s_add_u32 s14, s15, 0x302000
  buffer_load_dwordx4 v21, s[40:43], s14 offen lds
  s_waitcnt lgkmcnt(0)
  s_add_u32 m0, s13, 0
  s_add_u32 s14, s15, 0x40000
  buffer_load_dwordx4 v21, s[40:43], s14 offen lds
  s_waitcnt vmcnt(5)
  ds_read_b64_tr_b16 v[80:81], v20 offset:28672
  ds_read_b64_tr_b16 v[82:83], v20 offset:28928
  ds_read_b64_tr_b16 v[84:85], v20 offset:30720
  ds_read_b64_tr_b16 v[86:87], v20 offset:30976
  ds_read_b64_tr_b16 v[88:89], v20 offset:28704
  ds_read_b64_tr_b16 v[90:91], v20 offset:28960
  ds_read_b64_tr_b16 v[92:93], v20 offset:30752
  ds_read_b64_tr_b16 v[94:95], v20 offset:31008
  s_add_u32 m0, s13, 1024
  s_add_u32 s14, s15, 0x42000
  buffer_load_dwordx4 v21, s[40:43], s14 offen lds
  s_add_u32 m0, s13, 2048
  s_add_u32 s14, s15, 0x140000
  buffer_load_dwordx4 v21, s[40:43], s14 offen lds
  s_add_u32 m0, s13, 3072
  s_add_u32 s14, s15, 0x142000
  buffer_load_dwordx4 v21, s[40:43], s14 offen lds
  s_waitcnt lgkmcnt(0)
  s_add_u32 m0, s13, 4096
  s_add_u32 s14, s15, 0x240000
  buffer_load_dwordx4 v21, s[40:43], s14 offen lds
  s_waitcnt vmcnt(5)
  ds_read_b64_tr_b16 v[96:97], v20 offset:32768
  ds_read_b64_tr_b16 v[98:99], v20 offset:33024
  ds_read_b64_tr_b16 v[100:101], v20 offset:34816
  ds_read_b64_tr_b16 v[102:103], v20 offset:35072
  ds_read_b64_tr_b16 v[104:105], v20 offset:32800
  ds_read_b64_tr_b16 v[106:107], v20 offset:33056
  ds_read_b64_tr_b16 v[108:109], v20 offset:34848
  ds_read_b64_tr_b16 v[110:111], v20 offset:35104
  s_add_u32 m0, s13, 5120
  s_add_u32 s14, s15, 0x242000
  buffer_load_dwordx4 v21, s[40:43], s14 offen lds
  s_add_u32 m0, s13, 6144
  s_add_u32 s14, s15, 0x340000
  buffer_load_dwordx4 v21, s[40:43], s14 offen lds
  s_add_u32 m0, s13, 7168
  s_add_u32 s14, s15, 0x342000
  buffer_load_dwordx4 v21, s[40:43], s14 offen lds
  s_waitcnt lgkmcnt(0)
  s_add_u32 m0, s13, 8192
  s_add_u32 s14, s15, 0x80000
  buffer_load_dwordx4 v21, s[40:43], s14 offen lds
  s_waitcnt vmcnt(5)
  ds_read_b64_tr_b16 v[112:113], v20 offset:0
  ds_read_b64_tr_b16 v[114:115], v20 offset:256
  ds_read_b64_tr_b16 v[116:117], v20 offset:2048
  ds_read_b64_tr_b16 v[118:119], v20 offset:2304
  ds_read_b64_tr_b16 v[120:121], v20 offset:32
  ds_read_b64_tr_b16 v[122:123], v20 offset:288
  ds_read_b64_tr_b16 v[124:125], v20 offset:2080
  ds_read_b64_tr_b16 v[126:127], v20 offset:2336
  s_add_u32 m0, s13, 9216
  s_add_u32 s14, s15, 0x82000
  buffer_load_dwordx4 v21, s[40:43], s14 offen lds
  s_add_u32 m0, s13, 10240
  s_add_u32 s14, s15, 0x180000
  buffer_load_dwordx4 v21, s[40:43], s14 offen lds
  s_add_u32 m0, s13, 11264
  s_add_u32 s14, s15, 0x182000
  buffer_load_dwordx4 v21, s[40:43], s14 offen lds
  s_waitcnt lgkmcnt(0)
  s_add_u32 m0, s13, 12288
  s_add_u32 s14, s76, 0x400
  buffer_load_dwordx4 v18, s[44:47], s14 offen lds
  s_waitcnt vmcnt(5)
  ds_read_b64_tr_b16 v[128:129], v20 offset:4096
  ds_read_b64_tr_b16 v[130:131], v20 offset:4352
  ds_read_b64_tr_b16 v[132:133], v20 offset:6144
  ds_read_b64_tr_b16 v[134:135], v20 offset:6400
  ds_read_b64_tr_b16 v[136:137], v20 offset:4128
  ds_read_b64_tr_b16 v[138:139], v20 offset:4384
  ds_read_b64_tr_b16 v[140:141], v20 offset:6176
  ds_read_b64_tr_b16 v[142:143], v20 offset:6432
  s_add_u32 m0, s13, 13312
  s_add_u32 s14, s76, 0x1600
  buffer_load_dwordx4 v18, s[44:47], s14 offen lds
  s_add_u32 m0, s13, 14336
  s_add_u32 s14, s76, 0x2800
  buffer_load_dwordx4 v18, s[44:47], s14 offen lds
  s_add_u32 m0, s13, 15360
  s_add_u32 s14, s76, 0x3a00
  buffer_load_dwordx4 v18, s[44:47], s14 offen lds
  s_waitcnt lgkmcnt(0)
  s_add_u32 m0, s13, 16384
  s_add_u32 s14, s16, 0x80
  buffer_load_dwordx4 v23, s[44:47], s14 offen lds
  s_waitcnt vmcnt(5)
  ds_read_b64_tr_b16 v[144:145], v20 offset:8192
  ds_read_b64_tr_b16 v[146:147], v20 offset:8448
  ds_read_b64_tr_b16 v[148:149], v20 offset:10240
  ds_read_b64_tr_b16 v[150:151], v20 offset:10496
  ds_read_b64_tr_b16 v[152:153], v20 offset:8224
  ds_read_b64_tr_b16 v[154:155], v20 offset:8480
  ds_read_b64_tr_b16 v[156:157], v20 offset:10272
  ds_read_b64_tr_b16 v[158:159], v20 offset:10528
  s_add_u32 m0, s13, 17408
  s_add_u32 s14, s16, 0x1280
  buffer_load_dwordx4 v23, s[44:47], s14 offen lds
  s_add_u32 m0, s13, 18432
  s_add_u32 s14, s16, 0x2480
  buffer_load_dwordx4 v23, s[44:47], s14 offen lds
  s_add_u32 m0, s13, 19456
  s_add_u32 s14, s16, 0x3680
  buffer_load_dwordx4 v23, s[44:47], s14 offen lds
  s_waitcnt lgkmcnt(0)
  s_add_u32 m0, s13, 20480
  s_add_u32 s14, s16, 0xc0
  buffer_load_dwordx4 v23, s[44:47], s14 offen lds
  s_waitcnt vmcnt(5)
  ds_read_b64_tr_b16 v[160:161], v20 offset:12288
  ds_read_b64_tr_b16 v[162:163], v20 offset:12544
  ds_read_b64_tr_b16 v[164:165], v20 offset:14336
  ds_read_b64_tr_b16 v[166:167], v20 offset:14592
  ds_read_b64_tr_b16 v[168:169], v20 offset:12320
  ds_read_b64_tr_b16 v[170:171], v20 offset:12576
  ds_read_b64_tr_b16 v[172:173], v20 offset:14368
  ds_read_b64_tr_b16 v[174:175], v20 offset:14624
  s_add_u32 m0, s13, 21504
  s_add_u32 s14, s16, 0x12c0
  buffer_load_dwordx4 v23, s[44:47], s14 offen lds
  s_add_u32 m0, s13, 22528
  s_add_u32 s14, s16, 0x24c0
  buffer_load_dwordx4 v23, s[44:47], s14 offen lds
  s_add_u32 m0, s13, 23552
  s_add_u32 s14, s16, 0x36c0
  buffer_load_dwordx4 v23, s[44:47], s14 offen lds
  s_waitcnt lgkmcnt(0)
  s_add_u32 m0, s13, 24576
  s_add_u32 s14, s16, 0x12000
  buffer_load_dwordx4 v23, s[44:47], s14 offen lds
  s_waitcnt vmcnt(5)
  ds_read_b64_tr_b16 v[176:177], v20 offset:16384
  ds_read_b64_tr_b16 v[178:179], v20 offset:16640
  ds_read_b64_tr_b16 v[180:181], v20 offset:18432
  ds_read_b64_tr_b16 v[182:183], v20 offset:18688
  ds_read_b64_tr_b16 v[184:185], v20 offset:16416
  ds_read_b64_tr_b16 v[186:187], v20 offset:16672
  ds_read_b64_tr_b16 v[188:189], v20 offset:18464
  ds_read_b64_tr_b16 v[190:191], v20 offset:18720
  s_add_u32 m0, s13, 25600
  s_add_u32 s14, s16, 0x13200
  buffer_load_dwordx4 v23, s[44:47], s14 offen lds
  s_add_u32 m0, s13, 26624
  s_add_u32 s14, s16, 0x14400
  buffer_load_dwordx4 v23, s[44:47], s14 offen lds
  s_add_u32 m0, s13, 27648
  s_add_u32 s14, s16, 0x15600
  buffer_load_dwordx4 v23, s[44:47], s14 offen lds
  s_waitcnt lgkmcnt(0)
  s_add_u32 m0, s13, 28672
  s_add_u32 s14, s16, 0x12040
  buffer_load_dwordx4 v23, s[44:47], s14 offen lds
  s_waitcnt vmcnt(5)
  ds_read_b64_tr_b16 v[192:193], v20 offset:20480
  ds_read_b64_tr_b16 v[194:195], v20 offset:20736
  ds_read_b64_tr_b16 v[196:197], v20 offset:22528
  ds_read_b64_tr_b16 v[198:199], v20 offset:22784
  ds_read_b64_tr_b16 v[200:201], v20 offset:20512
  ds_read_b64_tr_b16 v[202:203], v20 offset:20768
  ds_read_b64_tr_b16 v[204:205], v20 offset:22560
  ds_read_b64_tr_b16 v[206:207], v20 offset:22816
  s_add_u32 m0, s13, 29696
  s_add_u32 s14, s16, 0x13240
  buffer_load_dwordx4 v23, s[44:47], s14 offen lds
  s_add_u32 m0, s13, 30720
  s_add_u32 s14, s16, 0x14440
  buffer_load_dwordx4 v23, s[44:47], s14 offen lds
  s_add_u32 m0, s13, 31744
  s_add_u32 s14, s16, 0x15640
  buffer_load_dwordx4 v23, s[44:47], s14 offen lds
  s_waitcnt lgkmcnt(0)
  s_add_u32 m0, s13, 32768
  s_add_u32 s14, s16, 0x12080
  buffer_load_dwordx4 v23, s[44:47], s14 offen lds
  s_waitcnt vmcnt(5)
  ds_read_b64_tr_b16 v[208:209], v20 offset:24576
  ds_read_b64_tr_b16 v[210:211], v20 offset:24832
  ds_read_b64_tr_b16 v[212:213], v20 offset:26624
  ds_read_b64_tr_b16 v[214:215], v20 offset:26880
  ds_read_b64_tr_b16 v[216:217], v20 offset:24608
  ds_read_b64_tr_b16 v[218:219], v20 offset:24864
  ds_read_b64_tr_b16 v[220:221], v20 offset:26656
  ds_read_b64_tr_b16 v[222:223], v20 offset:26912
  s_add_u32 m0, s13, 33792
  s_add_u32 s14, s16, 0x13280
  buffer_load_dwordx4 v23, s[44:47], s14 offen lds
  s_add_u32 m0, s13, 34816
  s_add_u32 s14, s16, 0x14480
  buffer_load_dwordx4 v23, s[44:47], s14 offen lds
  s_add_u32 m0, s13, 35840
  s_add_u32 s14, s16, 0x15680
  buffer_load_dwordx4 v23, s[44:47], s14 offen lds
  s_waitcnt lgkmcnt(0)
  s_add_u32 m0, s13, 0
  s_add_u32 s14, s16, 0x120c0
  buffer_load_dwordx4 v23, s[44:47], s14 offen lds
  s_waitcnt vmcnt(5)
  ds_read_b64_tr_b16 v[224:225], v20 offset:28672
  ds_read_b64_tr_b16 v[226:227], v20 offset:28928
  ds_read_b64_tr_b16 v[228:229], v20 offset:30720
  ds_read_b64_tr_b16 v[230:231], v20 offset:30976
  ds_read_b64_tr_b16 v[232:233], v20 offset:28704
  ds_read_b64_tr_b16 v[234:235], v20 offset:28960
  ds_read_b64_tr_b16 v[236:237], v20 offset:30752
  ds_read_b64_tr_b16 v[238:239], v20 offset:31008
  s_add_u32 m0, s13, 1024
  s_add_u32 s14, s16, 0x132c0
  buffer_load_dwordx4 v23, s[44:47], s14 offen lds
  s_add_u32 m0, s13, 2048
  s_add_u32 s14, s16, 0x144c0
  buffer_load_dwordx4 v23, s[44:47], s14 offen lds
  s_add_u32 m0, s13, 3072
  s_add_u32 s14, s16, 0x156c0
  buffer_load_dwordx4 v23, s[44:47], s14 offen lds
  s_waitcnt lgkmcnt(0)
  s_add_u32 m0, s13, 4096
  s_add_u32 s14, s16, 0x0
  buffer_load_dwordx4 v23, s[44:47], s14 offen lds
  s_waitcnt vmcnt(5)
  ds_read_b64_tr_b16 v[240:241], v20 offset:32768
  ds_read_b64_tr_b16 v[242:243], v20 offset:33024
  ds_read_b64_tr_b16 v[244:245], v20 offset:34816
  ds_read_b64_tr_b16 v[246:247], v20 offset:35072
  ds_read_b64_tr_b16 v[248:249], v20 offset:32800
  ds_read_b64_tr_b16 v[250:251], v20 offset:33056
  ds_read_b64_tr_b16 v[252:253], v20 offset:34848
  ds_read_b64_tr_b16 v[254:255], v20 offset:35104
  s_add_u32 m0, s13, 5120
  s_add_u32 s14, s16, 0x1200
  buffer_load_dwordx4 v23, s[44:47], s14 offen lds
  s_add_u32 m0, s13, 6144
  s_add_u32 s14, s16, 0x2400
  buffer_load_dwordx4 v23, s[44:47], s14 offen lds
  s_add_u32 m0, s13, 7168
  s_add_u32 s14, s16, 0x3600
  buffer_load_dwordx4 v23, s[44:47], s14 offen lds
  s_waitcnt lgkmcnt(0)
  s_add_u32 m0, s13, 8192
  s_add_u32 s14, s16, 0x40
  buffer_load_dwordx4 v23, s[44:47], s14 offen lds
  s_waitcnt vmcnt(5)
  ds_read_b64_tr_b16 v[48:49], v20 offset:0
  ds_read_b64_tr_b16 v[50:51], v20 offset:256
  ds_read_b64_tr_b16 v[52:53], v20 offset:2048
  ds_read_b64_tr_b16 v[54:55], v20 offset:2304
  ds_read_b64_tr_b16 v[56:57], v20 offset:32
  ds_read_b64_tr_b16 v[58:59], v20 offset:288
  ds_read_b64_tr_b16 v[60:61], v20 offset:2080
  ds_read_b64_tr_b16 v[62:63], v20 offset:2336
  s_add_u32 m0, s13, 9216
  s_add_u32 s14, s16, 0x1240
  buffer_load_dwordx4 v23, s[44:47], s14 offen lds
  s_add_u32 m0, s13, 10240
  s_add_u32 s14, s16, 0x2440
  buffer_load_dwordx4 v23, s[44:47], s14 offen lds
  s_add_u32 m0, s13, 11264
  s_add_u32 s14, s16, 0x3640
  buffer_load_dwordx4 v23, s[44:47], s14 offen lds
  s_waitcnt lgkmcnt(0)
  ds_write_b128 v2, v[48:51] offset:0
  ds_write_b128 v2, v[52:55] offset:1024
  ds_write_b128 v2, v[56:59] offset:2048
  ds_write_b128 v2, v[60:63] offset:3072
  s_waitcnt lgkmcnt(0)
  s_add_u32 m0, s13, 12288
  s_add_u32 s14, s15, 0x400000
  buffer_load_dwordx4 v22, s[32:35], s14 offen lds
  s_waitcnt vmcnt(5)
  ds_read_b64_tr_b16 v[48:49], v20 offset:4096
  ds_read_b64_tr_b16 v[50:51], v20 offset:4352
  ds_read_b64_tr_b16 v[52:53], v20 offset:6144
  ds_read_b64_tr_b16 v[54:55], v20 offset:6400
  ds_read_b64_tr_b16 v[56:57], v20 offset:4128
  ds_read_b64_tr_b16 v[58:59], v20 offset:4384
  ds_read_b64_tr_b16 v[60:61], v20 offset:6176
  ds_read_b64_tr_b16 v[62:63], v20 offset:6432
  s_add_u32 m0, s13, 13312
  s_add_u32 s14, s15, 0x404000
  buffer_load_dwordx4 v22, s[32:35], s14 offen lds
  s_add_u32 m0, s13, 14336
  s_add_u32 s14, s15, 0x440000
  buffer_load_dwordx4 v22, s[32:35], s14 offen lds
  s_add_u32 m0, s13, 15360
  s_add_u32 s14, s15, 0x444000
  buffer_load_dwordx4 v22, s[32:35], s14 offen lds
  s_waitcnt lgkmcnt(0)
  ds_write_b128 v2, v[48:51] offset:4096
  ds_write_b128 v2, v[52:55] offset:5120
  ds_write_b128 v2, v[56:59] offset:6144
  ds_write_b128 v2, v[60:63] offset:7168
  s_waitcnt lgkmcnt(0)
  s_add_u32 m0, s13, 16384
  s_add_u32 s14, s15, 0x280000
  buffer_load_dwordx4 v21, s[32:35], s14 offen lds
  s_waitcnt vmcnt(5)
  ds_read_b64_tr_b16 v[48:49], v20 offset:8192
  ds_read_b64_tr_b16 v[50:51], v20 offset:8448
  ds_read_b64_tr_b16 v[52:53], v20 offset:10240
  ds_read_b64_tr_b16 v[54:55], v20 offset:10496
  ds_read_b64_tr_b16 v[56:57], v20 offset:8224
  ds_read_b64_tr_b16 v[58:59], v20 offset:8480
  ds_read_b64_tr_b16 v[60:61], v20 offset:10272
  ds_read_b64_tr_b16 v[62:63], v20 offset:10528
  s_add_u32 m0, s13, 17408
  s_add_u32 s14, s15, 0x282000
  buffer_load_dwordx4 v21, s[32:35], s14 offen lds
  s_add_u32 m0, s13, 18432
  s_add_u32 s14, s15, 0x380000
  buffer_load_dwordx4 v21, s[32:35], s14 offen lds
  s_add_u32 m0, s13, 19456
  s_add_u32 s14, s15, 0x382000
  buffer_load_dwordx4 v21, s[32:35], s14 offen lds
  s_waitcnt lgkmcnt(0)
  ds_write_b128 v2, v[48:51] offset:8192
  ds_write_b128 v2, v[52:55] offset:9216
  ds_write_b128 v2, v[56:59] offset:10240
  ds_write_b128 v2, v[60:63] offset:11264
  s_waitcnt lgkmcnt(0)
  s_add_u32 m0, s13, 20480
  s_add_u32 s14, s15, 0x240000
  buffer_load_dwordx4 v21, s[32:35], s14 offen lds
  s_waitcnt vmcnt(5)
  s_getpc_b64 s[100:101]
.wm_4:
  s_sub_u32 s100, s100, .wm_4-interleave_layers__ssm_conv_h3__memory_aug_recurrent_mem_tr__prompt_kernel
  s_subb_u32 s101, s101, 0
  s_lshl_b32 s99, s9, 2
  s_add_u32 s99, s99, s3
  s_lshl_b32 s99, s99, 10
  v_lshlrev_b32 v8, 4, v0
  v_add_u32 v8, s99, v8
  v_min_u32 v8, .code_end-interleave_layers__ssm_conv_h3__memory_aug_recurrent_mem_tr__prompt_kernel-16, v8
  global_load_dwordx4 v[8:11], v8, s[100:101]
  ds_read_b64_tr_b16 v[32:33], v20 offset:12288
  ds_read_b64_tr_b16 v[34:35], v20 offset:12544
  ds_read_b64_tr_b16 v[36:37], v20 offset:14336
  ds_read_b64_tr_b16 v[38:39], v20 offset:14592
  ds_read_b64_tr_b16 v[40:41], v20 offset:12320
  ds_read_b64_tr_b16 v[42:43], v20 offset:12576
  ds_read_b64_tr_b16 v[44:45], v20 offset:14368
  ds_read_b64_tr_b16 v[46:47], v20 offset:14624
  s_add_u32 m0, s13, 21504
  s_add_u32 s14, s15, 0x242000
  buffer_load_dwordx4 v21, s[32:35], s14 offen lds
  s_waitcnt lgkmcnt(0)
  ds_write_b128 v2, v[32:35] offset:12288
  ds_write_b128 v2, v[36:39] offset:13312
  ds_write_b128 v2, v[40:43] offset:14336
  ds_write_b128 v2, v[44:47] offset:15360
  s_add_u32 m0, s13, 22528
  s_add_u32 s14, s15, 0x340000
  buffer_load_dwordx4 v21, s[32:35], s14 offen lds
  ds_read_b128 v[48:51], v19 offset:12288
  ds_read_b128 v[52:55], v19 offset:13312
  ds_read_b128 v[56:59], v19 offset:12304
  ds_read_b128 v[60:63], v19 offset:13328
  s_add_u32 m0, s13, 23552
  s_add_u32 s14, s15, 0x342000
  buffer_load_dwordx4 v21, s[32:35], s14 offen lds
  s_waitcnt lgkmcnt(0)
  ds_write_b128 v2, v[48:51] offset:12288
  ds_write_b128 v2, v[52:55] offset:13312
  ds_write_b128 v2, v[56:59] offset:14336
  ds_write_b128 v2, v[60:63] offset:15360
  s_waitcnt lgkmcnt(0)
  s_add_u32 m0, s13, 24576
  s_add_u32 s14, s15, 0x240000
  buffer_load_dwordx4 v21, s[36:39], s14 offen lds
  s_waitcnt vmcnt(6)
  s_load_dwordx2 s[100:101], s[0:1], 112
  v_and_b32 v12, 7, v0
  v_lshlrev_b32 v12, 5, v12
  s_waitcnt lgkmcnt(0)
.cw_5:
  global_load_dword v13, v12, s[100:101] offset:4 sc1
  s_waitcnt vmcnt(0)
  v_cmp_gt_u32 vcc, 32, v13
  s_cbranch_vccz .cd_6
  s_sleep 2
  s_sub_u32 s10, s10, 1
  s_cbranch_scc0 .cw_5
  s_mov_b32 s10, 0
.cd_6:
  v_and_b32 v11, 7, v0
  v_cmp_eq_u32 vcc, 1, v11
  s_nop 1
  v_cndmask_b32 v11, 0, 32, vcc
  s_load_dwordx2 s[100:101], s[0:1], 112
  v_and_b32 v12, 7, v0
  v_lshlrev_b32 v12, 5, v12
  s_waitcnt lgkmcnt(0)
.cw_7:
  global_load_dword v13, v12, s[100:101] offset:8 sc1
  s_waitcnt vmcnt(0)
  v_cmp_gt_u32 vcc, v11, v13
  s_cbranch_vccz .cd_8
  s_sleep 2
  s_sub_u32 s10, s10, 1
  s_cbranch_scc0 .cw_7
  s_mov_b32 s10, 0
.cd_8:
  ds_read_b64_tr_b16 v[32:33], v20 offset:16384
  ds_read_b64_tr_b16 v[34:35], v20 offset:16640
  ds_read_b64_tr_b16 v[36:37], v20 offset:18432
  ds_read_b64_tr_b16 v[38:39], v20 offset:18688
  ds_read_b64_tr_b16 v[40:41], v20 offset:16416
  ds_read_b64_tr_b16 v[42:43], v20 offset:16672
  ds_read_b64_tr_b16 v[44:45], v20 offset:18464
  ds_read_b64_tr_b16 v[46:47], v20 offset:18720
  s_add_u32 m0, s13, 25600
  s_add_u32 s14, s15, 0x242000
  buffer_load_dwordx4 v21, s[36:39], s14 offen lds
  s_waitcnt lgkmcnt(0)
  ds_write_b128 v2, v[32:35] offset:16384
  ds_write_b128 v2, v[36:39] offset:17408
  ds_write_b128 v2, v[40:43] offset:18432
  ds_write_b128 v2, v[44:47] offset:19456
  s_add_u32 m0, s13, 26624
  s_add_u32 s14, s15, 0x340000
  buffer_load_dwordx4 v21, s[36:39], s14 offen lds
  ds_read_b128 v[48:51], v19 offset:16384
  ds_read_b128 v[52:55], v19 offset:17408
  ds_read_b128 v[56:59], v19 offset:16400
  ds_read_b128 v[60:63], v19 offset:17424
  s_add_u32 m0, s13, 27648
  s_add_u32 s14, s15, 0x342000
  buffer_load_dwordx4 v21, s[36:39], s14 offen lds
  s_waitcnt lgkmcnt(0)
  ds_write_b128 v2, v[48:51] offset:16384
  ds_write_b128 v2, v[52:55] offset:17408
  ds_write_b128 v2, v[56:59] offset:18432
  ds_write_b128 v2, v[60:63] offset:19456
  s_waitcnt lgkmcnt(0)
  s_add_u32 m0, s13, 28672
  s_add_u32 s14, s15, 0x2c0000
  buffer_load_dwordx4 v21, s[36:39], s14 offen lds
  ds_read_b64_tr_b16 v[32:33], v20 offset:20480
  ds_read_b64_tr_b16 v[34:35], v20 offset:20736
  ds_read_b64_tr_b16 v[36:37], v20 offset:22528
  ds_read_b64_tr_b16 v[38:39], v20 offset:22784
  ds_read_b64_tr_b16 v[40:41], v20 offset:20512
  ds_read_b64_tr_b16 v[42:43], v20 offset:20768
  ds_read_b64_tr_b16 v[44:45], v20 offset:22560
  ds_read_b64_tr_b16 v[46:47], v20 offset:22816
  s_add_u32 m0, s13, 29696
  s_add_u32 s14, s15, 0x2c2000
  buffer_load_dwordx4 v21, s[36:39], s14 offen lds
  s_waitcnt lgkmcnt(0)
  ds_write_b128 v2, v[32:35] offset:20480
  ds_write_b128 v2, v[36:39] offset:21504
  ds_write_b128 v2, v[40:43] offset:22528
  ds_write_b128 v2, v[44:47] offset:23552
  s_add_u32 m0, s13, 30720
  s_add_u32 s14, s15, 0x3c0000
  buffer_load_dwordx4 v21, s[36:39], s14 offen lds
  ds_read_b128 v[48:51], v19 offset:20480
  ds_read_b128 v[52:55], v19 offset:21504
  ds_read_b128 v[56:59], v19 offset:20496
  ds_read_b128 v[60:63], v19 offset:21520
  s_add_u32 m0, s13, 31744
  s_add_u32 s14, s15, 0x3c2000
  buffer_load_dwordx4 v21, s[36:39], s14 offen lds
  s_waitcnt lgkmcnt(0)
  ds_write_b128 v2, v[48:51] offset:20480
  ds_write_b128 v2, v[52:55] offset:21504
  ds_write_b128 v2, v[56:59] offset:22528
  ds_write_b128 v2, v[60:63] offset:23552
  s_waitcnt lgkmcnt(0)
  s_add_u32 m0, s13, 32768
  s_add_u32 s14, s15, 0x280000
  buffer_load_dwordx4 v21, s[40:43], s14 offen lds
  s_waitcnt vmcnt(5)
  s_min_u32 s73, s3, 2
  s_mul_i32 s73, s73, 304128
  s_add_u32 s73, s73, s56
  s_mul_i32 s75, s12, 9216
  s_add_u32 s75, s75, s73
  s_add_u32 s75, s75, 9216
  v_lshlrev_b32 v8, 7, v0
  buffer_load_dword v9, v8, s[4:7], s73 offen sc1
  buffer_load_dword v9, v8, s[4:7], s73 offen offset:1024 sc1
  buffer_load_dword v9, v8, s[4:7], s75 offen sc1
  buffer_load_dword v9, v8, s[4:7], s75 offen offset:1024 sc1
  ds_read_b64_tr_b16 v[32:33], v20 offset:24576
  ds_read_b64_tr_b16 v[34:35], v20 offset:24832
  ds_read_b64_tr_b16 v[36:37], v20 offset:26624
  ds_read_b64_tr_b16 v[38:39], v20 offset:26880
  ds_read_b64_tr_b16 v[40:41], v20 offset:24608
  ds_read_b64_tr_b16 v[42:43], v20 offset:24864
  ds_read_b64_tr_b16 v[44:45], v20 offset:26656
  ds_read_b64_tr_b16 v[46:47], v20 offset:26912
  s_add_u32 m0, s13, 33792
  s_add_u32 s14, s15, 0x282000
  buffer_load_dwordx4 v21, s[40:43], s14 offen lds
  s_waitcnt lgkmcnt(0)
  ds_write_b128 v2, v[32:35] offset:24576
  ds_write_b128 v2, v[36:39] offset:25600
  ds_write_b128 v2, v[40:43] offset:26624
  ds_write_b128 v2, v[44:47] offset:27648
  s_add_u32 m0, s13, 34816
  s_add_u32 s14, s15, 0x380000
  buffer_load_dwordx4 v21, s[40:43], s14 offen lds
  ds_read_b128 v[48:51], v19 offset:24576
  ds_read_b128 v[52:55], v19 offset:25600
  ds_read_b128 v[56:59], v19 offset:24592
  ds_read_b128 v[60:63], v19 offset:25616
  s_add_u32 m0, s13, 35840
  s_add_u32 s14, s15, 0x382000
  buffer_load_dwordx4 v21, s[40:43], s14 offen lds
  s_waitcnt lgkmcnt(0)
  ds_write_b128 v2, v[48:51] offset:24576
  ds_write_b128 v2, v[52:55] offset:25600
  ds_write_b128 v2, v[56:59] offset:26624
  ds_write_b128 v2, v[60:63] offset:27648
  s_waitcnt lgkmcnt(0)
  s_waitcnt vmcnt(8)
  ds_read_b64_tr_b16 v[32:33], v20 offset:28672
  ds_read_b64_tr_b16 v[34:35], v20 offset:28928
  ds_read_b64_tr_b16 v[36:37], v20 offset:30720
  ds_read_b64_tr_b16 v[38:39], v20 offset:30976
  ds_read_b64_tr_b16 v[40:41], v20 offset:28704
  ds_read_b64_tr_b16 v[42:43], v20 offset:28960
  ds_read_b64_tr_b16 v[44:45], v20 offset:30752
  ds_read_b64_tr_b16 v[46:47], v20 offset:31008
  s_waitcnt lgkmcnt(0)
  ds_write_b128 v2, v[32:35] offset:28672
  ds_write_b128 v2, v[36:39] offset:29696
  ds_write_b128 v2, v[40:43] offset:30720
  ds_write_b128 v2, v[44:47] offset:31744
  ds_read_b128 v[48:51], v19 offset:28672
  ds_read_b128 v[52:55], v19 offset:29696
  ds_read_b128 v[56:59], v19 offset:28688
  ds_read_b128 v[60:63], v19 offset:29712
  s_waitcnt lgkmcnt(0)
  ds_write_b128 v2, v[48:51] offset:28672
  ds_write_b128 v2, v[52:55] offset:29696
  ds_write_b128 v2, v[56:59] offset:30720
  ds_write_b128 v2, v[60:63] offset:31744
  s_waitcnt lgkmcnt(0)
  s_waitcnt vmcnt(0)
  ds_read_b64_tr_b16 v[48:49], v20 offset:32768
  ds_read_b64_tr_b16 v[50:51], v20 offset:33024
  ds_read_b64_tr_b16 v[52:53], v20 offset:34816
  ds_read_b64_tr_b16 v[54:55], v20 offset:35072
  ds_read_b64_tr_b16 v[56:57], v20 offset:32800
  ds_read_b64_tr_b16 v[58:59], v20 offset:33056
  ds_read_b64_tr_b16 v[60:61], v20 offset:34848
  ds_read_b64_tr_b16 v[62:63], v20 offset:35104
  s_waitcnt lgkmcnt(0)
  ds_write_b128 v2, v[48:51] offset:32768
  ds_write_b128 v2, v[52:55] offset:33792
  ds_write_b128 v2, v[56:59] offset:34816
  ds_write_b128 v2, v[60:63] offset:35840
  s_waitcnt lgkmcnt(0)
  v_bfe_u32 v1, v0, 2, 2
  v_lshlrev_b32 v1, 8, v1
  v_bfe_u32 v24, v0, 0, 1
  v_lshl_add_u32 v1, v24, 7, v1
  v_bfe_u32 v24, v0, 4, 2
  v_lshl_add_u32 v1, v24, 5, v1
  v_bfe_u32 v24, v0, 1, 1
  v_lshl_add_u32 v1, v24, 4, v1
  v_and_b32 v24, 8, v0
  v_lshlrev_b32 v24, 3, v24
  v_xor_b32 v1, v1, v24
  v_add_u32 v1, 147456, v1
  v_bfe_u32 v3, v0, 3, 1
  v_lshlrev_b32 v3, 10, v3
  v_bfe_u32 v24, v0, 0, 3
  v_lshl_add_u32 v3, v24, 6, v3
  v_bfe_u32 v24, v0, 4, 2
  v_lshl_add_u32 v3, v24, 4, v3
  v_add_u32 v3, 156672, v3
  v_bfe_u32 v24, v0, 1, 2
  v_lshlrev_b32 v24, 4, v24
  v_xor_b32 v3, v3, v24
  s_lshl_b32 s14, s3, 9
  s_add_u32 s14, s14, 156672
  v_bfe_u32 v4, v0, 4, 2
  v_lshlrev_b32 v4, 7, v4
  v_bfe_u32 v24, v0, 0, 4
  v_lshl_add_u32 v4, v24, 2, v4
  v_add_u32 v4, s14, v4
  v_bfe_u32 v24, v0, 4, 2
  v_lshlrev_b32 v24, 4, v24
  v_xor_b32 v4, v4, v24
  v_bfe_u32 v5, v0, 1, 1
  v_lshlrev_b32 v5, 10, v5
  v_bfe_u32 v24, v0, 2, 2
  v_lshl_add_u32 v5, v24, 7, v5
  v_bfe_u32 v24, v0, 0, 1
  v_lshl_add_u32 v5, v24, 6, v5
  v_bfe_u32 v24, v0, 4, 2
  v_lshl_add_u32 v5, v24, 4, v5
  v_add_u32 v5, 158848, v5
  v_bfe_u32 v24, v0, 2, 2
  v_lshlrev_b32 v24, 4, v24
  v_xor_b32 v5, v5, v24
  v_bfe_u32 v6, v0, 1, 1
  v_lshlrev_b32 v6, 9, v6
  v_bfe_u32 v24, v0, 2, 2
  v_lshl_add_u32 v6, v24, 7, v6
  v_bfe_u32 v24, v0, 0, 1
  v_lshl_add_u32 v6, v24, 6, v6
  v_bfe_u32 v24, v0, 4, 2
  v_lshl_add_u32 v6, v24, 4, v6
  v_add_u32 v6, 156672, v6
  v_bfe_u32 v24, v0, 2, 2
  v_lshlrev_b32 v24, 4, v24
  v_xor_b32 v6, v6, v24
  v_and_b32 v24, 2, v0
  v_lshl_add_u32 v6, v24, 4, v6
  v_bfe_u32 v8, v0, 0, 6
  v_lshlrev_b32 v8, 1, v8
  v_bfe_u32 v9, v0, 3, 3
  v_mul_u32_u24 v9, 9216, v9
  v_and_b32 v24, 7, v0
  v_lshl_add_u32 v9, v24, 4, v9
  s_mov_b32 s24, 0x00ff00ff
  s_mov_b32 s25, 0x00ff00ff
  s_cmp_ge_u32 s3, 2
  s_cselect_b32 s26, 0xff00ff00, s24
  s_mov_b32 s27, s26
  s_mov_b32 s28, -1
  s_mov_b32 s29, 0
  s_mov_b32 s80, 0xaaaaaaaa
  s_mov_b32 s81, 0xaaaaaaaa
  s_cmp_eq_u32 s3, 2
  s_cselect_b32 s80, 0xf0f0f0f0, s80
  s_mov_b32 s81, s80
  s_mov_b32 s82, 0x3030303
  s_cselect_b32 s82, 0x11111111, s82
  s_mov_b32 s83, s82
  s_mov_b32 s84, 0x30303030
  s_cselect_b32 s84, 0x22222222, s84
  s_mov_b32 s85, s84
  s_mov_b32 s86, 0xc0c0c0c
  s_cselect_b32 s86, 0x44444444, s86
  s_mov_b32 s87, s86
  s_mov_b32 s88, 0xc0c0c0c0
  s_cselect_b32 s88, 0x88888888, s88
  s_mov_b32 s89, s88
  s_mov_b32 s30, 0x3e0293ee
  s_mov_b32 s52, 0
  s_lshl_b32 s53, s11, 5
  s_add_u32 s53, s53, s12
  s_lshl_b32 s62, s53, 18
  s_lshl_b32 s53, s53, 20
  s_add_u32 s53, s53, 0x4000000
  s_add_u32 s62, s62, 0xd000000
  s_and_b32 s54, s3, 1
  s_lshl_b32 s54, s54, 12
  s_lshr_b32 s14, s3, 1
  s_lshl_b32 s14, s14, 11
  s_add_u32 s54, s54, s14
  s_sub_u32 s54, s54, s13
  s_lshl_b32 s55, s3, 11
  s_add_u32 s55, s55, 8192
  s_sub_u32 s55, s55, s13
  s_mul_i32 s56, s11, 0xe0000
  s_add_u32 s56, s56, 0x1c80000
  s_add_u32 s57, s56, 304128
  s_add_u32 s58, s56, 608256
  s_mul_i32 s22, s12, 9216
  s_add_u32 s22, s22, 9216
  s_lshl_b32 s61, s3, 5
  s_add_u32 s61, s61, s12
  s_lshr_b32 s14, s12, 2
  s_add_u32 s14, s14, 64
  s_cmp_eq_u32 s3, 2
  s_cselect_b32 s61, s14, s61
  s_lshl_b32 s61, s61, 7
  s_and_b32 s14, s12, 3
  s_cmp_eq_u32 s14, 0
  s_cselect_b32 s14, 3, 2
  s_cmp_ge_u32 s3, s14
  s_cselect_b32 s61, -1, s61
  s_lshl_b32 s17, s11, 5
  s_add_u32 s17, s17, s12
  s_lshl_b32 s17, s17, 8
  s_add_u32 s17, s17, 0x0
  s_and_b32 s19, s3, 1
  s_mul_i32 s19, s19, 1024
  s_lshr_b32 s14, s3, 1
  s_mul_i32 s14, s14, 512
  s_sub_u32 s19, s19, s14
  s_add_u32 s19, s19, 4224
  s_mul_i32 s20, s3, 544
  s_lshl_b32 s21, s3, 11
  s_lshl_b32 s95, s3, 8
  s_add_u32 s95, s95, 8192
  s_lshr_b32 s23, s61, 3
  s_lshr_b32 s31, s61, 2
  s_xor_b32 s23, s23, s31
  s_and_b32 s23, s23, 64
  s_and_b32 s31, s61, 0x3c00
  s_add_u32 s15, s23, s31
  s_and_b32 s31, s61, 0x180
  s_lshl_b32 s31, s31, 1
  s_add_u32 s15, s15, s31
  s_cmp_lt_u32 s3, 2
  s_cselect_b32 s31, 0x1000, 0
  s_xor_b32 s15, s15, s31
  s_and_b32 s31, s15, 0x1c00
  s_cselect_b32 s31, 0, 0x2000
  s_xor_b32 s15, s15, s31
  v_bfe_u32 v7, v0, 0, 4
  v_lshlrev_b32 v7, 2, v7
  v_bfe_u32 v24, v0, 4, 1
  v_lshl_add_u32 v7, v24, 7, v7
  v_add_u32 v7, s15, v7
  v_bfe_u32 v24, v0, 1, 1
  v_mul_u32_u24 v24, 0xaaaa, v24
  v_add_u32 v0, 0x14444, v24
  s_mov_b32 s63, 0
  s_mov_b32 s44, s56
  s_mov_b32 s94, 0x1e40100
  s_cmp_ge_u32 s3, 2
  s_cselect_b32 s15, 1024, 0
  s_add_u32 s15, s15, 5248
  s_sub_u32 s15, s15, s19
  s_sub_u32 s42, 5248, s20
  s_mov_b32 s16, 0x42000000
  s_mul_i32 s59, s3, 1024
  s_add_u32 s59, s59, 158848
  s_sub_u32 s59, s59, s13
  s_lshl_b32 s14, s3, 10
  s_add_u32 s62, s62, s14
  s_sub_u32 s62, s62, s13
  s_mov_b32 s60, 0x1e48000
  s_add_u32 s60, s60, s14
  s_sub_u32 s60, s60, s13
  s_lshl_b32 s14, s12, 7
  s_cmp_eq_u32 s61, -1
  s_cselect_b32 s48, s14, s61
  s_lshl_b32 s49, s3, 10
  s_lshr_b32 s43, s3, 1
  s_lshl_b32 s43, s43, 9
  s_and_b32 s14, s3, 1
  s_lshl_b32 s14, s14, 6
  s_add_u32 s43, s43, s14
  s_add_u32 s43, s43, 8192
  s_lshl_b32 s45, s3, 12
  s_add_u32 s45, s45, 16384
  s_mov_b32 s96, 0x3f803f80
  s_mov_b32 s97, 0x3f803f80
  s_mov_b32 s18, 1
.pl_9:
  buffer_load_ushort v11, v8, s[4:7], s17 offen sc1
  s_waitcnt vmcnt(0)
  v_cmp_gt_u32 vcc, s18, v11
  s_cbranch_vccz .pd_10
  s_sub_u32 s10, s10, 1
  s_cbranch_scc0 .pl_9
  s_mov_b32 s10, 0
.pd_10:
  s_add_u32 s14, s53, s54
  s_add_u32 s54, s54, 16384
  buffer_load_dwordx4 v[16:19], v2, s[4:7], s14 offen sc1
  buffer_load_dwordx4 v[20:23], v2, s[4:7], s14 offen offset:1024 sc1
  s_branch .credo_13x
.credo_13:
  s_waitcnt vmcnt(0) lgkmcnt(0)
  s_sub_u32 s14, s14, 16384
  buffer_load_dwordx4 v[16:19], v2, s[4:7], s14 offen sc1
  buffer_load_dwordx4 v[20:23], v2, s[4:7], s14 offen offset:1024 sc1
  s_mov_b32 s60, 0x1e60000
.credo_13x:
  ds_read_b128 v[48:51], v2 offset:12288
  ds_read_b128 v[52:55], v2 offset:13312
  ds_read_b128 v[56:59], v2 offset:18432
  ds_read_b128 v[60:63], v2 offset:19456
.cloop_11:
  s_add_u32 s14, s56, s49
  s_sub_u32 s14, s14, s13
  s_add_u32 m0, s49, 147456
  s_barrier
  v_add_u32 v11, s59, v2
  ds_read_b128 v[12:15], v11
  v_mov_b64 v[40:41], 0
  v_mov_b64 v[42:43], 0
  v_mov_b64 v[44:45], 0
  v_mov_b64 v[46:47], 0
  v_lshlrev_b32 v10, 1, v8
  s_add_u32 s45, s14, 4096
  s_add_u32 s23, s56, s95
  s_add_u32 s31, s53, s55
  s_add_u32 s50, s52, 1
  s_mov_b32 s51, 0
  s_and_b32 s47, s50, 1
  s_lshl_b32 s47, s47, 7
  s_add_u32 s47, s47, s17
  s_lshr_b32 s18, s50, 1
  s_add_u32 s18, s18, 1
  s_min_u32 s18, s18, 32
  v_mov_b32 v0, v0
  s_nop 2
  v_mov_b32 v0, v0
  s_nop 2
  v_mov_b32 v0, v0
  s_nop 2
  v_mov_b32 v0, v0
  s_nop 2
  buffer_load_dwordx4 v2, s[4:7], s14 offen sc1 lds
  s_waitcnt vmcnt(5)
  ds_read_b128 v[64:67], v2 offset:16384
  s_waitcnt vmcnt(4)
  ds_read_b128 v[68:71], v2 offset:17408
  s_waitcnt vmcnt(3)
  ds_read_b128 v[72:75], v2 offset:14336
  s_waitcnt vmcnt(2)
  ds_read_b128 v[76:79], v2 offset:15360
  v_mov_b32 v0, v0
  s_nop 2
  v_mov_b32 v0, v0
  s_nop 2
  v_mov_b32 v0, v0
  s_nop 2
  s_add_u32 m0, s49, 151552
  s_nop 0
  buffer_load_dwordx4 v2, s[4:7], s45 offen sc1 lds
  s_add_u32 m0, s95, 147456
  s_nop 0
  buffer_load_dword v10, s[4:7], s23 offen sc1 lds
  s_add_u32 m0, s49, 147456
  s_nop 0
  buffer_load_dwordx4 v2, s[4:7], s14 offen sc1 lds
  v_mov_b32 v0, v0
  s_nop 2
  v_mov_b32 v0, v0
  s_nop 2
  v_mfma_f32_16x16x4_f32 v[40:43], v44, v44, 0
  s_waitcnt vmcnt(3)
  s_barrier
.bg_14:
  ds_read_b128 v[24:27], v1 offset:0
  ds_read_b128 v[28:31], v1 offset:1024
  v_mov_b32 v0, v0
  ds_read_b128 v[32:35], v1 offset:2048
  ds_read_b128 v[36:39], v1 offset:3072
  v_mov_b32 v0, v0
  s_nop 2
  s_waitcnt lgkmcnt(3)
  v_smfmac_f32_16x16x64_bf16 v[40:43], v[24:27], v[48:55], v0
  s_waitcnt lgkmcnt(2)
  v_max_u32 v11, v24, v28
  v_smfmac_f32_16x16x64_bf16 v[44:47], v[24:27], v[72:79], v0
  s_waitcnt vmcnt(1)
  s_barrier
  v_smfmac_f32_16x16x64_bf16 v[40:43], v[28:31], v[64:71], v0
  s_waitcnt lgkmcnt(0)
  ds_read_b128 v[24:27], v1 offset:4096
  v_max3_u32 v11, v11, v32, v36
  v_smfmac_f32_16x16x64_bf16 v[44:47], v[28:31], v[56:63], v0
  ds_read_b128 v[28:31], v1 offset:5120
  v_cmp_eq_u32 vcc, -1, v11
  v_smfmac_f32_16x16x64_bf16 v[40:43], v[32:35], a[0:7], v0
  s_cbranch_vccnz .br_15
.br_15b:
  buffer_load_ushort v11, v8, s[4:7], s47 offen sc1
  v_smfmac_f32_16x16x64_bf16 v[44:47], v[32:35], a[8:15], v0
  buffer_load_dwordx4 v[72:75], v2, s[4:7], s31 offen sc1
  ds_read_b128 v[32:35], v1 offset:6144
  v_smfmac_f32_16x16x64_bf16 v[40:43], v[36:39], a[16:23], v0
  ds_read_b128 v[64:67], v2 offset:20480
  v_mov_b64 v[48:49], 0
  v_smfmac_f32_16x16x64_bf16 v[44:47], v[36:39], a[24:31], v0
  s_waitcnt lgkmcnt(3)
  ds_read_b128 v[68:71], v2 offset:21504
  v_mov_b64 v[50:51], 0
  v_smfmac_f32_16x16x64_bf16 v[40:43], v[24:27], a[32:39], v0
  s_add_u32 s14, s53, s54
  ds_read_b128 v[36:39], v1 offset:7168
  v_mov_b64 v[52:53], 0
  v_smfmac_f32_16x16x64_bf16 v[44:47], v[24:27], a[40:47], v0
  s_waitcnt lgkmcnt(4)
  buffer_load_dwordx4 v[76:79], v2, s[4:7], s31 offen offset:1024 sc1
  ds_read_b128 v[56:59], v2 offset:22528
  v_smfmac_f32_16x16x64_bf16 v[40:43], v[28:31], a[48:55], v0
  ds_read_b128 v[60:63], v2 offset:23552
  v_mov_b64 v[54:55], 0
  v_smfmac_f32_16x16x64_bf16 v[44:47], v[28:31], a[56:63], v0
  s_waitcnt lgkmcnt(5)
  ds_read_b128 v[24:27], v1 offset:8192
  v_mov_b32 v10, -1
  v_smfmac_f32_16x16x64_bf16 v[40:43], v[32:35], a[64:71], v0
  v_smfmac_f32_16x16x64_bf16 v[44:47], v[32:35], a[72:79], v0
  s_waitcnt lgkmcnt(3)
  buffer_store_short v10, v8, s[4:7], s94 offen
  v_smfmac_f32_16x16x64_bf16 v[40:43], v[36:39], v[64:71], v0
  s_waitcnt lgkmcnt(1)
  ds_read_b128 v[64:67], v2 offset:24576
  v_mov_b32 v10, s15
  v_smfmac_f32_16x16x64_bf16 v[44:47], v[36:39], v[56:63], v0
  s_waitcnt lgkmcnt(1)
  ds_read_b128 v[68:71], v2 offset:25600
  v_cndmask_b32 v10, v10, 0, s[26:27]
  v_smfmac_f32_16x16x64_bf16 v[40:43], v[24:27], a[80:87], v0
  ds_read_b128 v[56:59], v2 offset:26624
  v_add3_u32 v10, v10, s19, v3
  v_smfmac_f32_16x16x64_bf16 v[44:47], v[24:27], a[88:95], v0
  ds_read_b128 v[60:63], v2 offset:27648
  v_smfmac_f32_16x16x64_bf16 v[48:51], v[24:27], a[192:199], v0
  buffer_store_dwordx4 v[12:15], v2, s[4:7], s60 offen sc1
  v_add_f32 v40, v40, v42
  v_add_f32 v41, v41, v43
  v_smfmac_f32_16x16x64_bf16 v[52:55], v[24:27], a[200:207], v0
  s_waitcnt lgkmcnt(2)
  ds_read_b128 v[24:27], v1 offset:4096
  v_add_f32 v44, v44, v46
  v_add_f32 v45, v45, v47
  v_smfmac_f32_16x16x64_bf16 v[48:51], v[36:39], v[64:71], v0
  s_waitcnt lgkmcnt(1)
  ds_read_b128 v[64:67], v2 offset:28672
  v_cvt_pk_bf16_f32 v40, v40, v44
  v_cvt_pk_bf16_f32 v41, v41, v45
  v_smfmac_f32_16x16x64_bf16 v[52:55], v[36:39], v[56:63], v0
  ds_write2_b32 v4, v40, v41 offset1:16
  v_smfmac_f32_16x16x64_bf16 v[48:51], v[32:35], a[176:183], v0
  ds_read_b128 v[68:71], v2 offset:29696
  ds_read_b128 v[36:39], v1 offset:3072
  v_smfmac_f32_16x16x64_bf16 v[52:55], v[32:35], a[184:191], v0
  ds_read_b128 v[56:59], v2 offset:30720
  v_smfmac_f32_16x16x64_bf16 v[48:51], v[28:31], a[160:167], v0
  ds_read_b128 v[60:63], v2 offset:31744
  v_smfmac_f32_16x16x64_bf16 v[52:55], v[28:31], a[168:175], v0
  s_waitcnt lgkmcnt(4)
  s_barrier
  ds_read_b128 v[40:43], v3
  v_smfmac_f32_16x16x64_bf16 v[48:51], v[24:27], a[144:151], v0
  ds_read_b128 v[44:47], v3 offset:512
  ds_read_b128 v[32:35], v1 offset:2048
  v_smfmac_f32_16x16x64_bf16 v[52:55], v[24:27], a[152:159], v0
  s_waitcnt lgkmcnt(5)
  ds_read_b128 v[28:31], v1 offset:1024
  v_smfmac_f32_16x16x64_bf16 v[48:51], v[36:39], v[64:71], v0
  s_waitcnt lgkmcnt(4)
  ds_read_b128 v[24:27], v1 offset:0
  v_smfmac_f32_16x16x64_bf16 v[52:55], v[36:39], v[56:63], v0
  s_waitcnt lgkmcnt(4)
  ds_read_b128 v[64:67], v2 offset:32768
  v_mfma_f32_16x16x32_bf16 v[12:15], v[16:19], v[40:43], 0
  s_waitcnt lgkmcnt(4)
  ds_read_b128 v[68:71], v2 offset:33792
  v_mov_b64 v[56:57], 0
  v_mfma_f32_16x16x32_bf16 v[12:15], v[20:23], v[44:47], v[12:15]
  s_waitcnt lgkmcnt(4)
  ds_read_b128 v[16:19], v2 offset:34816
  v_mov_b64 v[58:59], 0
  v_smfmac_f32_16x16x64_bf16 v[48:51], v[32:35], a[128:135], v0
  ds_read_b128 v[20:23], v2 offset:35840
  v_mov_b64 v[60:61], 0
  v_smfmac_f32_16x16x64_bf16 v[52:55], v[32:35], a[136:143], v0
  s_waitcnt lgkmcnt(5)
  ds_write_b64 v10, v[12:13]
  v_cmp_u_f32 vcc, v12, v12
  v_smfmac_f32_16x16x64_bf16 v[48:51], v[28:31], a[112:119], v0
  ds_write_b64 v10, v[14:15] offset:8
  v_smfmac_f32_16x16x64_bf16 v[52:55], v[28:31], a[120:127], v0
  s_waitcnt lgkmcnt(6)
  s_cbranch_vccnz .rd_16
.rd_16b:
  v_mov_b64 v[62:63], 0
  v_smfmac_f32_16x16x64_bf16 v[48:51], v[24:27], a[96:103], v0
  v_mov_b32 v10, s42
  v_smfmac_f32_16x16x64_bf16 v[52:55], v[24:27], a[104:111], v0
  s_waitcnt lgkmcnt(4)
  v_cndmask_b32 v10, v10, 0, s[24:25]
  v_smfmac_f32_16x16x64_bf16 v[56:59], v[28:31], v[64:71], v0
  s_waitcnt lgkmcnt(0)
  s_barrier
  v_add_f32 v48, v48, v50
  v_add_f32 v49, v49, v51
  v_smfmac_f32_16x16x64_bf16 v[60:63], v[28:31], v[16:23], v0
  ds_read_b128 v[28:31], v1 offset:5120
  v_add_f32 v52, v52, v54
  v_cvt_pk_bf16_f32 v48, v48, v52
  ds_write_b32 v4, v48 offset:2176
  v_add_f32 v53, v53, v55
  v_cvt_pk_bf16_f32 v49, v49, v53
  ds_write_b32 v4, v49 offset:2240
  v_smfmac_f32_16x16x64_bf16 v[56:59], v[24:27], a[208:215], v0
  ds_read_b128 v[64:67], v3 offset:4224
  ds_read_b128 v[68:71], v3 offset:4736
  v_smfmac_f32_16x16x64_bf16 v[60:63], v[24:27], a[216:223], v0
  ds_read_b128 v[24:27], v1 offset:4096
  v_add3_u32 v10, v10, s20, v3
  v_smfmac_f32_16x16x64_bf16 v[56:59], v[32:35], a[224:231], v0
  s_lshr_b32 s23, s21, 2
  v_smfmac_f32_16x16x64_bf16 v[60:63], v[32:35], a[232:239], v0
  s_waitcnt lgkmcnt(3)
  s_barrier
  ds_read_b128 v[48:51], v5
  v_smfmac_f32_16x16x64_bf16 v[56:59], v[36:39], a[240:247], v0
  ds_read_b128 v[52:55], v5 offset:512
  s_waitcnt lgkmcnt(3)
  v_add_f32 v64, v64, v68
  v_smfmac_f32_16x16x64_bf16 v[60:63], v[36:39], a[248:255], v0
  s_waitcnt lgkmcnt(2)
  ds_read_b128 v[36:39], v1 offset:7168
  v_add_f32 v65, v65, v69
  v_add_f32 v66, v66, v70
  v_smfmac_f32_16x16x64_bf16 v[56:59], v[24:27], v[80:87], v0
  ds_read_b128 v[32:35], v1 offset:6144
  v_add_f32 v67, v67, v71
  v_mul_f32 v64, s30, v64
  v_smfmac_f32_16x16x64_bf16 v[60:63], v[24:27], v[88:95], v0
  s_waitcnt lgkmcnt(3)
  ds_read_b128 v[24:27], v1 offset:8192
  v_mul_f32 v65, s30, v65
  v_mfma_f32_16x16x32_bf16 v[12:15], v[48:51], v[40:43], 0
  s_waitcnt lgkmcnt(3)
  v_mul_f32 v66, s30, v66
  v_mfma_f32_16x16x32_bf16 v[12:15], v[52:55], v[44:47], v[12:15]
  v_mul_f32 v67, s30, v67
  v_max3_f32 v68, |v64|, |v65|, |v66|
  v_smfmac_f32_16x16x64_bf16 v[56:59], v[28:31], v[96:103], v0
  v_mov_b64 v[52:53], s[96:97]
  v_smfmac_f32_16x16x64_bf16 v[60:63], v[28:31], v[104:111], v0
  s_waitcnt lgkmcnt(1)
  v_add_f32_dpp v70, v14, v12 row_ror:8 row_mask:0xf bank_mask:0x3
  v_add_f32_dpp v70, v13, v15 row_ror:8 row_mask:0xf bank_mask:0xc
  v_smfmac_f32_16x16x64_bf16 v[56:59], v[32:35], v[112:119], v0
  v_mul_f32 v70, s30, v70
  v_max3_f32 v68, v68, |v67|, |v70|
  v_cmp_nle_f32 vcc, v68, s16
  v_smfmac_f32_16x16x64_bf16 v[60:63], v[32:35], v[120:127], v0
  s_cbranch_vccnz .tm_18
.tm_18b:
  v_exp_f32 v64, v64
  v_smfmac_f32_16x16x64_bf16 v[56:59], v[36:39], v[128:135], v0
  s_waitcnt vmcnt(4)
  v_cmp_gt_u32 vcc, s18, v11
  v_exp_f32 v65, v65
  v_smfmac_f32_16x16x64_bf16 v[60:63], v[36:39], v[136:143], v0
  s_waitcnt lgkmcnt(0)
  v_exp_f32 v66, v66
  v_cvt_pk_bf16_f32 v64, v64, v65
  v_smfmac_f32_16x16x64_bf16 v[56:59], v[24:27], v[144:151], v0
  s_cbranch_vccnz .fk_17
.fk_17b:
  buffer_load_dwordx4 v[16:19], v2, s[4:7], s14 offen sc1
  v_exp_f32 v67, v67
  v_exp_f32 v70, v70
  v_cvt_pk_bf16_f32 v65, v66, v67
  v_smfmac_f32_16x16x64_bf16 v[60:63], v[24:27], v[152:159], v0
  s_waitcnt vmcnt(4)
  v_mov_b32_dpp v66, v64 row_ror:8 row_mask:0xf bank_mask:0xf
  v_mov_b32_dpp v67, v65 row_ror:8 row_mask:0xf bank_mask:0xf
  v_mov_b32_dpp v69, v70 row_ror:8 row_mask:0xf bank_mask:0xf
  v_mov_b64 v[54:55], s[96:97]
  v_mfma_f32_16x16x32_bf16 v[40:43], v[72:75], v[64:67], 0
  v_cvt_pk_bf16_f32 v12, v70, v69
  v_mov_b32 v13, 0
  v_mfma_f32_16x16x32_bf16 v[48:51], v[52:55], v[64:67], 0
  s_waitcnt vmcnt(3)
  buffer_load_dwordx4 v[20:23], v2, s[4:7], s14 offen offset:1024 sc1
  v_add_f32 v56, v56, v58
  v_add_f32 v57, v57, v59
  v_mfma_f32_16x16x32_bf16 v[44:47], v[76:79], v[64:67], 0
  ds_read_b128 v[72:75], v2 offset:4096
  v_add_f32 v60, v60, v62
  v_add_f32 v61, v61, v63
  v_cvt_pk_bf16_f32 v56, v56, v57
  v_cvt_pk_bf16_f32 v57, v60, v61
  v_mfma_f32_16x16x16_bf16 v[48:51], v[52:53], v[12:13], v[48:51]
  ds_read_b128 v[76:79], v2 offset:5120
  v_mov_b32 v14, 0
  v_mov_b32 v15, v12
  v_mfma_f32_16x16x16_bf16 v[40:43], v[56:57], v[12:13], v[40:43]
  ds_write_b32 v4, v56 offset:4224
  v_lshlrev_b32 v11, 2, v8
  v_mfma_f32_16x16x16_bf16 v[44:47], v[56:57], v[14:15], v[44:47]
  ds_write_b32 v4, v57 offset:4288
  v_rcp_f32 v48, v48
  s_nop 1
  v_pk_mul_f32 v[40:41], v[40:41], v[48:49] op_sel_hi:[1,0]
  v_pk_mul_f32 v[42:43], v[42:43], v[48:49] op_sel_hi:[1,0]
  s_nop 1
  v_pk_mul_f32 v[44:45], v[44:45], v[48:49] op_sel_hi:[1,0]
  v_pk_mul_f32 v[46:47], v[46:47], v[48:49] op_sel_hi:[1,0]
  v_cvt_pk_bf16_f32 v40, v40, v41
  v_cvt_pk_bf16_f32 v41, v42, v43
  v_cvt_pk_bf16_f32 v42, v44, v45
  v_cvt_pk_bf16_f32 v43, v46, v47
  v_mfma_f32_32x32x2_f32 v[24:39], v13, v13, 0
  ds_write_b64 v10, v[40:41]
  ds_write_b64 v10, v[42:43] offset:8
  ds_read_b128 v[64:67], v2 offset:6144
  ds_read_b128 v[68:71], v2 offset:7168
  s_add_u32 s14, s56, s22
  s_add_u32 s31, s14, s23
  s_add_u32 s23, s14, s43
  s_add_u32 s14, s31, 4096
  v_mfma_f32_32x32x2_f32 v[40:55], v13, v13, 0
  s_waitcnt lgkmcnt(2)
  s_barrier
  ds_read_b128 v[56:59], v6
  ds_read_b128 v[60:63], v6 offset:1088
  v_mfma_f32_16x16x1_4b_f32 v[40:55], v13, v13, 0
  s_waitcnt lgkmcnt(1)
  v_smfmac_f32_16x16x64_bf16 v[24:27], v[56:59], v[72:79], v0
  s_add_u32 s94, s56, s48
  ds_read_b128 v[72:75], v2 offset:8192
  v_mov_b64 v[12:13], 0
  v_smfmac_f32_16x16x64_bf16 v[28:31], v[56:59], v[64:71], v0
  s_waitcnt lgkmcnt(1)
  ds_read_b128 v[76:79], v2 offset:9216
  v_mov_b64 v[14:15], 0
  v_smfmac_f32_16x16x64_bf16 v[24:27], v[60:63], v[208:215], v0
  s_add_u32 s90, s94, 9216
  ds_read_b128 v[64:67], v2 offset:10240
  v_and_b32 v10, 0x60, v8
  v_smfmac_f32_16x16x64_bf16 v[28:31], v[60:63], v[216:223], v0
  s_add_u32 s91, s94, 82944
  ds_read_b128 v[68:71], v2 offset:11264
  v_add_lshl_u32 v10, v10, v8, 1
  v_smfmac_f32_16x16x64_bf16 v[32:35], v[60:63], v[224:231], v0
  s_add_u32 s92, s94, 156672
  v_add_f32 v24, v24, v26
  v_add_f32 v25, v25, v27
  v_smfmac_f32_16x16x64_bf16 v[36:39], v[60:63], v[232:239], v0
  s_waitcnt lgkmcnt(2)
  v_add_f32 v28, v28, v30
  v_add_f32 v29, v29, v31
  v_smfmac_f32_16x16x64_bf16 v[32:35], v[56:59], v[72:79], v0
  s_waitcnt lgkmcnt(0)
  ds_read_b128 v[72:75], v2 offset:0
  v_cvt_pk_bf16_f32 v24, v24, v28
  v_cvt_pk_bf16_f32 v25, v25, v29
  v_and_or_b32 v24, v24, -2, s63
  v_smfmac_f32_16x16x64_bf16 v[36:39], v[56:59], v[64:71], v0
  buffer_store_dwordx2 v[24:25], v11, s[4:7], s31 offen offset:0
  v_smfmac_f32_16x16x64_bf16 v[48:51], v[56:59], v[176:183], v0
  s_add_u32 s93, s94, 230400
  ds_read_b128 v[76:79], v2 offset:1024
  v_add_f32 v32, v32, v34
  v_add_f32 v33, v33, v35
  v_smfmac_f32_16x16x64_bf16 v[52:55], v[56:59], v[184:191], v0
  ds_read_b128 v[64:67], v2 offset:2048
  v_add_f32 v36, v36, v38
  v_add_f32 v37, v37, v39
  v_smfmac_f32_16x16x64_bf16 v[48:51], v[60:63], v[240:247], v0
  ds_read_b128 v[68:71], v2 offset:3072
  v_cvt_pk_bf16_f32 v32, v32, v36
  v_cvt_pk_bf16_f32 v33, v33, v37
  v_and_or_b32 v32, v32, -2, s63
  v_smfmac_f32_16x16x64_bf16 v[52:55], v[60:63], v[248:255], v0
  buffer_store_dwordx2 v[32:33], v11, s[4:7], s31 offen offset:2048
  v_smfmac_f32_16x16x64_bf16 v[44:47], v[56:59], v[192:199], v0
  v_add_f32 v48, v48, v50
  v_add_f32 v49, v49, v51
  v_smfmac_f32_16x16x64_bf16 v[40:43], v[56:59], v[200:207], v0
  s_waitcnt lgkmcnt(2)
  v_add_f32 v52, v52, v54
  v_add_f32 v53, v53, v55
  v_smfmac_f32_16x16x64_bf16 v[44:47], v[60:63], v[72:79], v0
  s_waitcnt lgkmcnt(0)
  v_cvt_pk_bf16_f32 v48, v48, v52
  v_cvt_pk_bf16_f32 v49, v49, v53
  v_and_or_b32 v48, v48, -2, s63
  v_smfmac_f32_16x16x64_bf16 v[40:43], v[60:63], v[64:71], v0
  buffer_store_dwordx2 v[48:49], v11, s[4:7], s14 offen offset:0
  v_smfmac_f32_16x16x64_bf16 v[12:15], v[56:59], v[160:167], v0
  v_add_f32 v44, v44, v46
  v_add_f32 v45, v45, v47
  v_smfmac_f32_16x16x64_bf16 v[12:15], v[60:63], v[168:175], v0
  v_add_f32 v40, v40, v42
  v_add_f32 v41, v41, v43
  v_cvt_pk_bf16_f32 v44, v44, v40
  v_cvt_pk_bf16_f32 v45, v45, v41
  v_and_or_b32 v44, v44, -2, s63
  buffer_store_dwordx2 v[44:45], v11, s[4:7], s14 offen offset:2048
  v_pk_add_f32 v[12:13], v[12:13], v[14:15]
  v_cvt_pk_bf16_f32 v12, v12, v13
  v_and_or_b32 v12, v12, -2, s63
  buffer_store_dword v12, v10, s[4:7], s23 offen
  s_mov_b32 s60, s62
  s_add_u32 s52, s52, 1
  s_cmp_eq_u32 s52, 64
  s_cbranch_scc1 .cexit_12
  s_add_u32 s53, s53, 16384
  s_add_u32 s62, s62, 4096
  s_cmp_eq_u32 s61, -1
  s_cbranch_scc1 .nr_19
  s_cmp_eq_u32 s3, 0
  s_cbranch_scc1 .nr_19e
  v_mov_b32 v0, v0
  s_nop 2
  v_mov_b32 v0, v0
  s_nop 2
  v_mov_b32 v0, v0
  s_nop 2
  v_mov_b32 v0, v0
  s_nop 2
.nr_19e:
  v_mov_b32 v0, v0
  s_nop 2
  v_mov_b32 v0, v0
  s_nop 2
  v_mov_b32 v0, v0
  s_nop 2
  v_mov_b32 v0, v0
  s_nop 2
  buffer_load_dwordx4 v[24:27], v9, s[4:7], s90 offen sc1
  buffer_load_dwordx4 v[28:31], v9, s[4:7], s91 offen sc1
  buffer_load_dwordx4 v[32:35], v9, s[4:7], s92 offen sc1
  buffer_load_dwordx4 v[36:39], v9, s[4:7], s93 offen sc1
  v_mov_b32 v44, 0x3f80
  v_mov_b32 v45, 0x3f800000
  v_cndmask_b32 v44, v44, v45, s[80:81]
  v_cndmask_b32 v40, 0, v44, s[82:83]
  v_cndmask_b32 v41, 0, v44, s[84:85]
  v_cndmask_b32 v42, 0, v44, s[86:87]
  v_cndmask_b32 v43, 0, v44, s[88:89]
  ds_read_b128 v[48:51], v2 offset:12288
  ds_read_b128 v[52:55], v2 offset:13312
  ds_read_b128 v[56:59], v2 offset:18432
  ds_read_b128 v[60:63], v2 offset:19456
  v_mov_b32 v0, v0
  s_nop 2
  v_mov_b32 v0, v0
  s_nop 2
  v_mov_b32 v0, v0
  s_nop 2
  v_mov_b32 v0, v0
  s_nop 2
  v_mov_b32 v0, v0
  s_nop 2
  buffer_load_dwordx4 v[64:67], v9, s[4:7], s90 offen sc1
  buffer_load_dwordx4 v[68:71], v9, s[4:7], s91 offen sc1
  buffer_load_dwordx4 v[72:75], v9, s[4:7], s92 offen sc1
  buffer_load_dwordx4 v[76:79], v9, s[4:7], s93 offen sc1
.ha_21:
  s_waitcnt vmcnt(7)
  v_mfma_f32_16x16x32_bf16 v[44:47], v[40:43], v[24:27], 0
  v_bitop3_b32 v12, v24, v26, s63 bitop3:0x7e
  s_waitcnt vmcnt(6)
  v_mfma_f32_16x16x32_bf16 v[44:47], v[40:43], v[28:31], v[44:47]
  v_bitop3_b32 v13, v28, v30, s63 bitop3:0x7e
  v_or_b32 v12, v12, v13
  s_waitcnt vmcnt(5)
  v_mfma_f32_16x16x32_bf16 v[44:47], v[40:43], v[32:35], v[44:47]
  v_bitop3_b32 v13, v32, v34, s63 bitop3:0x7e
  s_waitcnt vmcnt(4)
  v_mfma_f32_16x16x32_bf16 v[44:47], v[40:43], v[36:39], v[44:47]
  v_bitop3_b32 v14, v36, v38, s63 bitop3:0x7e
  v_or3_b32 v12, v12, v13, v14
  v_and_b32 v12, 1, v12
  v_cmp_ne_u32 vcc, 0, v12
  s_cbranch_vccnz .ha_21r
.pb_20:
  s_mov_b64 exec, s[28:29]
  s_nop 1
  v_add_f32_dpp v12, v44, v44 row_ror:8 row_mask:0xf bank_mask:0x3
  v_add_f32_dpp v13, v45, v45 row_ror:8 row_mask:0xf bank_mask:0x3
  v_add_f32_dpp v12, v46, v46 row_ror:8 row_mask:0xf bank_mask:0xc
  v_add_f32_dpp v13, v47, v47 row_ror:8 row_mask:0xf bank_mask:0xc
  v_cvt_pk_bf16_f32 v44, v12, v13
  buffer_store_dword v44, v7, s[4:7], s57 offen
  s_mov_b64 exec, -1
  s_branch .nr_19j
.nr_19:
  ds_read_b128 v[48:51], v2 offset:12288
  ds_read_b128 v[52:55], v2 offset:13312
  ds_read_b128 v[56:59], v2 offset:18432
  ds_read_b128 v[60:63], v2 offset:19456
  v_mov_b32 v0, v0
  s_nop 2
  v_mov_b32 v0, v0
  s_nop 2
  v_mov_b32 v0, v0
  s_nop 2
  v_mov_b32 v0, v0
  s_nop 2
  v_mov_b32 v0, v0
  s_nop 2
  v_mov_b32 v0, v0
  s_nop 2
  v_mov_b32 v0, v0
  s_nop 2
  v_mov_b32 v0, v0
  s_nop 2
  v_mov_b32 v0, v0
  s_nop 2
  v_mov_b32 v0, v0
  s_nop 2
  v_mov_b32 v0, v0
  s_nop 2
  v_mov_b32 v0, v0
  s_nop 2
  v_mov_b32 v0, v0
  s_nop 2
  v_mov_b32 v0, v0
  s_nop 2
  v_mov_b32 v0, v0
  s_nop 2
  v_mov_b32 v0, v0
  s_nop 2
  v_mov_b32 v0, v0
  s_nop 2
  v_mov_b32 v0, v0
  s_nop 2
  v_mov_b32 v0, v0
  s_nop 2
  v_mov_b32 v0, v0
  s_nop 2
  v_mov_b32 v0, v0
  s_nop 2
  v_mov_b32 v0, v0
  s_nop 2
  v_mov_b32 v0, v0
  s_nop 2
  v_mov_b32 v0, v0
  s_nop 2
.nr_19j:
  s_mov_b32 s14, s56
  s_mov_b32 s56, s57
  s_mov_b32 s57, s58
  s_mov_b32 s58, s14
  s_cmp_eq_u32 s56, s44
  s_cselect_b32 s14, 1, 0
  s_xor_b32 s63, s63, s14
  s_branch .cloop_11
.rd_16:
  s_sub_u32 s10, s10, 64
  s_cbranch_scc0 .credo_13
  s_mov_b32 s10, 0
  s_branch .rd_16b
.br_15:
  s_sub_u32 s10, s10, 1
  s_cbranch_scc1 .br_15c
  s_add_u32 s51, s51, 1
  s_cmp_lt_u32 s51, 2
  s_waitcnt vmcnt(0) lgkmcnt(0)
  s_cbranch_scc1 .br_15d
  s_add_u32 m0, s49, 151552
  s_nop 0
  buffer_load_dwordx4 v2, s[4:7], s45 offen sc1 lds
  s_add_u32 m0, s95, 147456
  s_nop 0
  buffer_load_dword v10, s[4:7], s23 offen sc1 lds
  s_add_u32 m0, s49, 147456
.br_15d:
  s_nop 0
  buffer_load_dwordx4 v2, s[4:7], s14 offen sc1 lds
  ds_read_b128 v[24:27], v1 offset:0
  ds_read_b128 v[28:31], v1 offset:1024
  ds_read_b128 v[32:35], v1 offset:2048
  ds_read_b128 v[36:39], v1 offset:3072
  v_mov_b64 v[40:41], 0
  v_mov_b64 v[42:43], 0
  v_mov_b64 v[44:45], 0
  v_mov_b64 v[46:47], 0
  s_waitcnt lgkmcnt(1)
  v_max3_u32 v11, v24, v28, v32
  s_waitcnt lgkmcnt(0)
  v_max_u32 v11, v11, v36
  v_cmp_eq_u32 vcc, -1, v11
  s_cbranch_vccnz .br_15
  s_waitcnt vmcnt(1)
  v_smfmac_f32_16x16x64_bf16 v[40:43], v[24:27], v[48:55], v0
  v_smfmac_f32_16x16x64_bf16 v[44:47], v[24:27], v[72:79], v0
  ds_read_b128 v[24:27], v1 offset:4096
  v_smfmac_f32_16x16x64_bf16 v[40:43], v[28:31], v[64:71], v0
  v_smfmac_f32_16x16x64_bf16 v[44:47], v[28:31], v[56:63], v0
  ds_read_b128 v[28:31], v1 offset:5120
  v_smfmac_f32_16x16x64_bf16 v[40:43], v[32:35], a[0:7], v0
  s_branch .br_15b
.br_15c:
  s_mov_b32 s10, 0
  s_branch .br_15b
.fk_17:
  buffer_load_ushort v11, v8, s[4:7], s47 offen sc1
  s_waitcnt vmcnt(0)
  v_cmp_gt_u32 vcc, s18, v11
  s_cbranch_vccz .fk_17b
  s_sub_u32 s10, s10, 1
  s_cbranch_scc0 .fk_17
  s_mov_b32 s10, 0
  s_branch .fk_17b
.tm_18:
  v_max3_f32 v68, v64, v65, v66
  v_max3_f32 v68, v68, v67, v70
  s_nop 1
  v_max_f32_dpp v68, v68, v68 row_ror:8 row_mask:0xf bank_mask:0xf
  v_mov_b32 v69, v68
  s_nop 1
  v_permlane16_swap_b32 v69, v68
  v_max_f32 v68, v68, v69
  v_mov_b32 v69, v68
  s_nop 1
  v_permlane32_swap_b32 v69, v68
  v_max_f32 v68, v68, v69
  v_sub_f32 v64, v64, v68
  v_sub_f32 v65, v65, v68
  v_sub_f32 v66, v66, v68
  v_sub_f32 v67, v67, v68
  v_sub_f32 v70, v70, v68
  s_branch .tm_18b
.ha_21r:
  buffer_load_dwordx4 v[24:27], v9, s[4:7], s90 offen sc1
  buffer_load_dwordx4 v[28:31], v9, s[4:7], s91 offen sc1
  buffer_load_dwordx4 v[32:35], v9, s[4:7], s92 offen sc1
  buffer_load_dwordx4 v[36:39], v9, s[4:7], s93 offen sc1
  s_sub_u32 s10, s10, 1
  s_cselect_b32 s10, 0, s10
  s_waitcnt vmcnt(7)
  v_mfma_f32_16x16x32_bf16 v[44:47], v[40:43], v[64:67], 0
  v_bitop3_b32 v12, v64, v66, s63 bitop3:0x7e
  s_waitcnt vmcnt(6)
  v_mfma_f32_16x16x32_bf16 v[44:47], v[40:43], v[68:71], v[44:47]
  v_bitop3_b32 v13, v68, v70, s63 bitop3:0x7e
  v_or_b32 v12, v12, v13
  s_waitcnt vmcnt(5)
  v_mfma_f32_16x16x32_bf16 v[44:47], v[40:43], v[72:75], v[44:47]
  v_bitop3_b32 v13, v72, v74, s63 bitop3:0x7e
  s_waitcnt vmcnt(4)
  v_mfma_f32_16x16x32_bf16 v[44:47], v[40:43], v[76:79], v[44:47]
  v_bitop3_b32 v14, v76, v78, s63 bitop3:0x7e
  v_or3_b32 v12, v12, v13, v14
  v_and_b32 v12, 1, v12
  v_cmp_ne_u32 vcc, 0, v12
  s_cbranch_vccz .pb_20
  buffer_load_dwordx4 v[64:67], v9, s[4:7], s90 offen sc1
  buffer_load_dwordx4 v[68:71], v9, s[4:7], s91 offen sc1
  buffer_load_dwordx4 v[72:75], v9, s[4:7], s92 offen sc1
  buffer_load_dwordx4 v[76:79], v9, s[4:7], s93 offen sc1
  s_sub_u32 s10, s10, 1
  s_cbranch_scc0 .ha_21
  s_mov_b32 s10, 0
  s_branch .pb_20
.cexit_12:
  s_waitcnt lgkmcnt(0)
  s_barrier
  v_add_u32 v11, s59, v2
  ds_read_b128 v[12:15], v11
  s_waitcnt lgkmcnt(0)
  buffer_store_dwordx4 v[12:15], v2, s[4:7], s60 offen sc1
  s_endpgm
conv:
  s_load_dwordx8 s[16:23], s[0:1], 8
  s_load_dwordx2 s[24:25], s[0:1], 40
  s_load_dwordx2 s[26:27], s[0:1], 0
  s_lshl_b32 s11, s3, 6
  v_add_u32 v90, s11, v0
  s_waitcnt lgkmcnt(0)
  s_mov_b32 s84, s16
  s_mov_b32 s85, s17
  s_mov_b32 s86, 0x240000
  s_mov_b32 s87, 0x20000
  s_mov_b32 s88, s18
  s_mov_b32 s89, s19
  s_mov_b32 s90, 0x240000
  s_mov_b32 s91, 0x20000
  s_lshl_b32 s13, s80, 2
  s_add_u32 s13, s13, s3
  s_lshl_b32 s14, s13, 12
  s_add_u32 s22, s22, s14
  s_addc_u32 s23, s23, 0
  s_mov_b32 s92, s22
  s_mov_b32 s93, s23
  s_mov_b32 s94, 0x1000
  s_mov_b32 s95, 0x20000
  s_lshr_b32 s14, s13, 1
  s_lshl_b32 s14, s14, 2
  s_add_u32 s24, s24, s14
  s_addc_u32 s25, s25, 0
  s_load_dword s60, s[24:25], 0
  s_lshl_b32 s14, s80, 8
  v_add_u32 v4, s14, v90
  v_mul_u32_u24 v2, 58255, v4
  v_lshrrev_b32 v2, 23, v2
  v_mul_u32_u24 v3, 144, v2
  v_sub_u32 v3, v4, v3
  v_lshlrev_b32 v4, 5, v3
  v_mul_u32_u24 v2, 9216, v2
  v_lshl_add_u32 v2, v3, 3, v2
  v_subrev_u32 v1, 3456, v2
  v_add_u32 v3, 4608, v2
  s_mov_b32 s52, s20
  s_mov_b32 s53, s21
  s_mov_b32 s54, 0x1200
  s_mov_b32 s55, 0x20000
  buffer_load_dwordx4 v[76:79], v4, s[52:55], 0 offen
  buffer_load_dwordx4 v[80:83], v4, s[52:55], 0 offen offset:16
  buffer_load_dwordx2 v[10:11], v1, s[84:87], 0 offen offset:0
  buffer_load_dwordx2 v[12:13], v1, s[84:87], 0 offen offset:1152
  buffer_load_dwordx2 v[14:15], v1, s[84:87], 0 offen offset:2304
  buffer_load_dwordx2 v[16:17], v2, s[84:87], 0 offen offset:0
  buffer_load_dwordx2 v[18:19], v2, s[84:87], 0 offen offset:1152
  buffer_load_dwordx2 v[20:21], v2, s[84:87], 0 offen offset:2304
  buffer_load_dwordx2 v[22:23], v2, s[84:87], 0 offen offset:3456
  buffer_load_dwordx2 v[24:25], v3, s[84:87], 0 offen offset:0
  buffer_load_dwordx2 v[26:27], v3, s[84:87], 0 offen offset:1152
  buffer_load_dwordx2 v[28:29], v3, s[84:87], 0 offen offset:2304
  buffer_load_dwordx2 v[30:31], v3, s[84:87], 0 offen offset:3456
  buffer_load_dwordx2 v[32:33], v2, s[88:91], 0 offen offset:0
  buffer_load_dwordx2 v[34:35], v2, s[88:91], 0 offen offset:1152
  buffer_load_dwordx2 v[36:37], v2, s[88:91], 0 offen offset:2304
  buffer_load_dwordx2 v[38:39], v2, s[88:91], 0 offen offset:3456
  buffer_load_dwordx2 v[40:41], v3, s[88:91], 0 offen offset:0
  buffer_load_dwordx2 v[42:43], v3, s[88:91], 0 offen offset:1152
  buffer_load_dwordx2 v[44:45], v3, s[88:91], 0 offen offset:2304
  buffer_load_dwordx2 v[46:47], v3, s[88:91], 0 offen offset:3456
  v_lshlrev_b32 v5, 4, v0
  s_mul_i32 s11, s3, 17408
  s_add_u32 s11, s11, 32768
  v_lshlrev_b32 v94, 6, v0
  buffer_load_dword v95, v94, s[92:95], 0 offen
  s_lshl_b32 s12, s3, 13
  s_waitcnt lgkmcnt(0)
  s_lshl_b32 s61, s60, 16
  s_and_b32 s60, s60, 0xffff0000
  s_bitcmp1_b32 s13, 0
  s_cselect_b32 s60, s60, s61
  v_lshlrev_b32 v7, 6, v0
  v_add_u32 v7, s12, v7
  v_add_u32 v6, s12, v5
  s_waitcnt vmcnt(21)
  v_lshlrev_b32 v84, 16, v76
  v_and_b32 v85, 0xffff0000, v76
  v_lshlrev_b32 v86, 16, v77
  v_and_b32 v87, 0xffff0000, v77
  s_waitcnt vmcnt(19)
  v_lshlrev_b32 v52, 16, v10
  s_waitcnt vmcnt(18)
  v_lshlrev_b32 v53, 16, v12
  s_waitcnt vmcnt(17)
  v_lshlrev_b32 v54, 16, v14
  s_waitcnt vmcnt(16)
  v_lshlrev_b32 v55, 16, v16
  s_waitcnt vmcnt(15)
  v_lshlrev_b32 v56, 16, v18
  s_waitcnt vmcnt(14)
  v_lshlrev_b32 v57, 16, v20
  s_waitcnt vmcnt(13)
  v_lshlrev_b32 v58, 16, v22
  s_waitcnt vmcnt(12)
  v_lshlrev_b32 v59, 16, v24
  s_waitcnt vmcnt(11)
  v_lshlrev_b32 v60, 16, v26
  s_waitcnt vmcnt(10)
  v_lshlrev_b32 v61, 16, v28
  s_waitcnt vmcnt(9)
  v_lshlrev_b32 v62, 16, v30
  v_mul_f32 v64, v87, v52
  v_fmac_f32 v64, v86, v53
  v_fmac_f32 v64, v85, v54
  v_fmac_f32 v64, v84, v55
  v_mul_f32 v65, v87, v53
  v_fmac_f32 v65, v86, v54
  v_fmac_f32 v65, v85, v55
  v_fmac_f32 v65, v84, v56
  v_mul_f32 v66, v87, v54
  v_fmac_f32 v66, v86, v55
  v_fmac_f32 v66, v85, v56
  v_fmac_f32 v66, v84, v57
  v_mul_f32 v67, v87, v55
  v_fmac_f32 v67, v86, v56
  v_fmac_f32 v67, v85, v57
  v_fmac_f32 v67, v84, v58
  v_mul_f32 v68, v87, v56
  v_fmac_f32 v68, v86, v57
  v_fmac_f32 v68, v85, v58
  v_fmac_f32 v68, v84, v59
  v_mul_f32 v69, v87, v57
  v_fmac_f32 v69, v86, v58
  v_fmac_f32 v69, v85, v59
  v_fmac_f32 v69, v84, v60
  v_mul_f32 v70, v87, v58
  v_fmac_f32 v70, v86, v59
  v_fmac_f32 v70, v85, v60
  v_fmac_f32 v70, v84, v61
  v_mul_f32 v71, v87, v59
  v_fmac_f32 v71, v86, v60
  v_fmac_f32 v71, v85, v61
  v_fmac_f32 v71, v84, v62
  s_waitcnt vmcnt(8)
  v_lshlrev_b32 v52, 16, v32
  s_waitcnt vmcnt(7)
  v_lshlrev_b32 v53, 16, v34
  s_waitcnt vmcnt(6)
  v_lshlrev_b32 v54, 16, v36
  s_waitcnt vmcnt(5)
  v_lshlrev_b32 v55, 16, v38
  s_waitcnt vmcnt(4)
  v_lshlrev_b32 v56, 16, v40
  s_waitcnt vmcnt(3)
  v_lshlrev_b32 v57, 16, v42
  s_waitcnt vmcnt(2)
  v_lshlrev_b32 v58, 16, v44
  s_waitcnt vmcnt(1)
  v_lshlrev_b32 v59, 16, v46
  v_pk_mul_f32 v[64:65], v[64:65], v[52:53]
  v_pk_mul_f32 v[66:67], v[66:67], v[54:55]
  v_pk_mul_f32 v[68:69], v[68:69], v[56:57]
  v_pk_mul_f32 v[70:71], v[70:71], v[58:59]
  v_cvt_pk_bf16_f32 v72, v71, v70
  v_cvt_pk_bf16_f32 v73, v69, v68
  v_cvt_pk_bf16_f32 v74, v67, v66
  v_cvt_pk_bf16_f32 v75, v65, v64
  ds_write_b128 v7, v[72:75] offset:0
  v_lshlrev_b32 v84, 16, v78
  v_and_b32 v85, 0xffff0000, v78
  v_lshlrev_b32 v86, 16, v79
  v_and_b32 v87, 0xffff0000, v79
  v_and_b32 v52, 0xffff0000, v10
  v_and_b32 v53, 0xffff0000, v12
  v_and_b32 v54, 0xffff0000, v14
  v_and_b32 v55, 0xffff0000, v16
  v_and_b32 v56, 0xffff0000, v18
  v_and_b32 v57, 0xffff0000, v20
  v_and_b32 v58, 0xffff0000, v22
  v_and_b32 v59, 0xffff0000, v24
  v_and_b32 v60, 0xffff0000, v26
  v_and_b32 v61, 0xffff0000, v28
  v_and_b32 v62, 0xffff0000, v30
  v_mul_f32 v64, v87, v52
  v_fmac_f32 v64, v86, v53
  v_fmac_f32 v64, v85, v54
  v_fmac_f32 v64, v84, v55
  v_mul_f32 v65, v87, v53
  v_fmac_f32 v65, v86, v54
  v_fmac_f32 v65, v85, v55
  v_fmac_f32 v65, v84, v56
  v_mul_f32 v66, v87, v54
  v_fmac_f32 v66, v86, v55
  v_fmac_f32 v66, v85, v56
  v_fmac_f32 v66, v84, v57
  v_mul_f32 v67, v87, v55
  v_fmac_f32 v67, v86, v56
  v_fmac_f32 v67, v85, v57
  v_fmac_f32 v67, v84, v58
  v_mul_f32 v68, v87, v56
  v_fmac_f32 v68, v86, v57
  v_fmac_f32 v68, v85, v58
  v_fmac_f32 v68, v84, v59
  v_mul_f32 v69, v87, v57
  v_fmac_f32 v69, v86, v58
  v_fmac_f32 v69, v85, v59
  v_fmac_f32 v69, v84, v60
  v_mul_f32 v70, v87, v58
  v_fmac_f32 v70, v86, v59
  v_fmac_f32 v70, v85, v60
  v_fmac_f32 v70, v84, v61
  v_mul_f32 v71, v87, v59
  v_fmac_f32 v71, v86, v60
  v_fmac_f32 v71, v85, v61
  v_fmac_f32 v71, v84, v62
  v_and_b32 v52, 0xffff0000, v32
  v_and_b32 v53, 0xffff0000, v34
  v_and_b32 v54, 0xffff0000, v36
  v_and_b32 v55, 0xffff0000, v38
  v_and_b32 v56, 0xffff0000, v40
  v_and_b32 v57, 0xffff0000, v42
  v_and_b32 v58, 0xffff0000, v44
  v_and_b32 v59, 0xffff0000, v46
  v_pk_mul_f32 v[64:65], v[64:65], v[52:53]
  v_pk_mul_f32 v[66:67], v[66:67], v[54:55]
  v_pk_mul_f32 v[68:69], v[68:69], v[56:57]
  v_pk_mul_f32 v[70:71], v[70:71], v[58:59]
  v_cvt_pk_bf16_f32 v72, v71, v70
  v_cvt_pk_bf16_f32 v73, v69, v68
  v_cvt_pk_bf16_f32 v74, v67, v66
  v_cvt_pk_bf16_f32 v75, v65, v64
  ds_write_b128 v7, v[72:75] offset:16
  v_lshlrev_b32 v84, 16, v80
  v_and_b32 v85, 0xffff0000, v80
  v_lshlrev_b32 v86, 16, v81
  v_and_b32 v87, 0xffff0000, v81
  v_lshlrev_b32 v52, 16, v11
  v_lshlrev_b32 v53, 16, v13
  v_lshlrev_b32 v54, 16, v15
  v_lshlrev_b32 v55, 16, v17
  v_lshlrev_b32 v56, 16, v19
  v_lshlrev_b32 v57, 16, v21
  v_lshlrev_b32 v58, 16, v23
  v_lshlrev_b32 v59, 16, v25
  v_lshlrev_b32 v60, 16, v27
  v_lshlrev_b32 v61, 16, v29
  v_lshlrev_b32 v62, 16, v31
  v_mul_f32 v64, v87, v52
  v_fmac_f32 v64, v86, v53
  v_fmac_f32 v64, v85, v54
  v_fmac_f32 v64, v84, v55
  v_mul_f32 v65, v87, v53
  v_fmac_f32 v65, v86, v54
  v_fmac_f32 v65, v85, v55
  v_fmac_f32 v65, v84, v56
  v_mul_f32 v66, v87, v54
  v_fmac_f32 v66, v86, v55
  v_fmac_f32 v66, v85, v56
  v_fmac_f32 v66, v84, v57
  v_mul_f32 v67, v87, v55
  v_fmac_f32 v67, v86, v56
  v_fmac_f32 v67, v85, v57
  v_fmac_f32 v67, v84, v58
  v_mul_f32 v68, v87, v56
  v_fmac_f32 v68, v86, v57
  v_fmac_f32 v68, v85, v58
  v_fmac_f32 v68, v84, v59
  v_mul_f32 v69, v87, v57
  v_fmac_f32 v69, v86, v58
  v_fmac_f32 v69, v85, v59
  v_fmac_f32 v69, v84, v60
  v_mul_f32 v70, v87, v58
  v_fmac_f32 v70, v86, v59
  v_fmac_f32 v70, v85, v60
  v_fmac_f32 v70, v84, v61
  v_mul_f32 v71, v87, v59
  v_fmac_f32 v71, v86, v60
  v_fmac_f32 v71, v85, v61
  v_fmac_f32 v71, v84, v62
  v_lshlrev_b32 v52, 16, v33
  v_lshlrev_b32 v53, 16, v35
  v_lshlrev_b32 v54, 16, v37
  v_lshlrev_b32 v55, 16, v39
  v_lshlrev_b32 v56, 16, v41
  v_lshlrev_b32 v57, 16, v43
  v_lshlrev_b32 v58, 16, v45
  v_lshlrev_b32 v59, 16, v47
  v_pk_mul_f32 v[64:65], v[64:65], v[52:53]
  v_pk_mul_f32 v[66:67], v[66:67], v[54:55]
  v_pk_mul_f32 v[68:69], v[68:69], v[56:57]
  v_pk_mul_f32 v[70:71], v[70:71], v[58:59]
  v_cvt_pk_bf16_f32 v72, v71, v70
  v_cvt_pk_bf16_f32 v73, v69, v68
  v_cvt_pk_bf16_f32 v74, v67, v66
  v_cvt_pk_bf16_f32 v75, v65, v64
  ds_write_b128 v7, v[72:75] offset:32
  v_lshlrev_b32 v84, 16, v82
  v_and_b32 v85, 0xffff0000, v82
  v_lshlrev_b32 v86, 16, v83
  v_and_b32 v87, 0xffff0000, v83
  v_and_b32 v52, 0xffff0000, v11
  v_and_b32 v53, 0xffff0000, v13
  v_and_b32 v54, 0xffff0000, v15
  v_and_b32 v55, 0xffff0000, v17
  v_and_b32 v56, 0xffff0000, v19
  v_and_b32 v57, 0xffff0000, v21
  v_and_b32 v58, 0xffff0000, v23
  v_and_b32 v59, 0xffff0000, v25
  v_and_b32 v60, 0xffff0000, v27
  v_and_b32 v61, 0xffff0000, v29
  v_and_b32 v62, 0xffff0000, v31
  v_mul_f32 v64, v87, v52
  v_fmac_f32 v64, v86, v53
  v_fmac_f32 v64, v85, v54
  v_fmac_f32 v64, v84, v55
  v_mul_f32 v65, v87, v53
  v_fmac_f32 v65, v86, v54
  v_fmac_f32 v65, v85, v55
  v_fmac_f32 v65, v84, v56
  v_mul_f32 v66, v87, v54
  v_fmac_f32 v66, v86, v55
  v_fmac_f32 v66, v85, v56
  v_fmac_f32 v66, v84, v57
  v_mul_f32 v67, v87, v55
  v_fmac_f32 v67, v86, v56
  v_fmac_f32 v67, v85, v57
  v_fmac_f32 v67, v84, v58
  v_mul_f32 v68, v87, v56
  v_fmac_f32 v68, v86, v57
  v_fmac_f32 v68, v85, v58
  v_fmac_f32 v68, v84, v59
  v_mul_f32 v69, v87, v57
  v_fmac_f32 v69, v86, v58
  v_fmac_f32 v69, v85, v59
  v_fmac_f32 v69, v84, v60
  v_mul_f32 v70, v87, v58
  v_fmac_f32 v70, v86, v59
  v_fmac_f32 v70, v85, v60
  v_fmac_f32 v70, v84, v61
  v_mul_f32 v71, v87, v59
  v_fmac_f32 v71, v86, v60
  v_fmac_f32 v71, v85, v61
  v_fmac_f32 v71, v84, v62
  v_and_b32 v52, 0xffff0000, v33
  v_and_b32 v53, 0xffff0000, v35
  v_and_b32 v54, 0xffff0000, v37
  v_and_b32 v55, 0xffff0000, v39
  v_and_b32 v56, 0xffff0000, v41
  v_and_b32 v57, 0xffff0000, v43
  v_and_b32 v58, 0xffff0000, v45
  v_and_b32 v59, 0xffff0000, v47
  v_pk_mul_f32 v[64:65], v[64:65], v[52:53]
  v_pk_mul_f32 v[66:67], v[66:67], v[54:55]
  v_pk_mul_f32 v[68:69], v[68:69], v[56:57]
  v_pk_mul_f32 v[70:71], v[70:71], v[58:59]
  v_cvt_pk_bf16_f32 v72, v71, v70
  v_cvt_pk_bf16_f32 v73, v69, v68
  v_cvt_pk_bf16_f32 v74, v67, v66
  v_cvt_pk_bf16_f32 v75, v65, v64
  ds_write_b128 v7, v[72:75] offset:48
  ds_read_b128 v[16:19], v6 offset:0
  ds_read_b128 v[20:23], v6 offset:1024
  ds_read_b128 v[24:27], v6 offset:2048
  ds_read_b128 v[28:31], v6 offset:3072
  s_lshl_b32 s14, s80, 2
  s_add_u32 s14, s14, s3
  s_lshl_b32 s14, s14, 6
  v_lshrrev_b32 v4, 2, v0
  v_add_u32 v4, s14, v4
  v_and_b32 v3, 3, v0
  v_lshlrev_b32 v3, 4, v3
  s_mov_b32 s14, 0x1a00000
  v_mul_u32_u24 v1, 58255, v4
  v_lshrrev_b32 v1, 23, v1
  v_mul_u32_u24 v2, 144, v1
  v_sub_u32 v2, v4, v2
  v_lshl_add_u32 v1, v1, 6, v3
  v_lshl_add_u32 v1, v2, 14, v1
  v_add_u32 v4, 16, v4
  s_waitcnt lgkmcnt(3)
  buffer_store_dwordx4 v[16:19], v1, s[4:7], s14 offen sc1
  v_mul_u32_u24 v1, 58255, v4
  v_lshrrev_b32 v1, 23, v1
  v_mul_u32_u24 v2, 144, v1
  v_sub_u32 v2, v4, v2
  v_lshl_add_u32 v1, v1, 6, v3
  v_lshl_add_u32 v1, v2, 14, v1
  v_add_u32 v4, 16, v4
  s_waitcnt lgkmcnt(2)
  buffer_store_dwordx4 v[20:23], v1, s[4:7], s14 offen sc1
  v_mul_u32_u24 v1, 58255, v4
  v_lshrrev_b32 v1, 23, v1
  v_mul_u32_u24 v2, 144, v1
  v_sub_u32 v2, v4, v2
  v_lshl_add_u32 v1, v1, 6, v3
  v_lshl_add_u32 v1, v2, 14, v1
  v_add_u32 v4, 16, v4
  s_waitcnt lgkmcnt(1)
  buffer_store_dwordx4 v[24:27], v1, s[4:7], s14 offen sc1
  v_mul_u32_u24 v1, 58255, v4
  v_lshrrev_b32 v1, 23, v1
  v_mul_u32_u24 v2, 144, v1
  v_sub_u32 v2, v4, v2
  v_lshl_add_u32 v1, v1, 6, v3
  v_lshl_add_u32 v1, v2, 14, v1
  v_add_u32 v4, 16, v4
  s_waitcnt lgkmcnt(0)
  buffer_store_dwordx4 v[28:31], v1, s[4:7], s14 offen sc1
  s_cmp_lg_u32 s3, 0
  s_cbranch_scc1 .iw_22
  s_load_dwordx2 s[100:101], s[0:1], 112
  v_and_b32 v12, 7, v0
  v_lshlrev_b32 v12, 5, v12
  s_waitcnt lgkmcnt(0)
.cw_23:
  global_load_dword v13, v12, s[100:101] offset:4 sc1
  s_waitcnt vmcnt(0)
  v_cmp_gt_u32 vcc, 32, v13
  s_cbranch_vccz .cd_24
  s_sleep 2
  s_sub_u32 s10, s10, 1
  s_cbranch_scc0 .cw_23
  s_mov_b32 s10, 0
.cd_24:
.iw_22:
  s_waitcnt vmcnt(0)
  s_barrier
  s_cmp_lg_u32 s3, 0
  s_cbranch_scc1 .af_25
  s_lshl_b32 s14, s80, 7
  s_add_u32 s14, s14, 0x18000
  v_mov_b32 v12, 1
  s_mov_b64 exec, 1
  buffer_store_dword v12, v5, s[4:7], s14 offen sc1
  s_mov_b64 exec, -1
.af_25:
  v_add_u32 v96, 0xffffffc2, v5
  s_add_u32 m0, s11, 0
  s_nop 0
  buffer_load_dwordx4 v96, s[92:95], 0 offen lds
  v_add_u32 v96, 0x3c2, v5
  s_add_u32 m0, s11, 1024
  s_nop 0
  buffer_load_dwordx4 v96, s[92:95], 0 offen lds
  v_add_u32 v96, 0x7c2, v5
  s_add_u32 m0, s11, 2048
  s_nop 0
  buffer_load_dwordx4 v96, s[92:95], 0 offen lds
  v_add_u32 v96, 0xbc2, v5
  s_add_u32 m0, s11, 3072
  s_nop 0
  buffer_load_dwordx4 v96, s[92:95], 0 offen lds
  v_add_u32 v96, 0xfc2, v5
  v_subrev_u32 v97, 4158, v96
  v_cmp_le_u32 vcc, 4, v0
  s_nop 1
  v_cndmask_b32 v96, v96, v97, vcc
  s_add_u32 m0, s11, 4096
  s_nop 0
  buffer_load_dwordx4 v96, s[92:95], 0 offen lds
  v_add_u32 v96, 0x384, v5
  s_add_u32 m0, s11, 5120
  s_nop 0
  buffer_load_dwordx4 v96, s[92:95], 0 offen lds
  v_add_u32 v96, 0x784, v5
  s_add_u32 m0, s11, 6144
  s_nop 0
  buffer_load_dwordx4 v96, s[92:95], 0 offen lds
  v_add_u32 v96, 0xb84, v5
  s_add_u32 m0, s11, 7168
  s_nop 0
  buffer_load_dwordx4 v96, s[92:95], 0 offen lds
  v_add_u32 v96, 0xf84, v5
  v_subrev_u32 v97, 4158, v96
  v_cmp_le_u32 vcc, 8, v0
  s_nop 1
  v_cndmask_b32 v96, v96, v97, vcc
  s_add_u32 m0, s11, 8192
  s_nop 0
  buffer_load_dwordx4 v96, s[92:95], 0 offen lds
  v_add_u32 v96, 0x346, v5
  s_add_u32 m0, s11, 9216
  s_nop 0
  buffer_load_dwordx4 v96, s[92:95], 0 offen lds
  v_add_u32 v96, 0x746, v5
  s_add_u32 m0, s11, 10240
  s_nop 0
  buffer_load_dwordx4 v96, s[92:95], 0 offen lds
  v_add_u32 v96, 0xb46, v5
  s_add_u32 m0, s11, 11264
  s_nop 0
  buffer_load_dwordx4 v96, s[92:95], 0 offen lds
  v_add_u32 v96, 0xf46, v5
  v_subrev_u32 v97, 4158, v96
  v_cmp_le_u32 vcc, 12, v0
  s_nop 1
  v_cndmask_b32 v96, v96, v97, vcc
  s_add_u32 m0, s11, 12288
  s_nop 0
  buffer_load_dwordx4 v96, s[92:95], 0 offen lds
  v_add_u32 v96, 0x308, v5
  s_add_u32 m0, s11, 13312
  s_nop 0
  buffer_load_dwordx4 v96, s[92:95], 0 offen lds
  v_add_u32 v96, 0x708, v5
  s_add_u32 m0, s11, 14336
  s_nop 0
  buffer_load_dwordx4 v96, s[92:95], 0 offen lds
  v_add_u32 v96, 0xb08, v5
  s_add_u32 m0, s11, 15360
  s_nop 0
  buffer_load_dwordx4 v96, s[92:95], 0 offen lds
  v_add_u32 v96, 0xf08, v5
  v_subrev_u32 v97, 4158, v96
  v_cmp_le_u32 vcc, 16, v0
  s_nop 1
  v_cndmask_b32 v96, v96, v97, vcc
  s_add_u32 m0, s11, 16384
  s_nop 0
  buffer_load_dwordx4 v96, s[92:95], 0 offen lds
  v_bfe_u32 v96, v0, 3, 2
  v_and_b32 v97, 7, v0
  v_add_u32 v8, v96, v97
  v_subrev_u32 v8, 7, v8
  v_lshlrev_b32 v8, 1, v8
  buffer_load_ushort v9, v8, s[92:95], 0 offen
  v_mul_u32_u24 v96, 4160, v96
  v_lshl_add_u32 v96, v97, 1, v96
  v_add_u32 v8, s11, v96
  s_cmp_lg_u32 s3, 0
  s_cbranch_scc1 .af_27
  s_mov_b32 exec_lo, -1
  s_mov_b32 exec_hi, 0xffff
  v_mul_u32_u24 v15, 384, v0
  s_mov_b32 s14, 0x18000
.al_26:
  s_sleep 4
  buffer_load_dword v12, v15, s[4:7], s14 offen sc1
  buffer_load_dword v13, v15, s[4:7], s14 offen offset:128 sc1
  buffer_load_dword v14, v15, s[4:7], s14 offen offset:256 sc1
  s_waitcnt vmcnt(0)
  v_min3_u32 v12, v12, v13, v14
  v_cmp_gt_u32 vcc, 1, v12
  s_cbranch_vccz .af_27
  s_sub_u32 s10, s10, 1
  s_cbranch_scc0 .al_26
  s_mov_b32 s10, 0
.af_27:
  s_mov_b64 exec, -1
  s_barrier
  s_lshl_b32 s14, s80, 14
  s_add_u32 s14, s14, 0x1a00000
  v_lshlrev_b32 v4, 4, v90
  buffer_load_dwordx4 v[16:19], v4, s[4:7], s14 offen sc1
  s_add_u32 s14, s14, 4096
  buffer_load_dwordx4 v[20:23], v4, s[4:7], s14 offen sc1
  s_add_u32 s14, s14, 4096
  buffer_load_dwordx4 v[24:27], v4, s[4:7], s14 offen sc1
  s_add_u32 s14, s14, 4096
  buffer_load_dwordx4 v[28:31], v4, s[4:7], s14 offen sc1
  s_add_u32 s14, s14, 4096
  v_mov_b32 v48, 0
  v_mov_b32 v49, 0
  v_mov_b32 v50, 0
  v_mov_b32 v51, 0
  ds_write_b128 v6, v[48:51] offset:5120
  ds_write_b128 v6, v[48:51] offset:6144
  ds_write_b128 v6, v[48:51] offset:7168
  v_lshrrev_b32 v6, 2, v90
  v_sub_u32 v6, 63, v6
  v_lshrrev_b32 v7, 2, v6
  v_mul_u32_u24 v7, 80, v7
  v_and_b32 v6, 3, v6
  v_lshl_add_u32 v7, v6, 4, v7
  v_and_b32 v6, 3, v0
  v_lshl_add_u32 v7, v6, 13, v7
  s_waitcnt vmcnt(3)
  ds_write_b128 v7, v[16:19] offset:3840
  s_waitcnt vmcnt(2)
  ds_write_b128 v7, v[20:23] offset:2560
  s_waitcnt vmcnt(1)
  ds_write_b128 v7, v[24:27] offset:1280
  s_waitcnt vmcnt(0)
  ds_write_b128 v7, v[28:31] offset:0
  ds_write_b16 v8, v9 offset:48
  v_and_b32 v6, 3, v0
  v_mul_u32_u24 v1, 4160, v6
  v_bfe_u32 v6, v0, 2, 3
  v_lshl_add_u32 v1, v6, 3, v1
  v_lshrrev_b32 v7, 5, v0
  v_lshl_add_u32 v1, v7, 4, v1
  v_add_u32 v1, s11, v1
  v_and_b32 v6, 31, v0
  v_sub_u32 v6, 31, v6
  v_mul_u32_u24 v3, 80, v6
  v_add_u32 v3, s12, v3
  v_lshl_add_u32 v2, v7, 4, v3
  v_lshlrev_b32 v7, 3, v7
  v_sub_u32 v3, v3, v7
  s_mov_b32 s84, s26
  s_mov_b32 s85, s27
  s_mov_b32 s86, 0x240000
  s_mov_b32 s87, 0x20000
  s_mov_b32 s24, -1
  s_mov_b32 s25, 0xffff
  v_lshlrev_b32 v91, 4, v0
  v_lshlrev_b32 v92, 3, v0
  v_mov_b32 v4, 0x80000000
  v_cndmask_b32 v91, v4, v91, s[24:25]
  v_cndmask_b32 v92, v4, v92, s[24:25]
  s_lshl_b32 s15, s81, 2
  s_add_u32 s15, s15, s3
  s_and_b32 s15, s15, 511
  s_lshl_b32 s62, s81, 7
  s_add_u32 s62, s62, 0x10000
  s_mul_i32 s15, s15, 1152
  s_add_u32 s14, s15, 0
  buffer_load_dwordx2 v[100:101], v92, s[84:87], s14 offen offset:0
  buffer_load_dwordx2 v[102:103], v92, s[84:87], s14 offen offset:384
  buffer_load_dwordx2 v[104:105], v92, s[84:87], s14 offen offset:768
  s_add_u32 s14, s15, 589824
  buffer_load_dwordx2 v[106:107], v92, s[84:87], s14 offen offset:0
  buffer_load_dwordx2 v[108:109], v92, s[84:87], s14 offen offset:384
  buffer_load_dwordx2 v[110:111], v92, s[84:87], s14 offen offset:768
  s_add_u32 s14, s15, 1179648
  buffer_load_dwordx2 v[112:113], v92, s[84:87], s14 offen offset:0
  buffer_load_dwordx2 v[114:115], v92, s[84:87], s14 offen offset:384
  buffer_load_dwordx2 v[116:117], v92, s[84:87], s14 offen offset:768
  s_add_u32 s14, s15, 1769472
  buffer_load_dwordx2 v[118:119], v92, s[84:87], s14 offen offset:0
  buffer_load_dwordx2 v[120:121], v92, s[84:87], s14 offen offset:384
  buffer_load_dwordx2 v[122:123], v92, s[84:87], s14 offen offset:768
  s_mul_i32 s14, s80, 57
  s_lshr_b32 s14, s14, 11
  s_mul_i32 s63, s14, 144
  s_sub_u32 s63, s13, s63
  s_lshl_b32 s63, s63, 15
  s_mov_b64 s[56:57], s[32:33]
  s_cmp_eq_u32 s14, 1
  s_cselect_b64 s[56:57], s[36:37], s[56:57]
  s_cmp_eq_u32 s14, 2
  s_cselect_b64 s[56:57], s[40:41], s[56:57]
  s_cmp_eq_u32 s14, 3
  s_cselect_b64 s[56:57], s[44:45], s[56:57]
  s_mov_b32 s58, 4718592
  s_mov_b32 s59, 0x20000
  v_lshlrev_b32 v94, 5, v0
  s_waitcnt lgkmcnt(0)
  s_barrier
  ds_read_b64 v[128:129], v1 offset:0
  ds_read_b64 v[130:131], v1 offset:8
  ds_read_b128 v[136:139], v2 offset:0
  ds_read_b128 v[140:143], v2 offset:2560
  ds_read_b64 v[132:133], v1 offset:2048
  ds_read_b64 v[134:135], v1 offset:2056
  ds_read_b64 v[144:145], v1 offset:32
  ds_read_b64 v[146:147], v1 offset:40
  ds_read_b128 v[152:155], v2 offset:32
  ds_read_b128 v[156:159], v2 offset:2592
  ds_read_b64 v[148:149], v1 offset:2080
  ds_read_b64 v[150:151], v1 offset:2088
  v_mov_b64 v[16:17], 0
  v_mov_b64 v[18:19], 0
  v_mov_b64 v[20:21], 0
  v_mov_b64 v[22:23], 0
  v_mov_b64 v[24:25], 0
  v_mov_b64 v[26:27], 0
  v_mov_b64 v[28:29], 0
  v_mov_b64 v[30:31], 0
  v_mov_b64 v[32:33], 0
  v_mov_b64 v[34:35], 0
  v_mov_b64 v[36:37], 0
  v_mov_b64 v[38:39], 0
  v_mov_b64 v[40:41], 0
  v_mov_b64 v[42:43], 0
  v_mov_b64 v[44:45], 0
  v_mov_b64 v[46:47], 0
  s_mov_b32 s14, 16
.cv_28:
  s_waitcnt lgkmcnt(9)
  v_mfma_f32_32x32x16_bf16 v[16:31], v[128:131], v[136:139], v[16:31]
  ds_read_b64 v[160:161], v1 offset:64
  ds_read_b64 v[162:163], v1 offset:72
  s_waitcnt lgkmcnt(10)
  v_mfma_f32_32x32x16_bf16 v[32:47], v[128:131], v[140:143], v[32:47]
  ds_read_b128 v[168:171], v2 offset:80
  ds_read_b128 v[172:175], v2 offset:2640
  s_waitcnt lgkmcnt(10)
  v_mfma_f32_32x32x16_bf16 v[16:31], v[132:135], v[140:143], v[16:31]
  ds_read_b64 v[164:165], v1 offset:2112
  ds_read_b64 v[166:167], v1 offset:2120
  buffer_load_dword v95, v94, s[56:59], s63 offen
  s_add_u32 s63, s63, 2048
  s_waitcnt lgkmcnt(9)
  v_mfma_f32_32x32x16_bf16 v[16:31], v[144:147], v[152:155], v[16:31]
  ds_read_b64 v[176:177], v1 offset:96
  ds_read_b64 v[178:179], v1 offset:104
  s_waitcnt lgkmcnt(10)
  v_mfma_f32_32x32x16_bf16 v[32:47], v[144:147], v[156:159], v[32:47]
  ds_read_b128 v[184:187], v2 offset:112
  ds_read_b128 v[188:191], v2 offset:2672
  s_waitcnt lgkmcnt(10)
  v_mfma_f32_32x32x16_bf16 v[16:31], v[148:151], v[156:159], v[16:31]
  ds_read_b64 v[180:181], v1 offset:2144
  ds_read_b64 v[182:183], v1 offset:2152
  s_waitcnt lgkmcnt(9)
  v_mfma_f32_32x32x16_bf16 v[16:31], v[160:163], v[168:171], v[16:31]
  ds_read_b64 v[128:129], v1 offset:128
  ds_read_b64 v[130:131], v1 offset:136
  s_waitcnt lgkmcnt(10)
  v_mfma_f32_32x32x16_bf16 v[32:47], v[160:163], v[172:175], v[32:47]
  ds_read_b128 v[136:139], v2 offset:160
  ds_read_b128 v[140:143], v2 offset:2720
  s_waitcnt lgkmcnt(10)
  v_mfma_f32_32x32x16_bf16 v[16:31], v[164:167], v[172:175], v[16:31]
  ds_read_b64 v[132:133], v1 offset:2176
  ds_read_b64 v[134:135], v1 offset:2184
  s_waitcnt lgkmcnt(9)
  v_mfma_f32_32x32x16_bf16 v[16:31], v[176:179], v[184:187], v[16:31]
  ds_read_b64 v[144:145], v1 offset:160
  ds_read_b64 v[146:147], v1 offset:168
  s_waitcnt lgkmcnt(10)
  v_mfma_f32_32x32x16_bf16 v[32:47], v[176:179], v[188:191], v[32:47]
  ds_read_b128 v[152:155], v2 offset:192
  ds_read_b128 v[156:159], v2 offset:2752
  s_waitcnt lgkmcnt(10)
  v_mfma_f32_32x32x16_bf16 v[16:31], v[180:183], v[188:191], v[16:31]
  ds_read_b64 v[148:149], v1 offset:2208
  ds_read_b64 v[150:151], v1 offset:2216
  v_add_u32 v1, 128, v1
  v_add_u32 v2, 160, v2
  s_sub_u32 s14, s14, 1
  s_cmp_lg_u32 s14, 0
  s_cbranch_scc1 .cv_28
  s_waitcnt lgkmcnt(0)
  ds_read_b64 v[48:49], v3 offset:2616
  ds_read_b64 v[50:51], v3 offset:2600
  ds_read_b64 v[52:53], v3 offset:2584
  ds_read_b64 v[54:55], v3 offset:2568
  ds_read_b64 v[56:57], v3 offset:56
  ds_read_b64 v[58:59], v3 offset:40
  ds_read_b64 v[60:61], v3 offset:24
  ds_read_b64 v[62:63], v3 offset:8
  s_barrier
  v_and_b32 v6, 15, v0
  v_mul_u32_u24 v6, 1040, v6
  v_lshrrev_b32 v7, 5, v0
  v_lshl_add_u32 v6, v7, 7, v6
  v_bfe_u32 v7, v0, 4, 1
  v_lshl_add_u32 v6, v7, 3, v6
  s_lshl_b32 s14, s3, 5
  v_add_u32 v6, s14, v6
  s_waitcnt lgkmcnt(7)
  v_and_b32 v64, 0xffff0000, v49
  v_lshlrev_b32 v65, 16, v49
  v_and_b32 v66, 0xffff0000, v48
  v_lshlrev_b32 v67, 16, v48
  v_fmac_f32 v32, s60, v64
  v_fmac_f32 v33, s60, v65
  v_fmac_f32 v34, s60, v66
  v_fmac_f32 v35, s60, v67
  v_cvt_pk_bf16_f32 v68, v32, v33
  v_cvt_pk_bf16_f32 v69, v34, v35
  ds_write_b64 v6, v[68:69] offset:32768
  s_waitcnt lgkmcnt(7)
  v_and_b32 v64, 0xffff0000, v51
  v_lshlrev_b32 v65, 16, v51
  v_and_b32 v66, 0xffff0000, v50
  v_lshlrev_b32 v67, 16, v50
  v_fmac_f32 v36, s60, v64
  v_fmac_f32 v37, s60, v65
  v_fmac_f32 v38, s60, v66
  v_fmac_f32 v39, s60, v67
  v_cvt_pk_bf16_f32 v68, v36, v37
  v_cvt_pk_bf16_f32 v69, v38, v39
  ds_write_b64 v6, v[68:69] offset:33024
  s_waitcnt lgkmcnt(7)
  v_and_b32 v64, 0xffff0000, v53
  v_lshlrev_b32 v65, 16, v53
  v_and_b32 v66, 0xffff0000, v52
  v_lshlrev_b32 v67, 16, v52
  v_fmac_f32 v40, s60, v64
  v_fmac_f32 v41, s60, v65
  v_fmac_f32 v42, s60, v66
  v_fmac_f32 v43, s60, v67
  v_cvt_pk_bf16_f32 v68, v40, v41
  v_cvt_pk_bf16_f32 v69, v42, v43
  ds_write_b64 v6, v[68:69] offset:33280
  s_waitcnt lgkmcnt(7)
  v_and_b32 v64, 0xffff0000, v55
  v_lshlrev_b32 v65, 16, v55
  v_and_b32 v66, 0xffff0000, v54
  v_lshlrev_b32 v67, 16, v54
  v_fmac_f32 v44, s60, v64
  v_fmac_f32 v45, s60, v65
  v_fmac_f32 v46, s60, v66
  v_fmac_f32 v47, s60, v67
  v_cvt_pk_bf16_f32 v68, v44, v45
  v_cvt_pk_bf16_f32 v69, v46, v47
  ds_write_b64 v6, v[68:69] offset:33536
  s_waitcnt lgkmcnt(7)
  v_and_b32 v64, 0xffff0000, v57
  v_lshlrev_b32 v65, 16, v57
  v_and_b32 v66, 0xffff0000, v56
  v_lshlrev_b32 v67, 16, v56
  v_fmac_f32 v16, s60, v64
  v_fmac_f32 v17, s60, v65
  v_fmac_f32 v18, s60, v66
  v_fmac_f32 v19, s60, v67
  v_cvt_pk_bf16_f32 v68, v16, v17
  v_cvt_pk_bf16_f32 v69, v18, v19
  ds_write_b64 v6, v[68:69] offset:32784
  s_waitcnt lgkmcnt(7)
  v_and_b32 v64, 0xffff0000, v59
  v_lshlrev_b32 v65, 16, v59
  v_and_b32 v66, 0xffff0000, v58
  v_lshlrev_b32 v67, 16, v58
  v_fmac_f32 v20, s60, v64
  v_fmac_f32 v21, s60, v65
  v_fmac_f32 v22, s60, v66
  v_fmac_f32 v23, s60, v67
  v_cvt_pk_bf16_f32 v68, v20, v21
  v_cvt_pk_bf16_f32 v69, v22, v23
  ds_write_b64 v6, v[68:69] offset:33040
  s_waitcnt lgkmcnt(7)
  v_and_b32 v64, 0xffff0000, v61
  v_lshlrev_b32 v65, 16, v61
  v_and_b32 v66, 0xffff0000, v60
  v_lshlrev_b32 v67, 16, v60
  v_fmac_f32 v24, s60, v64
  v_fmac_f32 v25, s60, v65
  v_fmac_f32 v26, s60, v66
  v_fmac_f32 v27, s60, v67
  v_cvt_pk_bf16_f32 v68, v24, v25
  v_cvt_pk_bf16_f32 v69, v26, v27
  ds_write_b64 v6, v[68:69] offset:33296
  s_waitcnt lgkmcnt(7)
  v_and_b32 v64, 0xffff0000, v63
  v_lshlrev_b32 v65, 16, v63
  v_and_b32 v66, 0xffff0000, v62
  v_lshlrev_b32 v67, 16, v62
  v_fmac_f32 v28, s60, v64
  v_fmac_f32 v29, s60, v65
  v_fmac_f32 v30, s60, v66
  v_fmac_f32 v31, s60, v67
  v_cvt_pk_bf16_f32 v68, v28, v29
  v_cvt_pk_bf16_f32 v69, v30, v31
  ds_write_b64 v6, v[68:69] offset:33552
  s_mul_i32 s14, s3, 1040
  v_add_u32 v6, s14, v5
  v_lshrrev_b32 v7, 3, v90
  v_mul_u32_u24 v7, 18432, v7
  v_and_b32 v8, 7, v0
  v_lshl_add_u32 v7, v8, 4, v7
  s_lshl_b32 s14, s80, 7
  s_add_u32 s14, s14, 0xe80000
  s_waitcnt lgkmcnt(0)
  s_barrier
  ds_read_b128 v[16:19], v6 offset:32768
  ds_read_b128 v[20:23], v6 offset:36928
  ds_read_b128 v[24:27], v6 offset:41088
  ds_read_b128 v[28:31], v6 offset:45248
  s_waitcnt lgkmcnt(3)
  buffer_store_dwordx4 v[16:19], v7, s[4:7], s14 offen sc1
  s_add_u32 s14, s14, 589824
  s_waitcnt lgkmcnt(2)
  buffer_store_dwordx4 v[20:23], v7, s[4:7], s14 offen sc1
  s_add_u32 s14, s14, 589824
  s_waitcnt lgkmcnt(1)
  buffer_store_dwordx4 v[24:27], v7, s[4:7], s14 offen sc1
  s_add_u32 s14, s14, 589824
  s_waitcnt lgkmcnt(0)
  buffer_store_dwordx4 v[28:31], v7, s[4:7], s14 offen sc1
  s_add_u32 s14, s14, 589824
  s_waitcnt vmcnt(0)
  s_barrier
  s_cmp_lg_u32 s3, 0
  s_cbranch_scc1 .af_29
  s_lshl_b32 s14, s80, 7
  s_add_u32 s14, s14, 0x18000
  v_mov_b32 v12, 2
  s_mov_b64 exec, 1
  buffer_store_dword v12, v5, s[4:7], s14 offen sc1
  s_cmp_eq_u32 s81, -1
  s_cbranch_scc1 .af_29
  s_mov_b32 exec_lo, -1
  s_mov_b32 exec_hi, 0xffff
  v_mul_u32_u24 v15, 384, v0
  s_mov_b32 s14, 0x18000
.al_30:
  s_sleep 4
  buffer_load_dword v12, v15, s[4:7], s14 offen sc1
  buffer_load_dword v13, v15, s[4:7], s14 offen offset:128 sc1
  buffer_load_dword v14, v15, s[4:7], s14 offen offset:256 sc1
  s_waitcnt vmcnt(0)
  v_min3_u32 v12, v12, v13, v14
  v_cmp_gt_u32 vcc, 2, v12
  s_cbranch_vccz .af_29
  s_sub_u32 s10, s10, 1
  s_cbranch_scc0 .al_30
  s_mov_b32 s10, 0
.af_29:
  s_mov_b64 exec, -1
  s_barrier
  s_cmp_eq_u32 s81, -1
  s_cbranch_scc1 roles
.lnjob:
  s_mul_i32 s14, s81, 18432
  s_add_u32 s14, s14, 0xe80000
  s_mul_i32 s11, s3, 4608
  s_add_u32 s14, s14, s11
  s_mov_b32 m0, s11
  s_nop 0
  buffer_load_dwordx4 v5, s[4:7], s14 offen offset:0 sc1 lds
  buffer_load_dwordx4 v5, s[4:7], s14 offen offset:1024 sc1 lds
  buffer_load_dwordx4 v5, s[4:7], s14 offen offset:2048 sc1 lds
  buffer_load_dwordx4 v5, s[4:7], s14 offen offset:3072 sc1 lds
  s_add_u32 m0, s11, 4096
  s_add_u32 s14, s14, 4096
  s_mov_b64 exec, 0xffffffff
  buffer_load_dwordx4 v5, s[4:7], s14 offen sc1 lds
  s_mov_b64 exec, -1
  v_lshlrev_b32 v6, 3, v0
  v_add_u32 v7, s11, v6
  v_and_b32 v8, 15, v0
  v_mul_u32_u24 v8, 1168, v8
  v_lshrrev_b32 v9, 4, v0
  v_lshl_add_u32 v8, v9, 3, v8
  s_mul_i32 s14, s3, 288
  v_add_u32 v8, s14, v8
  s_mul_i32 s14, s3, 1168
  v_add_u32 v6, s14, v6
  s_cmp_eq_u32 s3, 0
  s_cselect_b32 s64, 1, 0
  s_mov_b32 s65, 0
  s_waitcnt vmcnt(0)
  ds_read_b64_tr_b16 v[16:17], v7 offset:0
  ds_read_b64_tr_b16 v[18:19], v7 offset:512
  ds_read_b64_tr_b16 v[20:21], v7 offset:1024
  ds_read_b64_tr_b16 v[22:23], v7 offset:1536
  ds_read_b64_tr_b16 v[24:25], v7 offset:2048
  ds_read_b64_tr_b16 v[26:27], v7 offset:2560
  ds_read_b64_tr_b16 v[28:29], v7 offset:3072
  ds_read_b64_tr_b16 v[30:31], v7 offset:3584
  ds_read_b64_tr_b16 v[32:33], v7 offset:4096
  s_waitcnt lgkmcnt(8)
  ds_write_b64 v8, v[16:17] offset:20480
  s_waitcnt lgkmcnt(8)
  ds_write_b64 v8, v[18:19] offset:20512
  s_waitcnt lgkmcnt(8)
  ds_write_b64 v8, v[20:21] offset:20544
  s_waitcnt lgkmcnt(8)
  ds_write_b64 v8, v[22:23] offset:20576
  s_waitcnt lgkmcnt(8)
  ds_write_b64 v8, v[24:25] offset:20608
  s_waitcnt lgkmcnt(8)
  ds_write_b64 v8, v[26:27] offset:20640
  s_waitcnt lgkmcnt(8)
  ds_write_b64 v8, v[28:29] offset:20672
  s_waitcnt lgkmcnt(8)
  ds_write_b64 v8, v[30:31] offset:20704
  s_waitcnt lgkmcnt(8)
  ds_write_b64 v8, v[32:33] offset:20736
  s_waitcnt lgkmcnt(0)
  s_barrier
  s_mov_b32 s13, 0
.ln_31:
  ds_read_b64 v[10:11], v6 offset:20480
  ds_read_b64 v[12:13], v6 offset:20864
  ds_read_b64 v[14:15], v6 offset:21248
  v_lshlrev_b32 v20, 16, v100
  v_and_b32 v21, 0xffff0000, v100
  v_lshlrev_b32 v22, 16, v101
  v_and_b32 v23, 0xffff0000, v101
  v_lshlrev_b32 v24, 16, v102
  v_and_b32 v25, 0xffff0000, v102
  v_lshlrev_b32 v26, 16, v103
  v_and_b32 v27, 0xffff0000, v103
  v_lshlrev_b32 v28, 16, v104
  v_and_b32 v29, 0xffff0000, v104
  v_lshlrev_b32 v30, 16, v105
  v_and_b32 v31, 0xffff0000, v105
  v_mov_b32 v100, v106
  v_mov_b32 v101, v107
  v_mov_b32 v102, v108
  v_mov_b32 v103, v109
  v_mov_b32 v104, v110
  v_mov_b32 v105, v111
  v_mov_b32 v106, v112
  v_mov_b32 v107, v113
  v_mov_b32 v108, v114
  v_mov_b32 v109, v115
  v_mov_b32 v110, v116
  v_mov_b32 v111, v117
  v_mov_b32 v112, v118
  v_mov_b32 v113, v119
  v_mov_b32 v114, v120
  v_mov_b32 v115, v121
  v_mov_b32 v116, v122
  v_mov_b32 v117, v123
  s_add_u32 s14, s15, 0x200000
  s_waitcnt lgkmcnt(2)
  buffer_store_dwordx2 v[10:11], v92, s[4:7], s14 offen offset:0 sc1
  s_waitcnt lgkmcnt(1)
  buffer_store_dwordx2 v[12:13], v92, s[4:7], s14 offen offset:384 sc1
  s_waitcnt lgkmcnt(0)
  buffer_store_dwordx2 v[14:15], v92, s[4:7], s14 offen offset:768 sc1
  v_lshlrev_b32 v56, 16, v10
  v_and_b32 v57, 0xffff0000, v10
  v_lshlrev_b32 v58, 16, v11
  v_and_b32 v59, 0xffff0000, v11
  v_lshlrev_b32 v60, 16, v12
  v_and_b32 v61, 0xffff0000, v12
  v_lshlrev_b32 v62, 16, v13
  v_and_b32 v63, 0xffff0000, v13
  v_lshlrev_b32 v64, 16, v14
  v_and_b32 v65, 0xffff0000, v14
  v_lshlrev_b32 v66, 16, v15
  v_and_b32 v67, 0xffff0000, v15
  v_readfirstlane_b32 s12, v20
  s_xor_b32 s12, s12, 0x80000000
  s_nop 0
  v_mov_b32 v50, s12
  v_pk_add_f32 v[32:33], v[20:21], v[50:51] op_sel_hi:[1,0]
  v_pk_add_f32 v[34:35], v[22:23], v[50:51] op_sel_hi:[1,0]
  v_pk_add_f32 v[36:37], v[24:25], v[50:51] op_sel_hi:[1,0]
  v_pk_add_f32 v[38:39], v[26:27], v[50:51] op_sel_hi:[1,0]
  v_pk_add_f32 v[40:41], v[28:29], v[50:51] op_sel_hi:[1,0]
  v_pk_add_f32 v[42:43], v[30:31], v[50:51] op_sel_hi:[1,0]
  v_pk_mul_f32 v[52:53], v[32:33], v[32:33]
  v_pk_add_f32 v[50:51], v[32:33], v[34:35]
  v_pk_fma_f32 v[52:53], v[34:35], v[34:35], v[52:53]
  v_pk_fma_f32 v[52:53], v[36:37], v[36:37], v[52:53]
  v_pk_add_f32 v[50:51], v[50:51], v[36:37]
  v_pk_fma_f32 v[52:53], v[38:39], v[38:39], v[52:53]
  v_pk_add_f32 v[50:51], v[50:51], v[38:39]
  v_pk_fma_f32 v[52:53], v[40:41], v[40:41], v[52:53]
  v_pk_add_f32 v[50:51], v[50:51], v[40:41]
  v_pk_fma_f32 v[52:53], v[42:43], v[42:43], v[52:53]
  v_pk_add_f32 v[50:51], v[50:51], v[42:43]
  v_add_f32 v50, v50, v51
  v_add_f32 v52, v52, v53
  v_cndmask_b32 v50, 0, v50, s[24:25]
  v_cndmask_b32 v52, 0, v52, s[24:25]
  s_nop 0
  v_add_f32_dpp v50, v50, v50 row_ror:8 row_mask:0xf bank_mask:0xf
  v_add_f32_dpp v52, v52, v52 row_ror:8 row_mask:0xf bank_mask:0xf
  s_nop 0
  v_add_f32_dpp v50, v50, v50 row_ror:4 row_mask:0xf bank_mask:0xf
  v_add_f32_dpp v52, v52, v52 row_ror:4 row_mask:0xf bank_mask:0xf
  s_nop 0
  v_add_f32_dpp v50, v50, v50 row_ror:2 row_mask:0xf bank_mask:0xf
  v_add_f32_dpp v52, v52, v52 row_ror:2 row_mask:0xf bank_mask:0xf
  s_nop 0
  v_add_f32_dpp v50, v50, v50 row_ror:1 row_mask:0xf bank_mask:0xf
  v_add_f32_dpp v52, v52, v52 row_ror:1 row_mask:0xf bank_mask:0xf
  v_mov_b32 v54, v50
  v_mov_b32 v55, v52
  s_nop 0
  v_permlane16_swap_b32 v54, v50
  v_permlane16_swap_b32 v55, v52
  v_add_f32 v50, v50, v54
  v_add_f32 v52, v52, v55
  v_mov_b32 v54, v50
  v_mov_b32 v55, v52
  s_nop 0
  v_permlane32_swap_b32 v54, v50
  v_permlane32_swap_b32 v55, v52
  v_add_f32 v50, v50, v54
  v_add_f32 v52, v52, v55
  v_mul_f32 v50, 0x3ae38e39, v50
  v_mul_f32 v52, 0x3ae38e39, v52
  v_fma_f32 v52, -v50, v50, v52
  v_max_f32 v52, 0, v52
  v_sub_f32 v50, s12, v50
  v_cvt_pk_bf16_f32 v52, v52, v52
  v_and_b32 v52, 0xffff0000, v52
  v_cvt_pk_bf16_f32 v50, v50, v50
  v_and_b32 v50, 0xffff0000, v50
  v_add_f32 v52, 0x3727c5ac, v52
  v_cvt_pk_bf16_f32 v52, v52, v52
  v_and_b32 v52, 0xffff0000, v52
  v_sqrt_f32 v52, v52
  s_nop 0
  v_cvt_pk_bf16_f32 v52, v52, v52
  v_and_b32 v52, 0xffff0000, v52
  v_rcp_f32 v52, v52
  v_pk_add_f32 v[32:33], v[20:21], v[50:51] op_sel_hi:[1,0]
  v_pk_add_f32 v[34:35], v[22:23], v[50:51] op_sel_hi:[1,0]
  v_pk_add_f32 v[36:37], v[24:25], v[50:51] op_sel_hi:[1,0]
  v_pk_add_f32 v[38:39], v[26:27], v[50:51] op_sel_hi:[1,0]
  v_pk_add_f32 v[40:41], v[28:29], v[50:51] op_sel_hi:[1,0]
  v_pk_add_f32 v[42:43], v[30:31], v[50:51] op_sel_hi:[1,0]
  v_pk_mul_f32 v[56:57], v[56:57], v[52:53] op_sel_hi:[1,0]
  v_pk_mul_f32 v[58:59], v[58:59], v[52:53] op_sel_hi:[1,0]
  v_pk_mul_f32 v[60:61], v[60:61], v[52:53] op_sel_hi:[1,0]
  v_pk_mul_f32 v[62:63], v[62:63], v[52:53] op_sel_hi:[1,0]
  v_pk_mul_f32 v[64:65], v[64:65], v[52:53] op_sel_hi:[1,0]
  v_pk_mul_f32 v[66:67], v[66:67], v[52:53] op_sel_hi:[1,0]
  v_pk_fma_f32 v[20:21], v[32:33], v[56:57], v[20:21]
  v_pk_fma_f32 v[22:23], v[34:35], v[58:59], v[22:23]
  v_pk_fma_f32 v[24:25], v[36:37], v[60:61], v[24:25]
  v_pk_fma_f32 v[26:27], v[38:39], v[62:63], v[26:27]
  v_pk_fma_f32 v[28:29], v[40:41], v[64:65], v[28:29]
  v_pk_fma_f32 v[30:31], v[42:43], v[66:67], v[30:31]
  v_cvt_pk_bf16_f32 v56, v20, v21
  v_cvt_pk_bf16_f32 v57, v22, v23
  v_cvt_pk_bf16_f32 v58, v24, v25
  v_cvt_pk_bf16_f32 v59, v26, v27
  v_cvt_pk_bf16_f32 v60, v28, v29
  v_cvt_pk_bf16_f32 v61, v30, v31
  v_lshlrev_b32 v20, 16, v56
  v_and_b32 v21, 0xffff0000, v56
  v_lshlrev_b32 v22, 16, v57
  v_and_b32 v23, 0xffff0000, v57
  v_lshlrev_b32 v24, 16, v58
  v_and_b32 v25, 0xffff0000, v58
  v_lshlrev_b32 v26, 16, v59
  v_and_b32 v27, 0xffff0000, v59
  v_lshlrev_b32 v28, 16, v60
  v_and_b32 v29, 0xffff0000, v60
  v_lshlrev_b32 v30, 16, v61
  v_and_b32 v31, 0xffff0000, v61
  s_add_u32 s14, s15, 0x480000
  buffer_store_dwordx2 v[56:57], v92, s[4:7], s14 offen offset:0 sc1
  buffer_store_dwordx2 v[58:59], v92, s[4:7], s14 offen offset:384 sc1
  buffer_store_dwordx2 v[60:61], v92, s[4:7], s14 offen offset:768 sc1
  v_readfirstlane_b32 s12, v20
  s_xor_b32 s12, s12, 0x80000000
  s_nop 0
  v_mov_b32 v50, s12
  v_pk_add_f32 v[32:33], v[20:21], v[50:51] op_sel_hi:[1,0]
  v_pk_add_f32 v[34:35], v[22:23], v[50:51] op_sel_hi:[1,0]
  v_pk_add_f32 v[36:37], v[24:25], v[50:51] op_sel_hi:[1,0]
  v_pk_add_f32 v[38:39], v[26:27], v[50:51] op_sel_hi:[1,0]
  v_pk_add_f32 v[40:41], v[28:29], v[50:51] op_sel_hi:[1,0]
  v_pk_add_f32 v[42:43], v[30:31], v[50:51] op_sel_hi:[1,0]
  v_pk_mul_f32 v[52:53], v[32:33], v[32:33]
  v_pk_add_f32 v[50:51], v[32:33], v[34:35]
  v_pk_fma_f32 v[52:53], v[34:35], v[34:35], v[52:53]
  v_pk_fma_f32 v[52:53], v[36:37], v[36:37], v[52:53]
  v_pk_add_f32 v[50:51], v[50:51], v[36:37]
  v_pk_fma_f32 v[52:53], v[38:39], v[38:39], v[52:53]
  v_pk_add_f32 v[50:51], v[50:51], v[38:39]
  v_pk_fma_f32 v[52:53], v[40:41], v[40:41], v[52:53]
  v_pk_add_f32 v[50:51], v[50:51], v[40:41]
  v_pk_fma_f32 v[52:53], v[42:43], v[42:43], v[52:53]
  v_pk_add_f32 v[50:51], v[50:51], v[42:43]
  v_add_f32 v50, v50, v51
  v_add_f32 v52, v52, v53
  v_cndmask_b32 v50, 0, v50, s[24:25]
  v_cndmask_b32 v52, 0, v52, s[24:25]
  s_nop 0
  v_add_f32_dpp v50, v50, v50 row_ror:8 row_mask:0xf bank_mask:0xf
  v_add_f32_dpp v52, v52, v52 row_ror:8 row_mask:0xf bank_mask:0xf
  s_nop 0
  v_add_f32_dpp v50, v50, v50 row_ror:4 row_mask:0xf bank_mask:0xf
  v_add_f32_dpp v52, v52, v52 row_ror:4 row_mask:0xf bank_mask:0xf
  s_nop 0
  v_add_f32_dpp v50, v50, v50 row_ror:2 row_mask:0xf bank_mask:0xf
  v_add_f32_dpp v52, v52, v52 row_ror:2 row_mask:0xf bank_mask:0xf
  s_nop 0
  v_add_f32_dpp v50, v50, v50 row_ror:1 row_mask:0xf bank_mask:0xf
  v_add_f32_dpp v52, v52, v52 row_ror:1 row_mask:0xf bank_mask:0xf
  v_mov_b32 v54, v50
  v_mov_b32 v55, v52
  s_nop 0
  v_permlane16_swap_b32 v54, v50
  v_permlane16_swap_b32 v55, v52
  v_add_f32 v50, v50, v54
  v_add_f32 v52, v52, v55
  v_mov_b32 v54, v50
  v_mov_b32 v55, v52
  s_nop 0
  v_permlane32_swap_b32 v54, v50
  v_permlane32_swap_b32 v55, v52
  v_add_f32 v50, v50, v54
  v_add_f32 v52, v52, v55
  v_mul_f32 v50, 0x3ae38e39, v50
  v_mul_f32 v52, 0x3ae38e39, v52
  v_fma_f32 v52, -v50, v50, v52
  v_max_f32 v52, 0, v52
  v_sub_f32 v50, s12, v50
  v_cvt_pk_bf16_f32 v52, v52, v52
  v_and_b32 v52, 0xffff0000, v52
  v_cvt_pk_bf16_f32 v50, v50, v50
  v_and_b32 v50, 0xffff0000, v50
  v_add_f32 v52, 0x3727c5ac, v52
  v_cvt_pk_bf16_f32 v52, v52, v52
  v_and_b32 v52, 0xffff0000, v52
  v_sqrt_f32 v52, v52
  s_nop 0
  v_cvt_pk_bf16_f32 v52, v52, v52
  v_and_b32 v52, 0xffff0000, v52
  v_rcp_f32 v52, v52
  v_pk_add_f32 v[32:33], v[20:21], v[50:51] op_sel_hi:[1,0]
  v_pk_add_f32 v[34:35], v[22:23], v[50:51] op_sel_hi:[1,0]
  v_pk_add_f32 v[36:37], v[24:25], v[50:51] op_sel_hi:[1,0]
  v_pk_add_f32 v[38:39], v[26:27], v[50:51] op_sel_hi:[1,0]
  v_pk_add_f32 v[40:41], v[28:29], v[50:51] op_sel_hi:[1,0]
  v_pk_add_f32 v[42:43], v[30:31], v[50:51] op_sel_hi:[1,0]
  v_cvt_pk_bf16_f32 v44, v32, v33
  v_cvt_pk_bf16_f32 v45, v34, v35
  v_cvt_pk_bf16_f32 v46, v36, v37
  v_cvt_pk_bf16_f32 v47, v38, v39
  v_cvt_pk_bf16_f32 v48, v40, v41
  v_cvt_pk_bf16_f32 v49, v42, v43
  v_lshlrev_b32 v32, 16, v44
  v_and_b32 v33, 0xffff0000, v44
  v_lshlrev_b32 v34, 16, v45
  v_and_b32 v35, 0xffff0000, v45
  v_lshlrev_b32 v36, 16, v46
  v_and_b32 v37, 0xffff0000, v46
  v_lshlrev_b32 v38, 16, v47
  v_and_b32 v39, 0xffff0000, v47
  v_lshlrev_b32 v40, 16, v48
  v_and_b32 v41, 0xffff0000, v48
  v_lshlrev_b32 v42, 16, v49
  v_and_b32 v43, 0xffff0000, v49
  v_pk_mul_f32 v[32:33], v[32:33], v[52:53] op_sel_hi:[1,0]
  v_pk_mul_f32 v[34:35], v[34:35], v[52:53] op_sel_hi:[1,0]
  v_pk_mul_f32 v[36:37], v[36:37], v[52:53] op_sel_hi:[1,0]
  v_pk_mul_f32 v[38:39], v[38:39], v[52:53] op_sel_hi:[1,0]
  v_pk_mul_f32 v[40:41], v[40:41], v[52:53] op_sel_hi:[1,0]
  v_pk_mul_f32 v[42:43], v[42:43], v[52:53] op_sel_hi:[1,0]
  v_cvt_pk_bf16_f32 v44, v32, v33
  v_cvt_pk_bf16_f32 v45, v34, v35
  v_cvt_pk_bf16_f32 v46, v36, v37
  v_cvt_pk_bf16_f32 v47, v38, v39
  v_cvt_pk_bf16_f32 v48, v40, v41
  v_cvt_pk_bf16_f32 v49, v42, v43
  s_add_u32 s14, s15, 0x700000
  buffer_store_dwordx2 v[44:45], v92, s[4:7], s14 offen offset:0 sc1
  buffer_store_dwordx2 v[46:47], v92, s[4:7], s14 offen offset:384 sc1
  buffer_store_dwordx2 v[48:49], v92, s[4:7], s14 offen offset:768 sc1
  s_add_u32 s13, s13, 1
  s_lshl_b32 s14, s13, 3
  v_mov_b32 v93, s14
  s_waitcnt vmcnt(0)
  s_barrier
  s_mov_b64 exec, s[64:65]
  buffer_store_dword v93, v5, s[4:7], s62 offen sc1
  s_mov_b64 exec, -1
  v_add_u32 v6, 4672, v6
  s_add_u32 s15, s15, 589824
  s_cmp_lt_u32 s13, 4
  s_cbranch_scc1 .ln_31
  s_barrier
  s_cmp_eq_u32 s82, -1
  s_cbranch_scc1 roles
  s_mov_b32 s81, s82
  s_mov_b32 s82, -1
  s_lshl_b32 s15, s81, 2
  s_add_u32 s15, s15, s3
  s_and_b32 s15, s15, 511
  s_lshl_b32 s62, s81, 7
  s_add_u32 s62, s62, 0x10000
  s_mul_i32 s15, s15, 1152
  s_add_u32 s14, s15, 0
  buffer_load_dwordx2 v[100:101], v92, s[84:87], s14 offen offset:0
  buffer_load_dwordx2 v[102:103], v92, s[84:87], s14 offen offset:384
  buffer_load_dwordx2 v[104:105], v92, s[84:87], s14 offen offset:768
  s_add_u32 s14, s15, 589824
  buffer_load_dwordx2 v[106:107], v92, s[84:87], s14 offen offset:0
  buffer_load_dwordx2 v[108:109], v92, s[84:87], s14 offen offset:384
  buffer_load_dwordx2 v[110:111], v92, s[84:87], s14 offen offset:768
  s_add_u32 s14, s15, 1179648
  buffer_load_dwordx2 v[112:113], v92, s[84:87], s14 offen offset:0
  buffer_load_dwordx2 v[114:115], v92, s[84:87], s14 offen offset:384
  buffer_load_dwordx2 v[116:117], v92, s[84:87], s14 offen offset:768
  s_add_u32 s14, s15, 1769472
  buffer_load_dwordx2 v[118:119], v92, s[84:87], s14 offen offset:0
  buffer_load_dwordx2 v[120:121], v92, s[84:87], s14 offen offset:384
  buffer_load_dwordx2 v[122:123], v92, s[84:87], s14 offen offset:768
  s_branch .lnjob
qkv:
  s_sub_u32 s12, s8, 2
  s_lshl_b32 s12, s12, 3
  s_and_b32 s14, s9, 7
  s_add_u32 s12, s12, s14
  s_lshr_b32 s11, s9, 4
  s_bfe_u32 s16, s9, 0x10003
  s_mul_i32 s13, s3, 36864
  v_lshrrev_b32 v20, 4, v0
  v_lshlrev_b32 v20, 9, v20
  v_bfe_u32 v24, v0, 2, 2
  v_lshl_add_u32 v20, v24, 6, v20
  v_and_b32 v24, 3, v0
  v_lshl_add_u32 v20, v24, 3, v20
  v_add_u32 v20, s13, v20
  v_bfe_u32 v21, v0, 0, 2
  v_lshlrev_b32 v21, 4, v21
  v_bfe_u32 v24, v0, 2, 4
  v_lshl_add_u32 v21, v24, 13, v21
  s_lshl_b32 s15, s12, 8
  s_lshl_b32 s14, s3, 6
  s_add_u32 s15, s15, s14
  s_add_u32 m0, s13, 0
  s_add_u32 s14, s15, 0x0
  buffer_load_dwordx4 v21, s[36:39], s14 offen lds
  s_add_u32 m0, s13, 1024
  s_add_u32 s14, s15, 0x20000
  buffer_load_dwordx4 v21, s[36:39], s14 offen lds
  s_add_u32 m0, s13, 2048
  s_add_u32 s14, s15, 0x40000
  buffer_load_dwordx4 v21, s[36:39], s14 offen lds
  s_add_u32 m0, s13, 3072
  s_add_u32 s14, s15, 0x60000
  buffer_load_dwordx4 v21, s[36:39], s14 offen lds
  s_add_u32 m0, s13, 4096
  s_add_u32 s14, s15, 0x80000
  buffer_load_dwordx4 v21, s[36:39], s14 offen lds
  s_add_u32 m0, s13, 5120
  s_add_u32 s14, s15, 0xa0000
  buffer_load_dwordx4 v21, s[36:39], s14 offen lds
  s_add_u32 m0, s13, 6144
  s_add_u32 s14, s15, 0xc0000
  buffer_load_dwordx4 v21, s[36:39], s14 offen lds
  s_add_u32 m0, s13, 7168
  s_add_u32 s14, s15, 0xe0000
  buffer_load_dwordx4 v21, s[36:39], s14 offen lds
  s_waitcnt lgkmcnt(0)
  s_add_u32 m0, s13, 8192
  s_add_u32 s14, s15, 0x100000
  buffer_load_dwordx4 v21, s[36:39], s14 offen lds
  s_waitcnt vmcnt(5)
  ds_read_b64_tr_b16 a[0:1], v20 offset:0
  ds_read_b64_tr_b16 a[2:3], v20 offset:256
  ds_read_b64_tr_b16 a[4:5], v20 offset:2048
  ds_read_b64_tr_b16 a[6:7], v20 offset:2304
  ds_read_b64_tr_b16 a[8:9], v20 offset:32
  ds_read_b64_tr_b16 a[10:11], v20 offset:288
  ds_read_b64_tr_b16 a[12:13], v20 offset:2080
  ds_read_b64_tr_b16 a[14:15], v20 offset:2336
  s_add_u32 m0, s13, 9216
  s_add_u32 s14, s15, 0x120000
  buffer_load_dwordx4 v21, s[36:39], s14 offen lds
  s_add_u32 m0, s13, 10240
  s_add_u32 s14, s15, 0x140000
  buffer_load_dwordx4 v21, s[36:39], s14 offen lds
  s_add_u32 m0, s13, 11264
  s_add_u32 s14, s15, 0x160000
  buffer_load_dwordx4 v21, s[36:39], s14 offen lds
  s_waitcnt lgkmcnt(0)
  s_add_u32 m0, s13, 12288
  s_add_u32 s14, s15, 0x180000
  buffer_load_dwordx4 v21, s[36:39], s14 offen lds
  s_waitcnt vmcnt(5)
  ds_read_b64_tr_b16 a[16:17], v20 offset:4096
  ds_read_b64_tr_b16 a[18:19], v20 offset:4352
  ds_read_b64_tr_b16 a[20:21], v20 offset:6144
  ds_read_b64_tr_b16 a[22:23], v20 offset:6400
  ds_read_b64_tr_b16 a[24:25], v20 offset:4128
  ds_read_b64_tr_b16 a[26:27], v20 offset:4384
  ds_read_b64_tr_b16 a[28:29], v20 offset:6176
  ds_read_b64_tr_b16 a[30:31], v20 offset:6432
  s_add_u32 m0, s13, 13312
  s_add_u32 s14, s15, 0x1a0000
  buffer_load_dwordx4 v21, s[36:39], s14 offen lds
  s_add_u32 m0, s13, 14336
  s_add_u32 s14, s15, 0x1c0000
  buffer_load_dwordx4 v21, s[36:39], s14 offen lds
  s_add_u32 m0, s13, 15360
  s_add_u32 s14, s15, 0x1e0000
  buffer_load_dwordx4 v21, s[36:39], s14 offen lds
  s_waitcnt lgkmcnt(0)
  s_add_u32 m0, s13, 16384
  s_add_u32 s14, s15, 0x200000
  buffer_load_dwordx4 v21, s[36:39], s14 offen lds
  s_waitcnt vmcnt(5)
  ds_read_b64_tr_b16 a[32:33], v20 offset:8192
  ds_read_b64_tr_b16 a[34:35], v20 offset:8448
  ds_read_b64_tr_b16 a[36:37], v20 offset:10240
  ds_read_b64_tr_b16 a[38:39], v20 offset:10496
  ds_read_b64_tr_b16 a[40:41], v20 offset:8224
  ds_read_b64_tr_b16 a[42:43], v20 offset:8480
  ds_read_b64_tr_b16 a[44:45], v20 offset:10272
  ds_read_b64_tr_b16 a[46:47], v20 offset:10528
  s_add_u32 m0, s13, 17408
  s_add_u32 s14, s15, 0x220000
  buffer_load_dwordx4 v21, s[36:39], s14 offen lds
  s_add_u32 m0, s13, 18432
  s_add_u32 s14, s15, 0x240000
  buffer_load_dwordx4 v21, s[36:39], s14 offen lds
  s_add_u32 m0, s13, 19456
  s_add_u32 s14, s15, 0x260000
  buffer_load_dwordx4 v21, s[36:39], s14 offen lds
  s_waitcnt lgkmcnt(0)
  s_add_u32 m0, s13, 20480
  s_add_u32 s14, s15, 0x280000
  buffer_load_dwordx4 v21, s[36:39], s14 offen lds
  s_waitcnt vmcnt(5)
  ds_read_b64_tr_b16 a[48:49], v20 offset:12288
  ds_read_b64_tr_b16 a[50:51], v20 offset:12544
  ds_read_b64_tr_b16 a[52:53], v20 offset:14336
  ds_read_b64_tr_b16 a[54:55], v20 offset:14592
  ds_read_b64_tr_b16 a[56:57], v20 offset:12320
  ds_read_b64_tr_b16 a[58:59], v20 offset:12576
  ds_read_b64_tr_b16 a[60:61], v20 offset:14368
  ds_read_b64_tr_b16 a[62:63], v20 offset:14624
  s_add_u32 m0, s13, 21504
  s_add_u32 s14, s15, 0x2a0000
  buffer_load_dwordx4 v21, s[36:39], s14 offen lds
  s_add_u32 m0, s13, 22528
  s_add_u32 s14, s15, 0x2c0000
  buffer_load_dwordx4 v21, s[36:39], s14 offen lds
  s_add_u32 m0, s13, 23552
  s_add_u32 s14, s15, 0x2e0000
  buffer_load_dwordx4 v21, s[36:39], s14 offen lds
  s_waitcnt lgkmcnt(0)
  s_add_u32 m0, s13, 24576
  s_add_u32 s14, s15, 0x300000
  buffer_load_dwordx4 v21, s[36:39], s14 offen lds
  s_waitcnt vmcnt(5)
  ds_read_b64_tr_b16 a[64:65], v20 offset:16384
  ds_read_b64_tr_b16 a[66:67], v20 offset:16640
  ds_read_b64_tr_b16 a[68:69], v20 offset:18432
  ds_read_b64_tr_b16 a[70:71], v20 offset:18688
  ds_read_b64_tr_b16 a[72:73], v20 offset:16416
  ds_read_b64_tr_b16 a[74:75], v20 offset:16672
  ds_read_b64_tr_b16 a[76:77], v20 offset:18464
  ds_read_b64_tr_b16 a[78:79], v20 offset:18720
  s_add_u32 m0, s13, 25600
  s_add_u32 s14, s15, 0x320000
  buffer_load_dwordx4 v21, s[36:39], s14 offen lds
  s_add_u32 m0, s13, 26624
  s_add_u32 s14, s15, 0x340000
  buffer_load_dwordx4 v21, s[36:39], s14 offen lds
  s_add_u32 m0, s13, 27648
  s_add_u32 s14, s15, 0x360000
  buffer_load_dwordx4 v21, s[36:39], s14 offen lds
  s_waitcnt lgkmcnt(0)
  s_add_u32 m0, s13, 28672
  s_add_u32 s14, s15, 0x380000
  buffer_load_dwordx4 v21, s[36:39], s14 offen lds
  s_waitcnt vmcnt(5)
  ds_read_b64_tr_b16 a[80:81], v20 offset:20480
  ds_read_b64_tr_b16 a[82:83], v20 offset:20736
  ds_read_b64_tr_b16 a[84:85], v20 offset:22528
  ds_read_b64_tr_b16 a[86:87], v20 offset:22784
  ds_read_b64_tr_b16 a[88:89], v20 offset:20512
  ds_read_b64_tr_b16 a[90:91], v20 offset:20768
  ds_read_b64_tr_b16 a[92:93], v20 offset:22560
  ds_read_b64_tr_b16 a[94:95], v20 offset:22816
  s_add_u32 m0, s13, 29696
  s_add_u32 s14, s15, 0x3a0000
  buffer_load_dwordx4 v21, s[36:39], s14 offen lds
  s_add_u32 m0, s13, 30720
  s_add_u32 s14, s15, 0x3c0000
  buffer_load_dwordx4 v21, s[36:39], s14 offen lds
  s_add_u32 m0, s13, 31744
  s_add_u32 s14, s15, 0x3e0000
  buffer_load_dwordx4 v21, s[36:39], s14 offen lds
  s_waitcnt lgkmcnt(0)
  s_add_u32 m0, s13, 32768
  s_add_u32 s14, s15, 0x400000
  buffer_load_dwordx4 v21, s[36:39], s14 offen lds
  s_waitcnt vmcnt(5)
  ds_read_b64_tr_b16 a[96:97], v20 offset:24576
  ds_read_b64_tr_b16 a[98:99], v20 offset:24832
  ds_read_b64_tr_b16 a[100:101], v20 offset:26624
  ds_read_b64_tr_b16 a[102:103], v20 offset:26880
  ds_read_b64_tr_b16 a[104:105], v20 offset:24608
  ds_read_b64_tr_b16 a[106:107], v20 offset:24864
  ds_read_b64_tr_b16 a[108:109], v20 offset:26656
  ds_read_b64_tr_b16 a[110:111], v20 offset:26912
  s_add_u32 m0, s13, 33792
  s_add_u32 s14, s15, 0x420000
  buffer_load_dwordx4 v21, s[36:39], s14 offen lds
  s_add_u32 m0, s13, 34816
  s_add_u32 s14, s15, 0x440000
  buffer_load_dwordx4 v21, s[36:39], s14 offen lds
  s_add_u32 m0, s13, 35840
  s_add_u32 s14, s15, 0x460000
  buffer_load_dwordx4 v21, s[36:39], s14 offen lds
  s_waitcnt lgkmcnt(0)
  s_add_u32 m0, s13, 0
  s_add_u32 s14, s15, 0x0
  buffer_load_dwordx4 v21, s[40:43], s14 offen lds
  s_waitcnt vmcnt(5)
  ds_read_b64_tr_b16 a[112:113], v20 offset:28672
  ds_read_b64_tr_b16 a[114:115], v20 offset:28928
  ds_read_b64_tr_b16 a[116:117], v20 offset:30720
  ds_read_b64_tr_b16 a[118:119], v20 offset:30976
  ds_read_b64_tr_b16 a[120:121], v20 offset:28704
  ds_read_b64_tr_b16 a[122:123], v20 offset:28960
  ds_read_b64_tr_b16 a[124:125], v20 offset:30752
  ds_read_b64_tr_b16 a[126:127], v20 offset:31008
  s_add_u32 m0, s13, 1024
  s_add_u32 s14, s15, 0x20000
  buffer_load_dwordx4 v21, s[40:43], s14 offen lds
  s_add_u32 m0, s13, 2048
  s_add_u32 s14, s15, 0x40000
  buffer_load_dwordx4 v21, s[40:43], s14 offen lds
  s_add_u32 m0, s13, 3072
  s_add_u32 s14, s15, 0x60000
  buffer_load_dwordx4 v21, s[40:43], s14 offen lds
  s_waitcnt lgkmcnt(0)
  s_add_u32 m0, s13, 4096
  s_add_u32 s14, s15, 0x80000
  buffer_load_dwordx4 v21, s[40:43], s14 offen lds
  s_waitcnt vmcnt(5)
  ds_read_b64_tr_b16 a[128:129], v20 offset:32768
  ds_read_b64_tr_b16 a[130:131], v20 offset:33024
  ds_read_b64_tr_b16 a[132:133], v20 offset:34816
  ds_read_b64_tr_b16 a[134:135], v20 offset:35072
  ds_read_b64_tr_b16 a[136:137], v20 offset:32800
  ds_read_b64_tr_b16 a[138:139], v20 offset:33056
  ds_read_b64_tr_b16 a[140:141], v20 offset:34848
  ds_read_b64_tr_b16 a[142:143], v20 offset:35104
  s_add_u32 m0, s13, 5120
  s_add_u32 s14, s15, 0xa0000
  buffer_load_dwordx4 v21, s[40:43], s14 offen lds
  s_add_u32 m0, s13, 6144
  s_add_u32 s14, s15, 0xc0000
  buffer_load_dwordx4 v21, s[40:43], s14 offen lds
  s_add_u32 m0, s13, 7168
  s_add_u32 s14, s15, 0xe0000
  buffer_load_dwordx4 v21, s[40:43], s14 offen lds
  s_waitcnt lgkmcnt(0)
  s_add_u32 m0, s13, 8192
  s_add_u32 s14, s15, 0x100000
  buffer_load_dwordx4 v21, s[40:43], s14 offen lds
  s_waitcnt vmcnt(5)
  ds_read_b64_tr_b16 a[144:145], v20 offset:0
  ds_read_b64_tr_b16 a[146:147], v20 offset:256
  ds_read_b64_tr_b16 a[148:149], v20 offset:2048
  ds_read_b64_tr_b16 a[150:151], v20 offset:2304
  ds_read_b64_tr_b16 a[152:153], v20 offset:32
  ds_read_b64_tr_b16 a[154:155], v20 offset:288
  ds_read_b64_tr_b16 a[156:157], v20 offset:2080
  ds_read_b64_tr_b16 a[158:159], v20 offset:2336
  s_add_u32 m0, s13, 9216
  s_add_u32 s14, s15, 0x120000
  buffer_load_dwordx4 v21, s[40:43], s14 offen lds
  s_add_u32 m0, s13, 10240
  s_add_u32 s14, s15, 0x140000
  buffer_load_dwordx4 v21, s[40:43], s14 offen lds
  s_add_u32 m0, s13, 11264
  s_add_u32 s14, s15, 0x160000
  buffer_load_dwordx4 v21, s[40:43], s14 offen lds
  s_waitcnt lgkmcnt(0)
  s_add_u32 m0, s13, 12288
  s_add_u32 s14, s15, 0x180000
  buffer_load_dwordx4 v21, s[40:43], s14 offen lds
  s_waitcnt vmcnt(5)
  ds_read_b64_tr_b16 a[160:161], v20 offset:4096
  ds_read_b64_tr_b16 a[162:163], v20 offset:4352
  ds_read_b64_tr_b16 a[164:165], v20 offset:6144
  ds_read_b64_tr_b16 a[166:167], v20 offset:6400
  ds_read_b64_tr_b16 a[168:169], v20 offset:4128
  ds_read_b64_tr_b16 a[170:171], v20 offset:4384
  ds_read_b64_tr_b16 a[172:173], v20 offset:6176
  ds_read_b64_tr_b16 a[174:175], v20 offset:6432
  s_add_u32 m0, s13, 13312
  s_add_u32 s14, s15, 0x1a0000
  buffer_load_dwordx4 v21, s[40:43], s14 offen lds
  s_add_u32 m0, s13, 14336
  s_add_u32 s14, s15, 0x1c0000
  buffer_load_dwordx4 v21, s[40:43], s14 offen lds
  s_add_u32 m0, s13, 15360
  s_add_u32 s14, s15, 0x1e0000
  buffer_load_dwordx4 v21, s[40:43], s14 offen lds
  s_waitcnt lgkmcnt(0)
  s_add_u32 m0, s13, 16384
  s_add_u32 s14, s15, 0x200000
  buffer_load_dwordx4 v21, s[40:43], s14 offen lds
  s_waitcnt vmcnt(5)
  ds_read_b64_tr_b16 a[176:177], v20 offset:8192
  ds_read_b64_tr_b16 a[178:179], v20 offset:8448
  ds_read_b64_tr_b16 a[180:181], v20 offset:10240
  ds_read_b64_tr_b16 a[182:183], v20 offset:10496
  ds_read_b64_tr_b16 a[184:185], v20 offset:8224
  ds_read_b64_tr_b16 a[186:187], v20 offset:8480
  ds_read_b64_tr_b16 a[188:189], v20 offset:10272
  ds_read_b64_tr_b16 a[190:191], v20 offset:10528
  s_add_u32 m0, s13, 17408
  s_add_u32 s14, s15, 0x220000
  buffer_load_dwordx4 v21, s[40:43], s14 offen lds
  s_add_u32 m0, s13, 18432
  s_add_u32 s14, s15, 0x240000
  buffer_load_dwordx4 v21, s[40:43], s14 offen lds
  s_add_u32 m0, s13, 19456
  s_add_u32 s14, s15, 0x260000
  buffer_load_dwordx4 v21, s[40:43], s14 offen lds
  s_waitcnt lgkmcnt(0)
  s_add_u32 m0, s13, 20480
  s_add_u32 s14, s15, 0x280000
  buffer_load_dwordx4 v21, s[40:43], s14 offen lds
  s_waitcnt vmcnt(5)
  ds_read_b64_tr_b16 a[192:193], v20 offset:12288
  ds_read_b64_tr_b16 a[194:195], v20 offset:12544
  ds_read_b64_tr_b16 a[196:197], v20 offset:14336
  ds_read_b64_tr_b16 a[198:199], v20 offset:14592
  ds_read_b64_tr_b16 a[200:201], v20 offset:12320
  ds_read_b64_tr_b16 a[202:203], v20 offset:12576
  ds_read_b64_tr_b16 a[204:205], v20 offset:14368
  ds_read_b64_tr_b16 a[206:207], v20 offset:14624
  s_add_u32 m0, s13, 21504
  s_add_u32 s14, s15, 0x2a0000
  buffer_load_dwordx4 v21, s[40:43], s14 offen lds
  s_add_u32 m0, s13, 22528
  s_add_u32 s14, s15, 0x2c0000
  buffer_load_dwordx4 v21, s[40:43], s14 offen lds
  s_add_u32 m0, s13, 23552
  s_add_u32 s14, s15, 0x2e0000
  buffer_load_dwordx4 v21, s[40:43], s14 offen lds
  s_waitcnt lgkmcnt(0)
  s_add_u32 m0, s13, 24576
  s_add_u32 s14, s15, 0x300000
  buffer_load_dwordx4 v21, s[40:43], s14 offen lds
  s_waitcnt vmcnt(5)
  ds_read_b64_tr_b16 a[208:209], v20 offset:16384
  ds_read_b64_tr_b16 a[210:211], v20 offset:16640
  ds_read_b64_tr_b16 a[212:213], v20 offset:18432
  ds_read_b64_tr_b16 a[214:215], v20 offset:18688
  ds_read_b64_tr_b16 a[216:217], v20 offset:16416
  ds_read_b64_tr_b16 a[218:219], v20 offset:16672
  ds_read_b64_tr_b16 a[220:221], v20 offset:18464
  ds_read_b64_tr_b16 a[222:223], v20 offset:18720
  s_add_u32 m0, s13, 25600
  s_add_u32 s14, s15, 0x320000
  buffer_load_dwordx4 v21, s[40:43], s14 offen lds
  s_add_u32 m0, s13, 26624
  s_add_u32 s14, s15, 0x340000
  buffer_load_dwordx4 v21, s[40:43], s14 offen lds
  s_add_u32 m0, s13, 27648
  s_add_u32 s14, s15, 0x360000
  buffer_load_dwordx4 v21, s[40:43], s14 offen lds
  s_waitcnt lgkmcnt(0)
  s_add_u32 m0, s13, 28672
  s_add_u32 s14, s15, 0x380000
  buffer_load_dwordx4 v21, s[40:43], s14 offen lds
  s_waitcnt vmcnt(5)
  ds_read_b64_tr_b16 a[224:225], v20 offset:20480
  ds_read_b64_tr_b16 a[226:227], v20 offset:20736
  ds_read_b64_tr_b16 a[228:229], v20 offset:22528
  ds_read_b64_tr_b16 a[230:231], v20 offset:22784
  ds_read_b64_tr_b16 a[232:233], v20 offset:20512
  ds_read_b64_tr_b16 a[234:235], v20 offset:20768
  ds_read_b64_tr_b16 a[236:237], v20 offset:22560
  ds_read_b64_tr_b16 a[238:239], v20 offset:22816
  s_add_u32 m0, s13, 29696
  s_add_u32 s14, s15, 0x3a0000
  buffer_load_dwordx4 v21, s[40:43], s14 offen lds
  s_add_u32 m0, s13, 30720
  s_add_u32 s14, s15, 0x3c0000
  buffer_load_dwordx4 v21, s[40:43], s14 offen lds
  s_add_u32 m0, s13, 31744
  s_add_u32 s14, s15, 0x3e0000
  buffer_load_dwordx4 v21, s[40:43], s14 offen lds
  s_waitcnt lgkmcnt(0)
  s_add_u32 m0, s13, 32768
  s_add_u32 s14, s15, 0x400000
  buffer_load_dwordx4 v21, s[40:43], s14 offen lds
  s_waitcnt vmcnt(5)
  ds_read_b64_tr_b16 a[240:241], v20 offset:24576
  ds_read_b64_tr_b16 a[242:243], v20 offset:24832
  ds_read_b64_tr_b16 a[244:245], v20 offset:26624
  ds_read_b64_tr_b16 a[246:247], v20 offset:26880
  ds_read_b64_tr_b16 a[248:249], v20 offset:24608
  ds_read_b64_tr_b16 a[250:251], v20 offset:24864
  ds_read_b64_tr_b16 a[252:253], v20 offset:26656
  ds_read_b64_tr_b16 a[254:255], v20 offset:26912
  s_add_u32 m0, s13, 33792
  s_add_u32 s14, s15, 0x420000
  buffer_load_dwordx4 v21, s[40:43], s14 offen lds
  s_add_u32 m0, s13, 34816
  s_add_u32 s14, s15, 0x440000
  buffer_load_dwordx4 v21, s[40:43], s14 offen lds
  s_add_u32 m0, s13, 35840
  s_add_u32 s14, s15, 0x460000
  buffer_load_dwordx4 v21, s[40:43], s14 offen lds
  s_waitcnt lgkmcnt(0)
  s_add_u32 m0, s13, 0
  s_add_u32 s14, s15, 0x0
  buffer_load_dwordx4 v21, s[32:35], s14 offen lds
  s_waitcnt vmcnt(5)
  ds_read_b64_tr_b16 v[80:81], v20 offset:28672
  ds_read_b64_tr_b16 v[82:83], v20 offset:28928
  ds_read_b64_tr_b16 v[84:85], v20 offset:30720
  ds_read_b64_tr_b16 v[86:87], v20 offset:30976
  ds_read_b64_tr_b16 v[88:89], v20 offset:28704
  ds_read_b64_tr_b16 v[90:91], v20 offset:28960
  ds_read_b64_tr_b16 v[92:93], v20 offset:30752
  ds_read_b64_tr_b16 v[94:95], v20 offset:31008
  s_add_u32 m0, s13, 1024
  s_add_u32 s14, s15, 0x20000
  buffer_load_dwordx4 v21, s[32:35], s14 offen lds
  s_add_u32 m0, s13, 2048
  s_add_u32 s14, s15, 0x40000
  buffer_load_dwordx4 v21, s[32:35], s14 offen lds
  s_add_u32 m0, s13, 3072
  s_add_u32 s14, s15, 0x60000
  buffer_load_dwordx4 v21, s[32:35], s14 offen lds
  s_waitcnt lgkmcnt(0)
  s_add_u32 m0, s13, 4096
  s_add_u32 s14, s15, 0x80000
  buffer_load_dwordx4 v21, s[32:35], s14 offen lds
  s_waitcnt vmcnt(5)
  ds_read_b64_tr_b16 v[96:97], v20 offset:32768
  ds_read_b64_tr_b16 v[98:99], v20 offset:33024
  ds_read_b64_tr_b16 v[100:101], v20 offset:34816
  ds_read_b64_tr_b16 v[102:103], v20 offset:35072
  ds_read_b64_tr_b16 v[104:105], v20 offset:32800
  ds_read_b64_tr_b16 v[106:107], v20 offset:33056
  ds_read_b64_tr_b16 v[108:109], v20 offset:34848
  ds_read_b64_tr_b16 v[110:111], v20 offset:35104
  s_add_u32 m0, s13, 5120
  s_add_u32 s14, s15, 0xa0000
  buffer_load_dwordx4 v21, s[32:35], s14 offen lds
  s_add_u32 m0, s13, 6144
  s_add_u32 s14, s15, 0xc0000
  buffer_load_dwordx4 v21, s[32:35], s14 offen lds
  s_add_u32 m0, s13, 7168
  s_add_u32 s14, s15, 0xe0000
  buffer_load_dwordx4 v21, s[32:35], s14 offen lds
  s_waitcnt lgkmcnt(0)
  s_add_u32 m0, s13, 8192
  s_add_u32 s14, s15, 0x100000
  buffer_load_dwordx4 v21, s[32:35], s14 offen lds
  s_waitcnt vmcnt(5)
  ds_read_b64_tr_b16 v[112:113], v20 offset:0
  ds_read_b64_tr_b16 v[114:115], v20 offset:256
  ds_read_b64_tr_b16 v[116:117], v20 offset:2048
  ds_read_b64_tr_b16 v[118:119], v20 offset:2304
  ds_read_b64_tr_b16 v[120:121], v20 offset:32
  ds_read_b64_tr_b16 v[122:123], v20 offset:288
  ds_read_b64_tr_b16 v[124:125], v20 offset:2080
  ds_read_b64_tr_b16 v[126:127], v20 offset:2336
  s_add_u32 m0, s13, 9216
  s_add_u32 s14, s15, 0x120000
  buffer_load_dwordx4 v21, s[32:35], s14 offen lds
  s_add_u32 m0, s13, 10240
  s_add_u32 s14, s15, 0x140000
  buffer_load_dwordx4 v21, s[32:35], s14 offen lds
  s_add_u32 m0, s13, 11264
  s_add_u32 s14, s15, 0x160000
  buffer_load_dwordx4 v21, s[32:35], s14 offen lds
  s_waitcnt lgkmcnt(0)
  s_add_u32 m0, s13, 12288
  s_add_u32 s14, s15, 0x180000
  buffer_load_dwordx4 v21, s[32:35], s14 offen lds
  s_waitcnt vmcnt(5)
  ds_read_b64_tr_b16 v[128:129], v20 offset:4096
  ds_read_b64_tr_b16 v[130:131], v20 offset:4352
  ds_read_b64_tr_b16 v[132:133], v20 offset:6144
  ds_read_b64_tr_b16 v[134:135], v20 offset:6400
  ds_read_b64_tr_b16 v[136:137], v20 offset:4128
  ds_read_b64_tr_b16 v[138:139], v20 offset:4384
  ds_read_b64_tr_b16 v[140:141], v20 offset:6176
  ds_read_b64_tr_b16 v[142:143], v20 offset:6432
  s_add_u32 m0, s13, 13312
  s_add_u32 s14, s15, 0x1a0000
  buffer_load_dwordx4 v21, s[32:35], s14 offen lds
  s_add_u32 m0, s13, 14336
  s_add_u32 s14, s15, 0x1c0000
  buffer_load_dwordx4 v21, s[32:35], s14 offen lds
  s_add_u32 m0, s13, 15360
  s_add_u32 s14, s15, 0x1e0000
  buffer_load_dwordx4 v21, s[32:35], s14 offen lds
  s_waitcnt lgkmcnt(0)
  s_add_u32 m0, s13, 16384
  s_add_u32 s14, s15, 0x200000
  buffer_load_dwordx4 v21, s[32:35], s14 offen lds
  s_waitcnt vmcnt(5)
  ds_read_b64_tr_b16 v[144:145], v20 offset:8192
  ds_read_b64_tr_b16 v[146:147], v20 offset:8448
  ds_read_b64_tr_b16 v[148:149], v20 offset:10240
  ds_read_b64_tr_b16 v[150:151], v20 offset:10496
  ds_read_b64_tr_b16 v[152:153], v20 offset:8224
  ds_read_b64_tr_b16 v[154:155], v20 offset:8480
  ds_read_b64_tr_b16 v[156:157], v20 offset:10272
  ds_read_b64_tr_b16 v[158:159], v20 offset:10528
  s_add_u32 m0, s13, 17408
  s_add_u32 s14, s15, 0x220000
  buffer_load_dwordx4 v21, s[32:35], s14 offen lds
  s_add_u32 m0, s13, 18432
  s_add_u32 s14, s15, 0x240000
  buffer_load_dwordx4 v21, s[32:35], s14 offen lds
  s_add_u32 m0, s13, 19456
  s_add_u32 s14, s15, 0x260000
  buffer_load_dwordx4 v21, s[32:35], s14 offen lds
  s_waitcnt lgkmcnt(0)
  s_add_u32 m0, s13, 20480
  s_add_u32 s14, s15, 0x280000
  buffer_load_dwordx4 v21, s[32:35], s14 offen lds
  s_waitcnt vmcnt(5)
  ds_read_b64_tr_b16 v[160:161], v20 offset:12288
  ds_read_b64_tr_b16 v[162:163], v20 offset:12544
  ds_read_b64_tr_b16 v[164:165], v20 offset:14336
  ds_read_b64_tr_b16 v[166:167], v20 offset:14592
  ds_read_b64_tr_b16 v[168:169], v20 offset:12320
  ds_read_b64_tr_b16 v[170:171], v20 offset:12576
  ds_read_b64_tr_b16 v[172:173], v20 offset:14368
  ds_read_b64_tr_b16 v[174:175], v20 offset:14624
  s_add_u32 m0, s13, 21504
  s_add_u32 s14, s15, 0x2a0000
  buffer_load_dwordx4 v21, s[32:35], s14 offen lds
  s_add_u32 m0, s13, 22528
  s_add_u32 s14, s15, 0x2c0000
  buffer_load_dwordx4 v21, s[32:35], s14 offen lds
  s_add_u32 m0, s13, 23552
  s_add_u32 s14, s15, 0x2e0000
  buffer_load_dwordx4 v21, s[32:35], s14 offen lds
  s_waitcnt lgkmcnt(0)
  s_add_u32 m0, s13, 24576
  s_add_u32 s14, s15, 0x300000
  buffer_load_dwordx4 v21, s[32:35], s14 offen lds
  s_waitcnt vmcnt(5)
  s_load_dwordx2 s[100:101], s[0:1], 112
  v_and_b32 v12, 7, v0
  v_lshlrev_b32 v12, 5, v12
  s_waitcnt lgkmcnt(0)
.cw_32:
  global_load_dword v13, v12, s[100:101] offset:4 sc1
  s_waitcnt vmcnt(0)
  v_cmp_gt_u32 vcc, 32, v13
  s_cbranch_vccz .cd_33
  s_sleep 2
  s_sub_u32 s10, s10, 1
  s_cbranch_scc0 .cw_32
  s_mov_b32 s10, 0
.cd_33:
  s_getpc_b64 s[100:101]
.wm_34:
  s_sub_u32 s100, s100, .wm_34-interleave_layers__ssm_conv_h3__memory_aug_recurrent_mem_tr__prompt_kernel
  s_subb_u32 s101, s101, 0
  s_lshl_b32 s99, s9, 2
  s_add_u32 s99, s99, s3
  s_lshl_b32 s99, s99, 10
  v_lshlrev_b32 v8, 4, v0
  v_add_u32 v8, s99, v8
  v_min_u32 v8, .code_end-interleave_layers__ssm_conv_h3__memory_aug_recurrent_mem_tr__prompt_kernel-16, v8
  global_load_dwordx4 v[8:11], v8, s[100:101]
  ds_read_b64_tr_b16 v[176:177], v20 offset:16384
  ds_read_b64_tr_b16 v[178:179], v20 offset:16640
  ds_read_b64_tr_b16 v[180:181], v20 offset:18432
  ds_read_b64_tr_b16 v[182:183], v20 offset:18688
  ds_read_b64_tr_b16 v[184:185], v20 offset:16416
  ds_read_b64_tr_b16 v[186:187], v20 offset:16672
  ds_read_b64_tr_b16 v[188:189], v20 offset:18464
  ds_read_b64_tr_b16 v[190:191], v20 offset:18720
  s_add_u32 m0, s13, 25600
  s_add_u32 s14, s15, 0x320000
  buffer_load_dwordx4 v21, s[32:35], s14 offen lds
  s_add_u32 m0, s13, 26624
  s_add_u32 s14, s15, 0x340000
  buffer_load_dwordx4 v21, s[32:35], s14 offen lds
  s_add_u32 m0, s13, 27648
  s_add_u32 s14, s15, 0x360000
  buffer_load_dwordx4 v21, s[32:35], s14 offen lds
  s_waitcnt lgkmcnt(0)
  s_add_u32 m0, s13, 28672
  s_add_u32 s14, s15, 0x380000
  buffer_load_dwordx4 v21, s[32:35], s14 offen lds
  ds_read_b64_tr_b16 v[192:193], v20 offset:20480
  ds_read_b64_tr_b16 v[194:195], v20 offset:20736
  ds_read_b64_tr_b16 v[196:197], v20 offset:22528
  ds_read_b64_tr_b16 v[198:199], v20 offset:22784
  ds_read_b64_tr_b16 v[200:201], v20 offset:20512
  ds_read_b64_tr_b16 v[202:203], v20 offset:20768
  ds_read_b64_tr_b16 v[204:205], v20 offset:22560
  ds_read_b64_tr_b16 v[206:207], v20 offset:22816
  s_add_u32 m0, s13, 29696
  s_add_u32 s14, s15, 0x3a0000
  buffer_load_dwordx4 v21, s[32:35], s14 offen lds
  s_add_u32 m0, s13, 30720
  s_add_u32 s14, s15, 0x3c0000
  buffer_load_dwordx4 v21, s[32:35], s14 offen lds
  s_add_u32 m0, s13, 31744
  s_add_u32 s14, s15, 0x3e0000
  buffer_load_dwordx4 v21, s[32:35], s14 offen lds
  s_waitcnt lgkmcnt(0)
  s_add_u32 m0, s13, 32768
  s_add_u32 s14, s15, 0x400000
  buffer_load_dwordx4 v21, s[32:35], s14 offen lds
  s_waitcnt vmcnt(5)
  ds_read_b64_tr_b16 v[208:209], v20 offset:24576
  ds_read_b64_tr_b16 v[210:211], v20 offset:24832
  ds_read_b64_tr_b16 v[212:213], v20 offset:26624
  ds_read_b64_tr_b16 v[214:215], v20 offset:26880
  ds_read_b64_tr_b16 v[216:217], v20 offset:24608
  ds_read_b64_tr_b16 v[218:219], v20 offset:24864
  ds_read_b64_tr_b16 v[220:221], v20 offset:26656
  ds_read_b64_tr_b16 v[222:223], v20 offset:26912
  s_add_u32 m0, s13, 33792
  s_add_u32 s14, s15, 0x420000
  buffer_load_dwordx4 v21, s[32:35], s14 offen lds
  s_add_u32 m0, s13, 34816
  s_add_u32 s14, s15, 0x440000
  buffer_load_dwordx4 v21, s[32:35], s14 offen lds
  s_add_u32 m0, s13, 35840
  s_add_u32 s14, s15, 0x460000
  buffer_load_dwordx4 v21, s[32:35], s14 offen lds
  s_waitcnt lgkmcnt(0)
  s_waitcnt vmcnt(4)
  ds_read_b64_tr_b16 v[224:225], v20 offset:28672
  ds_read_b64_tr_b16 v[226:227], v20 offset:28928
  ds_read_b64_tr_b16 v[228:229], v20 offset:30720
  ds_read_b64_tr_b16 v[230:231], v20 offset:30976
  ds_read_b64_tr_b16 v[232:233], v20 offset:28704
  ds_read_b64_tr_b16 v[234:235], v20 offset:28960
  ds_read_b64_tr_b16 v[236:237], v20 offset:30752
  ds_read_b64_tr_b16 v[238:239], v20 offset:31008
  s_waitcnt lgkmcnt(0)
  s_waitcnt vmcnt(0)
  ds_read_b64_tr_b16 v[240:241], v20 offset:32768
  ds_read_b64_tr_b16 v[242:243], v20 offset:33024
  ds_read_b64_tr_b16 v[244:245], v20 offset:34816
  ds_read_b64_tr_b16 v[246:247], v20 offset:35072
  ds_read_b64_tr_b16 v[248:249], v20 offset:32800
  ds_read_b64_tr_b16 v[250:251], v20 offset:33056
  ds_read_b64_tr_b16 v[252:253], v20 offset:34848
  ds_read_b64_tr_b16 v[254:255], v20 offset:35104
  s_waitcnt lgkmcnt(0)
  s_and_b32 s14, s3, 1
  s_lshl_b32 s14, s14, 4
  v_and_b32 v24, 15, v0
  v_add_u32 v24, s14, v24
  v_lshrrev_b32 v25, 4, v0
  v_lshlrev_b32 v25, 2, v25
  v_sub_u32 v24, v24, v25
  v_cmp_le_i32 s[64:65], 0, v24
  v_cmp_le_i32 s[66:67], 1, v24
  v_cmp_le_i32 s[68:69], 2, v24
  v_cmp_le_i32 s[70:71], 3, v24
  v_cmp_le_i32 s[72:73], 16, v24
  v_cmp_le_i32 s[74:75], 17, v24
  v_cmp_le_i32 s[76:77], 18, v24
  v_cmp_le_i32 s[78:79], 19, v24
  v_lshrrev_b32 v1, 2, v0
  v_mul_u32_u24 v1, 1152, v1
  v_and_b32 v24, 3, v0
  v_lshlrev_b32 v24, 4, v24
  v_and_b32 v25, 32, v0
  v_xor_b32 v24, v24, v25
  v_add_u32 v1, v1, v24
  v_bfe_u32 v3, v0, 0, 4
  v_lshlrev_b32 v3, 6, v3
  v_bfe_u32 v24, v0, 4, 2
  v_lshl_add_u32 v3, v24, 4, v3
  v_and_b32 v24, 8, v0
  v_lshlrev_b32 v24, 2, v24
  v_xor_b32 v3, v3, v24
  v_bfe_u32 v2, v0, 4, 2
  v_lshlrev_b32 v2, 4, v2
  v_bfe_u32 v24, v0, 2, 2
  v_lshl_add_u32 v2, v24, 7, v2
  v_bfe_u32 v24, v0, 0, 1
  v_lshl_add_u32 v2, v24, 6, v2
  v_add_u32 v2, 147456, v2
  v_bfe_u32 v24, v0, 2, 2
  v_lshlrev_b32 v24, 4, v24
  v_xor_b32 v2, v2, v24
  v_lshlrev_b32 v0, 4, v0
  s_mov_b32 s18, 0x3e0293ee
  s_mov_b32 s52, 0
  s_mov_b32 s19, 0
  s_mul_i32 s22, s11, 0
  s_add_u32 s22, s22, 3
  s_mov_b32 s25, 0
  s_lshl_b32 s24, s3, 10
  s_mul_i32 s53, s11, 0x500000
  s_add_u32 s53, s53, 0x700000
  s_mul_i32 s14, s16, 36864
  s_add_u32 s53, s53, s14
  s_and_b32 s61, s3, 1
  s_mul_i32 s14, s61, 18432
  s_add_u32 s53, s53, s14
  s_lshl_b32 s17, s61, 10
  s_lshl_b32 s20, s61, 12
  s_lshr_b32 s61, s3, 1
  s_mul_i32 s14, s61, 576
  s_add_u32 s53, s53, s14
  s_mul_i32 s14, s61, 18432
  s_add_u32 s17, s17, s14
  s_lshl_b32 s21, s61, 12
  s_lshl_b32 s61, s11, 5
  s_add_u32 s61, s61, s12
  s_lshl_b32 s14, s61, 6
  s_add_u32 s14, s14, s16
  s_lshl_b32 s54, s14, 14
  s_add_u32 s54, s54, 0x4000000
  s_lshl_b32 s55, s14, 12
  s_add_u32 s55, s55, 0xd000000
  s_add_u32 s55, s55, s24
  s_mov_b32 s59, s55
  s_lshl_b32 s56, s14, 13
  s_add_u32 s56, s56, 0x2000000
  s_lshl_b32 s14, s61, 1
  s_add_u32 s14, s14, s16
  s_lshl_b32 s57, s14, 6
  s_add_u32 s57, s57, s3
  s_lshl_b32 s57, s57, 1
  s_add_u32 s57, s57, 0x0
  s_lshl_b32 s14, s11, 1
  s_add_u32 s14, s14, s16
  s_lshl_b32 s14, s14, 5
  s_add_u32 s14, s14, s12
  s_lshl_b32 s58, s14, 2
  s_add_u32 s58, s58, s3
  s_lshl_b32 s58, s58, 7
  s_add_u32 s58, s58, 0x20000
  s_lshl_b32 s23, s16, 1
  s_and_b32 s14, s3, 1
  s_add_u32 s23, s23, s14
  s_cmp_eq_u32 s11, 0
  s_cselect_b32 s26, 2048, 0
  s_cselect_b32 s27, 2, 4
  s_cselect_b32 s14, 9, 11
  s_cselect_b32 s61, 0, 0x4000
  s_lshl_b32 s23, s23, s14
  s_add_u32 s23, s23, s61
  s_add_u32 s23, s23, 0x10000
  s_mov_b32 s62, 73728
  s_mov_b32 s63, 73728
  s_add_u32 s56, s56, s21
  s_lshr_b32 s14, s20, 2
  s_add_u32 s56, s56, s14
  s_barrier
  v_mov_b32 v7, 0
.ql_35:
  s_add_u32 s60, s52, 1
  s_waitcnt vmcnt(2)
  v_cmp_gt_u32 vcc, s60, v7
  s_lshr_b32 s14, s52, 5
  s_or_b32 s14, s14, s25
  s_cbranch_scc1 .qnh_36
  s_cbranch_vccnz .qnh_36
  s_add_u32 m0, s17, 0
  s_nop 0
  buffer_load_dwordx4 v1, s[4:7], s53 offen offset:0 sc1 lds
  s_add_u32 m0, s17, 1984
  s_nop 0
  buffer_load_dwordx4 v1, s[4:7], s53 offen offset:64 sc1 lds
  s_add_u32 m0, s17, 3968
  s_nop 0
  buffer_load_dwordx4 v1, s[4:7], s53 offen offset:128 sc1 lds
  s_add_u32 m0, s17, 5952
  s_nop 0
  buffer_load_dwordx4 v1, s[4:7], s53 offen offset:192 sc1 lds
  s_add_u32 m0, s17, 7936
  s_nop 0
  buffer_load_dwordx4 v1, s[4:7], s53 offen offset:256 sc1 lds
  s_add_u32 m0, s17, 9920
  s_nop 0
  buffer_load_dwordx4 v1, s[4:7], s53 offen offset:320 sc1 lds
  s_add_u32 m0, s17, 11904
  s_nop 0
  buffer_load_dwordx4 v1, s[4:7], s53 offen offset:384 sc1 lds
  s_add_u32 m0, s17, 13888
  s_nop 0
  buffer_load_dwordx4 v1, s[4:7], s53 offen offset:448 sc1 lds
  s_add_u32 m0, s17, 15872
  s_nop 0
  buffer_load_dwordx4 v1, s[4:7], s53 offen offset:512 sc1 lds
  s_mov_b32 s25, 2
.qnh_36:
  s_cmp_lt_u32 s52, s22
  s_cbranch_scc1 .qna_37w
  v_add_u32 v4, s63, v0
  v_add_u32 v5, s20, v4
  ds_read_b128 v[24:27], v5 offset:0
  ds_read_b128 v[28:31], v5 offset:1024
  ds_read_b128 v[32:35], v5 offset:2048
  ds_read_b128 v[36:39], v5 offset:3072
  ds_read_b128 v[40:43], v4 offset:8192
  ds_read_b128 v[44:47], v4 offset:9216
  ds_read_b128 v[48:51], v4 offset:10240
  ds_read_b128 v[52:55], v4 offset:11264
  ds_read_b128 v[56:59], v4 offset:12288
  ds_read_b128 v[60:63], v4 offset:13312
  ds_read_b128 v[64:67], v4 offset:14336
  ds_read_b128 v[68:71], v4 offset:15360
  v_add_u32 v5, s21, v4
  s_add_u32 s14, s24, 147456
  v_add_u32 v6, s14, v0
  s_lshr_b32 s14, s21, 2
  s_add_u32 s14, s14, 149504
  v_lshrrev_b32 v7, 2, v0
  v_and_b32 v4, 0xc0, v7
  v_add3_u32 v7, s14, v7, v4
  v_lshrrev_b32 v4, 2, v4
  v_xor_b32 v7, v7, v4
  s_waitcnt lgkmcnt(7)
  v_mfma_f32_16x16x32_bf16 v[72:75], v[40:43], v[24:27], 0
  s_waitcnt lgkmcnt(6)
  v_mfma_f32_16x16x32_bf16 v[72:75], v[44:47], v[28:31], v[72:75]
  s_waitcnt lgkmcnt(5)
  v_mfma_f32_16x16x32_bf16 v[72:75], v[48:51], v[32:35], v[72:75]
  s_waitcnt lgkmcnt(4)
  v_mfma_f32_16x16x32_bf16 v[72:75], v[52:55], v[36:39], v[72:75]
  s_waitcnt lgkmcnt(3)
  v_mfma_f32_16x16x32_bf16 v[76:79], v[56:59], v[24:27], 0
  s_waitcnt lgkmcnt(2)
  v_mfma_f32_16x16x32_bf16 v[76:79], v[60:63], v[28:31], v[76:79]
  s_waitcnt lgkmcnt(1)
  v_mfma_f32_16x16x32_bf16 v[76:79], v[64:67], v[32:35], v[76:79]
  s_waitcnt lgkmcnt(0)
  v_mfma_f32_16x16x32_bf16 v[76:79], v[68:71], v[36:39], v[76:79]
  ds_read_b128 v[56:59], v5 offset:16384
  ds_read_b128 v[60:63], v5 offset:17408
  ds_read_b128 v[64:67], v5 offset:18432
  ds_read_b128 v[68:71], v5 offset:19456
  v_mov_b32 v44, 0xff800000
  v_mov_b32 v48, 0x3f803f80
  v_mov_b32 v49, 0x3f803f80
  v_mov_b32 v50, 0x3f803f80
  v_mov_b32 v51, 0x3f803f80
  v_cndmask_b32 v72, v44, v72, s[64:65]
  v_cndmask_b32 v73, v44, v73, s[66:67]
  v_cndmask_b32 v74, v44, v74, s[68:69]
  v_cndmask_b32 v75, v44, v75, s[70:71]
  v_cndmask_b32 v76, v44, v76, s[72:73]
  v_cndmask_b32 v77, v44, v77, s[74:75]
  v_cndmask_b32 v78, v44, v78, s[76:77]
  v_cndmask_b32 v79, v44, v79, s[78:79]
  v_max3_f32 v45, v72, v73, v74
  v_max3_f32 v45, v45, v75, v76
  v_max3_f32 v45, v45, v77, v78
  v_max_f32 v45, v45, v79
.mp_40:
  s_waitcnt vmcnt(0)
  v_max3_u32 v46, v12, v13, v14
  v_max_u32 v46, v46, v15
  v_cmp_eq_u32 vcc, -1, v46
  s_cbranch_vccz .md_41
  s_sleep 3
  buffer_load_dwordx4 v[12:15], v0, s[4:7], s55 offen sc1
  s_sub_u32 s10, s10, 1
  s_cbranch_scc0 .mp_40
  s_mov_b32 s10, 0
.md_41:
  s_waitcnt vmcnt(0)
  ds_write_b128 v6, v[12:15]
  s_waitcnt lgkmcnt(0)
  s_barrier
  ds_read_b128 v[8:11], v2 offset:0
  ds_read_b128 v[12:15], v2 offset:512
  ds_read_b128 v[16:19], v2 offset:1024
  ds_read_b128 v[20:23], v2 offset:1536
  ds_read2_b32 v[4:5], v7 offset1:16
  ds_read2_b32 v[6:7], v7 offset0:128 offset1:144
  s_waitcnt lgkmcnt(5)
  v_mfma_f32_16x16x32_bf16 v[40:43], v[8:11], v[24:27], 0
  s_waitcnt lgkmcnt(4)
  v_mfma_f32_16x16x32_bf16 v[40:43], v[12:15], v[28:31], v[40:43]
  s_waitcnt lgkmcnt(3)
  v_mfma_f32_16x16x32_bf16 v[40:43], v[16:19], v[32:35], v[40:43]
  s_waitcnt lgkmcnt(2)
  v_mfma_f32_16x16x32_bf16 v[40:43], v[20:23], v[36:39], v[40:43]
  s_nop 7
  v_max3_f32 v45, v45, v40, v41
  v_mov_b32 v46, v45
  s_nop 1
  v_permlane16_swap_b32 v46, v45
  v_max_f32 v45, v45, v46
  v_mov_b32 v46, v45
  s_nop 1
  v_permlane32_swap_b32 v46, v45
  v_max_f32 v45, v45, v46
  v_mul_f32 v45, s18, v45
  v_fma_f32 v72, v72, s18, -v45
  v_fma_f32 v73, v73, s18, -v45
  v_fma_f32 v74, v74, s18, -v45
  v_fma_f32 v75, v75, s18, -v45
  v_fma_f32 v76, v76, s18, -v45
  v_fma_f32 v77, v77, s18, -v45
  v_fma_f32 v78, v78, s18, -v45
  v_fma_f32 v79, v79, s18, -v45
  v_fma_f32 v40, v40, s18, -v45
  v_fma_f32 v41, v41, s18, -v45
  v_exp_f32 v72, v72
  v_exp_f32 v73, v73
  v_exp_f32 v74, v74
  v_exp_f32 v75, v75
  v_exp_f32 v76, v76
  v_exp_f32 v77, v77
  v_exp_f32 v78, v78
  v_exp_f32 v79, v79
  v_exp_f32 v40, v40
  v_exp_f32 v41, v41
  v_cvt_pk_bf16_f32 v8, v72, v73
  v_cvt_pk_bf16_f32 v9, v74, v75
  v_cvt_pk_bf16_f32 v10, v76, v77
  v_cvt_pk_bf16_f32 v11, v78, v79
  v_cvt_pk_bf16_f32 v12, v40, v41
  v_mov_b32 v13, 0
  v_mov_b32 v14, 0
  v_cvt_pk_bf16_f32 v15, v40, v41
  v_mfma_f32_16x16x32_bf16 v[52:55], v[48:51], v[8:11], 0
  v_mfma_f32_16x16x32_bf16 v[24:27], v[56:59], v[8:11], 0
  v_mfma_f32_16x16x32_bf16 v[28:31], v[60:63], v[8:11], 0
  v_mfma_f32_16x16x32_bf16 v[32:35], v[64:67], v[8:11], 0
  v_mfma_f32_16x16x32_bf16 v[36:39], v[68:71], v[8:11], 0
  v_mfma_f32_16x16x16_bf16 v[52:55], v[48:49], v[12:13], v[52:55]
  s_waitcnt lgkmcnt(1)
  v_mfma_f32_16x16x16_bf16 v[24:27], v[4:5], v[12:13], v[24:27]
  v_mfma_f32_16x16x16_bf16 v[28:31], v[4:5], v[14:15], v[28:31]
  s_waitcnt lgkmcnt(0)
  v_mfma_f32_16x16x16_bf16 v[32:35], v[6:7], v[12:13], v[32:35]
  v_mfma_f32_16x16x16_bf16 v[36:39], v[6:7], v[14:15], v[36:39]
  s_add_u32 s19, s19, 1
  s_add_u32 s55, s55, 8192
  s_add_u32 s63, s63, 24576
  s_cmp_eq_u32 s63, 147456
  s_cselect_b32 s63, 73728, s63
  v_rcp_f32 v52, v52
  s_nop 0
  v_pk_mul_f32 v[24:25], v[24:25], v[52:53] op_sel_hi:[1,0]
  v_pk_mul_f32 v[26:27], v[26:27], v[52:53] op_sel_hi:[1,0]
  v_pk_mul_f32 v[28:29], v[28:29], v[52:53] op_sel_hi:[1,0]
  v_pk_mul_f32 v[30:31], v[30:31], v[52:53] op_sel_hi:[1,0]
  v_pk_mul_f32 v[32:33], v[32:33], v[52:53] op_sel_hi:[1,0]
  v_pk_mul_f32 v[34:35], v[34:35], v[52:53] op_sel_hi:[1,0]
  v_pk_mul_f32 v[36:37], v[36:37], v[52:53] op_sel_hi:[1,0]
  v_pk_mul_f32 v[38:39], v[38:39], v[52:53] op_sel_hi:[1,0]
  v_cvt_pk_bf16_f32 v24, v24, v25
  v_cvt_pk_bf16_f32 v25, v26, v27
  v_cvt_pk_bf16_f32 v26, v28, v29
  v_cvt_pk_bf16_f32 v27, v30, v31
  v_cvt_pk_bf16_f32 v28, v32, v33
  v_cvt_pk_bf16_f32 v29, v34, v35
  v_cvt_pk_bf16_f32 v30, v36, v37
  v_cvt_pk_bf16_f32 v31, v38, v39
  buffer_store_dwordx4 v[24:27], v0, s[4:7], s56 offen sc1
  buffer_store_dwordx4 v[28:31], v0, s[4:7], s56 offen offset:2048 sc1
  s_add_u32 s56, s56, 16384
  v_mov_b32 v12, -1
.qna_37:
  s_cmp_eq_u32 s25, 1
  s_cbranch_scc1 .qn2_39
  s_cmp_eq_u32 s25, 2
  s_cbranch_scc1 .q2_43
  v_mov_b32 v10, s19
  v_bfe_u32 v9, v0, 4, s27
  v_lshlrev_b32 v9, 7, v9
  buffer_load_dword v8, v9, s[4:7], s23 offen sc1
  s_waitcnt vmcnt(0)
  v_cmp_gt_u32 vcc, s60, v8
  s_cmp_ge_u32 s52, 32
  s_cselect_b64 vcc, -1, vcc
  s_cbranch_vccz .q1_42
  buffer_store_dword v10, off, s[4:7], s58 sc1
  s_cbranch_scc1 .qnp_38
.pl_44:
  buffer_load_dword v8, v9, s[4:7], s23 offen offset:0 sc1
  s_waitcnt vmcnt(0)
  v_cmp_gt_u32 vcc, s60, v8
  s_cbranch_vccz .pd_45
  s_sleep 1
  s_sub_u32 s10, s10, 1
  s_cbranch_scc0 .pl_44
  s_mov_b32 s10, 0
.pd_45:
.q1_42:
  s_add_u32 m0, s17, 0
  s_nop 0
  buffer_load_dwordx4 v1, s[4:7], s53 offen offset:0 sc1 lds
  s_add_u32 m0, s17, 1984
  s_nop 0
  buffer_load_dwordx4 v1, s[4:7], s53 offen offset:64 sc1 lds
  s_add_u32 m0, s17, 3968
  s_nop 0
  buffer_load_dwordx4 v1, s[4:7], s53 offen offset:128 sc1 lds
  s_add_u32 m0, s17, 5952
  s_nop 0
  buffer_load_dwordx4 v1, s[4:7], s53 offen offset:192 sc1 lds
  s_add_u32 m0, s17, 7936
  s_nop 0
  buffer_load_dwordx4 v1, s[4:7], s53 offen offset:256 sc1 lds
  s_add_u32 m0, s17, 9920
  s_nop 0
  buffer_load_dwordx4 v1, s[4:7], s53 offen offset:320 sc1 lds
  s_add_u32 m0, s17, 11904
  s_nop 0
  buffer_load_dwordx4 v1, s[4:7], s53 offen offset:384 sc1 lds
  s_add_u32 m0, s17, 13888
  s_nop 0
  buffer_load_dwordx4 v1, s[4:7], s53 offen offset:448 sc1 lds
  s_add_u32 m0, s17, 15872
  s_nop 0
  buffer_load_dwordx4 v1, s[4:7], s53 offen offset:512 sc1 lds
  buffer_store_dword v10, off, s[4:7], s58 sc1
  buffer_store_dword v10, off, s[4:7], s58 sc1
.q2_43:
  s_waitcnt vmcnt(2)
.qn2_39:
  v_mov_b64 v[4:5], -1
  v_mov_b64 v[6:7], -1
  s_add_u32 s60, s52, 2
  s_mov_b32 s80, s53
  s_add_u32 s53, s53, 73728
  s_add_u32 s15, s23, s26
  s_and_b32 s15, s15, 0x3fff
  s_andn2_b32 s23, s23, 0x3fff
  s_or_b32 s23, s23, s15
  s_add_u32 s17, s17, 36864
  s_cmp_ge_u32 s17, 73728
  s_cselect_b32 s15, 73728, 0
  s_sub_u32 s17, s17, s15
  s_barrier
  ds_read_b128 v[56:59], v3 offset:0
  ds_read_b128 v[60:63], v3 offset:1024
  ds_read_b128 v[64:67], v3 offset:2048
  ds_read_b128 v[68:71], v3 offset:3072
  ds_read_b128 v[72:75], v3 offset:4096
  ds_read_b128 v[76:79], v3 offset:5120
  s_waitcnt lgkmcnt(5)
  v_mfma_f32_16x16x32_bf16 v[8:11], a[0:3], v[56:59], 0
  v_mfma_f32_16x16x32_bf16 v[12:15], a[8:11], v[56:59], 0
  v_mfma_f32_16x16x32_bf16 v[24:27], v[56:59], a[144:147], 0
  v_mfma_f32_16x16x32_bf16 v[32:35], v[56:59], a[152:155], 0
  s_waitcnt lgkmcnt(4)
  ds_read_b128 v[56:59], v3 offset:6144
  v_mfma_f32_16x16x32_bf16 v[16:19], a[0:3], v[60:63], 0
  v_mfma_f32_16x16x32_bf16 v[20:23], a[8:11], v[60:63], 0
  v_mfma_f32_16x16x32_bf16 v[28:31], v[60:63], a[144:147], 0
  v_mfma_f32_16x16x32_bf16 v[36:39], v[60:63], a[152:155], 0
  s_waitcnt lgkmcnt(4)
  ds_read_b128 v[60:63], v3 offset:7168
  v_mfma_f32_16x16x32_bf16 v[8:11], a[4:7], v[64:67], v[8:11]
  v_mfma_f32_16x16x32_bf16 v[12:15], a[12:15], v[64:67], v[12:15]
  v_mfma_f32_16x16x32_bf16 v[24:27], v[64:67], a[148:151], v[24:27]
  v_mfma_f32_16x16x32_bf16 v[32:35], v[64:67], a[156:159], v[32:35]
  s_waitcnt lgkmcnt(4)
  ds_read_b128 v[64:67], v3 offset:8192
  v_mfma_f32_16x16x32_bf16 v[16:19], a[4:7], v[68:71], v[16:19]
  v_mfma_f32_16x16x32_bf16 v[20:23], a[12:15], v[68:71], v[20:23]
  v_mfma_f32_16x16x32_bf16 v[28:31], v[68:71], a[148:151], v[28:31]
  v_mfma_f32_16x16x32_bf16 v[36:39], v[68:71], a[156:159], v[36:39]
  s_waitcnt lgkmcnt(4)
  ds_read_b128 v[68:71], v3 offset:9216
  v_mfma_f32_16x16x32_bf16 v[8:11], a[16:19], v[72:75], v[8:11]
  v_mfma_f32_16x16x32_bf16 v[12:15], a[24:27], v[72:75], v[12:15]
  v_mfma_f32_16x16x32_bf16 v[24:27], v[72:75], a[160:163], v[24:27]
  v_mfma_f32_16x16x32_bf16 v[32:35], v[72:75], a[168:171], v[32:35]
  s_waitcnt lgkmcnt(4)
  ds_read_b128 v[72:75], v3 offset:10240
  v_mfma_f32_16x16x32_bf16 v[16:19], a[16:19], v[76:79], v[16:19]
  v_bfe_u32 v41, v0, 4, s27
  v_lshlrev_b32 v41, 7, v41
  v_mfma_f32_16x16x32_bf16 v[20:23], a[24:27], v[76:79], v[20:23]
  buffer_load_dword v41, v41, s[4:7], s23 offen sc1
  v_mfma_f32_16x16x32_bf16 v[28:31], v[76:79], a[160:163], v[28:31]
  v_mfma_f32_16x16x32_bf16 v[36:39], v[76:79], a[168:171], v[36:39]
  s_waitcnt lgkmcnt(4)
  ds_read_b128 v[76:79], v3 offset:11264
  v_mfma_f32_16x16x32_bf16 v[8:11], a[20:23], v[56:59], v[8:11]
  v_mfma_f32_16x16x32_bf16 v[12:15], a[28:31], v[56:59], v[12:15]
  v_mfma_f32_16x16x32_bf16 v[24:27], v[56:59], a[164:167], v[24:27]
  v_mfma_f32_16x16x32_bf16 v[32:35], v[56:59], a[172:175], v[32:35]
  s_waitcnt lgkmcnt(4)
  ds_read_b128 v[56:59], v3 offset:12288
  v_mfma_f32_16x16x32_bf16 v[16:19], a[20:23], v[60:63], v[16:19]
  v_mfma_f32_16x16x32_bf16 v[20:23], a[28:31], v[60:63], v[20:23]
  v_mfma_f32_16x16x32_bf16 v[28:31], v[60:63], a[164:167], v[28:31]
  v_mfma_f32_16x16x32_bf16 v[36:39], v[60:63], a[172:175], v[36:39]
  s_waitcnt lgkmcnt(4)
  ds_read_b128 v[60:63], v3 offset:13312
  v_mfma_f32_16x16x32_bf16 v[8:11], a[32:35], v[64:67], v[8:11]
  v_mfma_f32_16x16x32_bf16 v[12:15], a[40:43], v[64:67], v[12:15]
  v_mfma_f32_16x16x32_bf16 v[24:27], v[64:67], a[176:179], v[24:27]
  v_mfma_f32_16x16x32_bf16 v[32:35], v[64:67], a[184:187], v[32:35]
  s_waitcnt lgkmcnt(4)
  ds_read_b128 v[64:67], v3 offset:14336
  v_mfma_f32_16x16x32_bf16 v[16:19], a[32:35], v[68:71], v[16:19]
  v_mfma_f32_16x16x32_bf16 v[20:23], a[40:43], v[68:71], v[20:23]
  v_mfma_f32_16x16x32_bf16 v[28:31], v[68:71], a[176:179], v[28:31]
  v_mfma_f32_16x16x32_bf16 v[36:39], v[68:71], a[184:187], v[36:39]
  s_waitcnt lgkmcnt(4)
  ds_read_b128 v[68:71], v3 offset:15360
  v_mfma_f32_16x16x32_bf16 v[8:11], a[36:39], v[72:75], v[8:11]
  v_mfma_f32_16x16x32_bf16 v[12:15], a[44:47], v[72:75], v[12:15]
  v_mfma_f32_16x16x32_bf16 v[24:27], v[72:75], a[180:183], v[24:27]
  v_mfma_f32_16x16x32_bf16 v[32:35], v[72:75], a[188:191], v[32:35]
  s_waitcnt lgkmcnt(4)
  ds_read_b128 v[72:75], v3 offset:16384
  v_mfma_f32_16x16x32_bf16 v[16:19], a[36:39], v[76:79], v[16:19]
  v_mov_b32 v40, s19
  v_mfma_f32_16x16x32_bf16 v[20:23], a[44:47], v[76:79], v[20:23]
  s_waitcnt vmcnt(1)
  buffer_store_dword v40, off, s[4:7], s58 sc1
  v_mfma_f32_16x16x32_bf16 v[28:31], v[76:79], a[180:183], v[28:31]
  v_mfma_f32_16x16x32_bf16 v[36:39], v[76:79], a[188:191], v[36:39]
  s_waitcnt lgkmcnt(4)
  ds_read_b128 v[76:79], v3 offset:17408
  v_mfma_f32_16x16x32_bf16 v[8:11], a[48:51], v[56:59], v[8:11]
  v_mfma_f32_16x16x32_bf16 v[12:15], a[56:59], v[56:59], v[12:15]
  buffer_store_dwordx4 v[4:7], v0, s[4:7], s59 offen sc1
  v_mfma_f32_16x16x32_bf16 v[24:27], v[56:59], a[192:195], v[24:27]
  v_mfma_f32_16x16x32_bf16 v[32:35], v[56:59], a[200:203], v[32:35]
  s_waitcnt lgkmcnt(4)
  ds_read_b128 v[56:59], v3 offset:18432
  v_mfma_f32_16x16x32_bf16 v[16:19], a[48:51], v[60:63], v[16:19]
  v_mfma_f32_16x16x32_bf16 v[20:23], a[56:59], v[60:63], v[20:23]
  s_add_u32 s59, s59, 8192
  v_mfma_f32_16x16x32_bf16 v[28:31], v[60:63], a[192:195], v[28:31]
  v_mfma_f32_16x16x32_bf16 v[36:39], v[60:63], a[200:203], v[36:39]
  s_waitcnt lgkmcnt(4)
  ds_read_b128 v[60:63], v3 offset:19456
  v_mfma_f32_16x16x32_bf16 v[8:11], a[52:55], v[64:67], v[8:11]
  v_mfma_f32_16x16x32_bf16 v[12:15], a[60:63], v[64:67], v[12:15]
  v_mfma_f32_16x16x32_bf16 v[24:27], v[64:67], a[196:199], v[24:27]
  v_mfma_f32_16x16x32_bf16 v[32:35], v[64:67], a[204:207], v[32:35]
  s_waitcnt lgkmcnt(4)
  ds_read_b128 v[64:67], v3 offset:20480
  v_mfma_f32_16x16x32_bf16 v[16:19], a[52:55], v[68:71], v[16:19]
  v_mfma_f32_16x16x32_bf16 v[20:23], a[60:63], v[68:71], v[20:23]
  v_mfma_f32_16x16x32_bf16 v[28:31], v[68:71], a[196:199], v[28:31]
  v_mfma_f32_16x16x32_bf16 v[36:39], v[68:71], a[204:207], v[36:39]
  s_waitcnt lgkmcnt(4)
  ds_read_b128 v[68:71], v3 offset:21504
  v_mfma_f32_16x16x32_bf16 v[8:11], a[64:67], v[72:75], v[8:11]
  v_mfma_f32_16x16x32_bf16 v[12:15], a[72:75], v[72:75], v[12:15]
  v_mfma_f32_16x16x32_bf16 v[24:27], v[72:75], a[208:211], v[24:27]
  v_mfma_f32_16x16x32_bf16 v[32:35], v[72:75], a[216:219], v[32:35]
  s_waitcnt lgkmcnt(4)
  ds_read_b128 v[72:75], v3 offset:22528
  v_mfma_f32_16x16x32_bf16 v[16:19], a[64:67], v[76:79], v[16:19]
  v_mfma_f32_16x16x32_bf16 v[20:23], a[72:75], v[76:79], v[20:23]
  v_mfma_f32_16x16x32_bf16 v[28:31], v[76:79], a[208:211], v[28:31]
  v_mfma_f32_16x16x32_bf16 v[36:39], v[76:79], a[216:219], v[36:39]
  s_waitcnt lgkmcnt(4)
  ds_read_b128 v[76:79], v3 offset:23552
  v_mfma_f32_16x16x32_bf16 v[8:11], a[68:71], v[56:59], v[8:11]
  v_mfma_f32_16x16x32_bf16 v[12:15], a[76:79], v[56:59], v[12:15]
  v_mfma_f32_16x16x32_bf16 v[24:27], v[56:59], a[212:215], v[24:27]
  v_mfma_f32_16x16x32_bf16 v[32:35], v[56:59], a[220:223], v[32:35]
  s_waitcnt lgkmcnt(4)
  ds_read_b128 v[56:59], v3 offset:24576
  v_mfma_f32_16x16x32_bf16 v[16:19], a[68:71], v[60:63], v[16:19]
  v_mfma_f32_16x16x32_bf16 v[20:23], a[76:79], v[60:63], v[20:23]
  v_mfma_f32_16x16x32_bf16 v[28:31], v[60:63], a[212:215], v[28:31]
  v_mfma_f32_16x16x32_bf16 v[36:39], v[60:63], a[220:223], v[36:39]
  s_waitcnt lgkmcnt(4)
  ds_read_b128 v[60:63], v3 offset:25600
  v_mfma_f32_16x16x32_bf16 v[8:11], a[80:83], v[64:67], v[8:11]
  s_waitcnt vmcnt(2)
  v_cmp_gt_u32 vcc, s60, v41
  v_mfma_f32_16x16x32_bf16 v[12:15], a[88:91], v[64:67], v[12:15]
  v_mfma_f32_16x16x32_bf16 v[24:27], v[64:67], a[224:227], v[24:27]
  s_cmp_eq_u64 vcc, 0
  s_cselect_b32 s25, 1, 0
  v_mfma_f32_16x16x32_bf16 v[32:35], v[64:67], a[232:235], v[32:35]
  s_waitcnt lgkmcnt(4)
  ds_read_b128 v[64:67], v3 offset:26624
  v_mfma_f32_16x16x32_bf16 v[16:19], a[80:83], v[68:71], v[16:19]
  s_cmp_lt_u32 s52, 31
  s_cselect_b32 s25, s25, 0
  v_mfma_f32_16x16x32_bf16 v[20:23], a[88:91], v[68:71], v[20:23]
  s_cmp_eq_u32 s25, 1
  s_cselect_b32 s80, s53, s80
  v_mfma_f32_16x16x32_bf16 v[28:31], v[68:71], a[224:227], v[28:31]
  v_mfma_f32_16x16x32_bf16 v[36:39], v[68:71], a[232:235], v[36:39]
  s_waitcnt lgkmcnt(4)
  ds_read_b128 v[68:71], v3 offset:27648
  v_mfma_f32_16x16x32_bf16 v[8:11], a[84:87], v[72:75], v[8:11]
  s_add_u32 m0, s17, 0
  v_mfma_f32_16x16x32_bf16 v[12:15], a[92:95], v[72:75], v[12:15]
  buffer_load_dwordx4 v1, s[4:7], s80 offen offset:0 sc1 lds
  v_mfma_f32_16x16x32_bf16 v[24:27], v[72:75], a[228:231], v[24:27]
  v_mfma_f32_16x16x32_bf16 v[32:35], v[72:75], a[236:239], v[32:35]
  s_waitcnt lgkmcnt(4)
  ds_read_b128 v[72:75], v3 offset:28672
  v_mfma_f32_16x16x32_bf16 v[16:19], a[84:87], v[76:79], v[16:19]
  v_mfma_f32_16x16x32_bf16 v[20:23], a[92:95], v[76:79], v[20:23]
  s_add_u32 m0, s17, 1984
  v_mfma_f32_16x16x32_bf16 v[28:31], v[76:79], a[228:231], v[28:31]
  buffer_load_dwordx4 v1, s[4:7], s80 offen offset:64 sc1 lds
  v_mfma_f32_16x16x32_bf16 v[36:39], v[76:79], a[236:239], v[36:39]
  s_waitcnt lgkmcnt(4)
  ds_read_b128 v[76:79], v3 offset:29696
  v_mfma_f32_16x16x32_bf16 v[8:11], a[96:99], v[56:59], v[8:11]
  v_mfma_f32_16x16x32_bf16 v[12:15], a[104:107], v[56:59], v[12:15]
  v_mfma_f32_16x16x32_bf16 v[24:27], v[56:59], a[240:243], v[24:27]
  v_mfma_f32_16x16x32_bf16 v[32:35], v[56:59], a[248:251], v[32:35]
  s_waitcnt lgkmcnt(4)
  s_add_u32 m0, s17, 3968
  ds_read_b128 v[56:59], v3 offset:30720
  v_mfma_f32_16x16x32_bf16 v[16:19], a[96:99], v[60:63], v[16:19]
  buffer_load_dwordx4 v1, s[4:7], s80 offen offset:128 sc1 lds
  v_mfma_f32_16x16x32_bf16 v[20:23], a[104:107], v[60:63], v[20:23]
  v_mfma_f32_16x16x32_bf16 v[28:31], v[60:63], a[240:243], v[28:31]
  v_mfma_f32_16x16x32_bf16 v[36:39], v[60:63], a[248:251], v[36:39]
  s_waitcnt lgkmcnt(4)
  s_add_u32 m0, s17, 5952
  ds_read_b128 v[60:63], v3 offset:31744
  v_mfma_f32_16x16x32_bf16 v[8:11], a[100:103], v[64:67], v[8:11]
  buffer_load_dwordx4 v1, s[4:7], s80 offen offset:192 sc1 lds
  v_mfma_f32_16x16x32_bf16 v[12:15], a[108:111], v[64:67], v[12:15]
  v_mfma_f32_16x16x32_bf16 v[24:27], v[64:67], a[244:247], v[24:27]
  v_mfma_f32_16x16x32_bf16 v[32:35], v[64:67], a[252:255], v[32:35]
  s_waitcnt lgkmcnt(4)
  ds_read_b128 v[64:67], v3 offset:32768
  v_mfma_f32_16x16x32_bf16 v[16:19], a[100:103], v[68:71], v[16:19]
  s_add_u32 m0, s17, 7936
  v_mfma_f32_16x16x32_bf16 v[20:23], a[108:111], v[68:71], v[20:23]
  buffer_load_dwordx4 v1, s[4:7], s80 offen offset:256 sc1 lds
  v_mfma_f32_16x16x32_bf16 v[28:31], v[68:71], a[244:247], v[28:31]
  v_mfma_f32_16x16x32_bf16 v[36:39], v[68:71], a[252:255], v[36:39]
  s_waitcnt lgkmcnt(4)
  ds_read_b128 v[68:71], v3 offset:33792
  v_mfma_f32_16x16x32_bf16 v[8:11], a[112:115], v[72:75], v[8:11]
  v_mfma_f32_16x16x32_bf16 v[12:15], a[120:123], v[72:75], v[12:15]
  s_add_u32 m0, s17, 9920
  v_mfma_f32_16x16x32_bf16 v[24:27], v[72:75], v[80:83], v[24:27]
  buffer_load_dwordx4 v1, s[4:7], s80 offen offset:320 sc1 lds
  v_mfma_f32_16x16x32_bf16 v[32:35], v[72:75], v[88:91], v[32:35]
  s_waitcnt lgkmcnt(4)
  ds_read_b128 v[72:75], v3 offset:34816
  v_mfma_f32_16x16x32_bf16 v[16:19], a[112:115], v[76:79], v[16:19]
  v_mfma_f32_16x16x32_bf16 v[20:23], a[120:123], v[76:79], v[20:23]
  v_mfma_f32_16x16x32_bf16 v[28:31], v[76:79], v[80:83], v[28:31]
  v_mfma_f32_16x16x32_bf16 v[36:39], v[76:79], v[88:91], v[36:39]
  s_waitcnt lgkmcnt(4)
  s_add_u32 m0, s17, 11904
  ds_read_b128 v[76:79], v3 offset:35840
  v_mfma_f32_16x16x32_bf16 v[8:11], a[116:119], v[56:59], v[8:11]
  buffer_load_dwordx4 v1, s[4:7], s80 offen offset:384 sc1 lds
  v_mfma_f32_16x16x32_bf16 v[12:15], a[124:127], v[56:59], v[12:15]
  v_mfma_f32_16x16x32_bf16 v[24:27], v[56:59], v[84:87], v[24:27]
  v_mfma_f32_16x16x32_bf16 v[32:35], v[56:59], v[92:95], v[32:35]
  s_waitcnt lgkmcnt(4)
  s_add_u32 m0, s17, 13888
  ds_read_b128 v[56:59], v3 offset:0
  v_mfma_f32_16x16x32_bf16 v[16:19], a[116:119], v[60:63], v[16:19]
  buffer_load_dwordx4 v1, s[4:7], s80 offen offset:448 sc1 lds
  v_mfma_f32_16x16x32_bf16 v[20:23], a[124:127], v[60:63], v[20:23]
  v_mfma_f32_16x16x32_bf16 v[28:31], v[60:63], v[84:87], v[28:31]
  v_mfma_f32_16x16x32_bf16 v[36:39], v[60:63], v[92:95], v[36:39]
  s_waitcnt lgkmcnt(4)
  ds_read_b128 v[60:63], v3 offset:1024
  v_mfma_f32_16x16x32_bf16 v[8:11], a[128:131], v[64:67], v[8:11]
  s_add_u32 m0, s17, 15872
  v_mfma_f32_16x16x32_bf16 v[12:15], a[136:139], v[64:67], v[12:15]
  buffer_load_dwordx4 v1, s[4:7], s80 offen offset:512 sc1 lds
  v_mfma_f32_16x16x32_bf16 v[24:27], v[64:67], v[96:99], v[24:27]
  v_mfma_f32_16x16x32_bf16 v[32:35], v[64:67], v[104:107], v[32:35]
  s_waitcnt lgkmcnt(4)
  ds_read_b128 v[64:67], v3 offset:2048
  v_mfma_f32_16x16x32_bf16 v[16:19], a[128:131], v[68:71], v[16:19]
  v_mfma_f32_16x16x32_bf16 v[20:23], a[136:139], v[68:71], v[20:23]
  v_mfma_f32_16x16x32_bf16 v[28:31], v[68:71], v[96:99], v[28:31]
  v_mfma_f32_16x16x32_bf16 v[36:39], v[68:71], v[104:107], v[36:39]
  s_waitcnt lgkmcnt(4)
  ds_read_b128 v[68:71], v3 offset:3072
  v_mfma_f32_16x16x32_bf16 v[8:11], a[132:135], v[72:75], v[8:11]
  s_add_u32 s61, s24, s62
  v_mfma_f32_16x16x32_bf16 v[12:15], a[140:143], v[72:75], v[12:15]
  v_add_u32 v4, s61, v0
  v_mfma_f32_16x16x32_bf16 v[24:27], v[72:75], v[100:103], v[24:27]
  s_add_u32 s61, s61, s24
  v_mfma_f32_16x16x32_bf16 v[32:35], v[72:75], v[108:111], v[32:35]
  s_waitcnt lgkmcnt(4)
  ds_read_b128 v[72:75], v3 offset:4096
  v_mfma_f32_16x16x32_bf16 v[16:19], a[132:135], v[76:79], v[16:19]
  v_add_u32 v5, s61, v0
  v_mfma_f32_16x16x32_bf16 v[20:23], a[140:143], v[76:79], v[20:23]
  s_add_u32 s61, s24, s54
  v_mfma_f32_16x16x32_bf16 v[28:31], v[76:79], v[100:103], v[28:31]
  s_add_u32 s15, s61, 4096
  v_mfma_f32_16x16x32_bf16 v[36:39], v[76:79], v[108:111], v[36:39]
  s_waitcnt lgkmcnt(4)
  ds_read_b128 v[76:79], v3 offset:5120
  v_mfma_f32_16x16x32_bf16 v[40:43], v[112:115], v[56:59], 0
  s_add_u32 s14, s15, s24
  v_mfma_f32_16x16x32_bf16 v[44:47], v[120:123], v[56:59], 0
  s_waitcnt lgkmcnt(4)
  ds_read_b128 v[56:59], v3 offset:6144
  v_mfma_f32_16x16x32_bf16 v[48:51], v[112:115], v[60:63], 0
  s_add_u32 s14, s14, 4096
  v_cvt_pk_bf16_f32 v8, v8, v9
  v_cvt_pk_bf16_f32 v9, v10, v11
  v_mfma_f32_16x16x32_bf16 v[52:55], v[120:123], v[60:63], 0
  s_waitcnt lgkmcnt(4)
  ds_read_b128 v[60:63], v3 offset:7168
  v_mfma_f32_16x16x32_bf16 v[40:43], v[116:119], v[64:67], v[40:43]
  v_cvt_pk_bf16_f32 v10, v12, v13
  v_cvt_pk_bf16_f32 v11, v14, v15
  v_mfma_f32_16x16x32_bf16 v[44:47], v[124:127], v[64:67], v[44:47]
  s_waitcnt lgkmcnt(4)
  ds_read_b128 v[64:67], v3 offset:8192
  v_mfma_f32_16x16x32_bf16 v[48:51], v[116:119], v[68:71], v[48:51]
  buffer_store_dwordx4 v[8:11], v0, s[4:7], s61 offen sc1
  v_mfma_f32_16x16x32_bf16 v[52:55], v[124:127], v[68:71], v[52:55]
  s_waitcnt lgkmcnt(4)
  ds_read_b128 v[68:71], v3 offset:9216
  v_mfma_f32_16x16x32_bf16 v[40:43], v[128:131], v[72:75], v[40:43]
  v_cvt_pk_bf16_f32 v16, v16, v17
  v_cvt_pk_bf16_f32 v17, v18, v19
  v_mfma_f32_16x16x32_bf16 v[44:47], v[136:139], v[72:75], v[44:47]
  s_waitcnt lgkmcnt(4)
  ds_read_b128 v[72:75], v3 offset:10240
  v_mfma_f32_16x16x32_bf16 v[48:51], v[128:131], v[76:79], v[48:51]
  v_cvt_pk_bf16_f32 v18, v20, v21
  v_cvt_pk_bf16_f32 v19, v22, v23
  v_mfma_f32_16x16x32_bf16 v[52:55], v[136:139], v[76:79], v[52:55]
  s_waitcnt lgkmcnt(4)
  ds_read_b128 v[76:79], v3 offset:11264
  v_mfma_f32_16x16x32_bf16 v[40:43], v[132:135], v[56:59], v[40:43]
  buffer_store_dwordx4 v[16:19], v0, s[4:7], s15 offen sc1
  v_mfma_f32_16x16x32_bf16 v[44:47], v[140:143], v[56:59], v[44:47]
  s_waitcnt lgkmcnt(4)
  ds_read_b128 v[56:59], v3 offset:12288
  v_mfma_f32_16x16x32_bf16 v[48:51], v[132:135], v[60:63], v[48:51]
  v_cvt_pk_bf16_f32 v24, v24, v25
  v_cvt_pk_bf16_f32 v25, v26, v27
  v_mfma_f32_16x16x32_bf16 v[52:55], v[140:143], v[60:63], v[52:55]
  s_waitcnt lgkmcnt(4)
  ds_read_b128 v[60:63], v3 offset:13312
  v_mfma_f32_16x16x32_bf16 v[40:43], v[144:147], v[64:67], v[40:43]
  v_cvt_pk_bf16_f32 v26, v28, v29
  v_cvt_pk_bf16_f32 v27, v30, v31
  v_mfma_f32_16x16x32_bf16 v[44:47], v[152:155], v[64:67], v[44:47]
  s_waitcnt lgkmcnt(4)
  ds_read_b128 v[64:67], v3 offset:14336
  v_mfma_f32_16x16x32_bf16 v[48:51], v[144:147], v[68:71], v[48:51]
  buffer_store_dwordx4 v[24:27], v0, s[4:7], s14 offen offset:0 sc1
  v_mfma_f32_16x16x32_bf16 v[52:55], v[152:155], v[68:71], v[52:55]
  s_waitcnt lgkmcnt(4)
  ds_read_b128 v[68:71], v3 offset:15360
  v_mfma_f32_16x16x32_bf16 v[40:43], v[148:151], v[72:75], v[40:43]
  v_cvt_pk_bf16_f32 v32, v32, v33
  v_cvt_pk_bf16_f32 v33, v34, v35
  v_mfma_f32_16x16x32_bf16 v[44:47], v[156:159], v[72:75], v[44:47]
  s_waitcnt lgkmcnt(4)
  ds_read_b128 v[72:75], v3 offset:16384
  v_mfma_f32_16x16x32_bf16 v[48:51], v[148:151], v[76:79], v[48:51]
  v_cvt_pk_bf16_f32 v34, v36, v37
  v_cvt_pk_bf16_f32 v35, v38, v39
  v_mfma_f32_16x16x32_bf16 v[52:55], v[156:159], v[76:79], v[52:55]
  s_waitcnt lgkmcnt(4)
  ds_read_b128 v[76:79], v3 offset:17408
  v_mfma_f32_16x16x32_bf16 v[40:43], v[160:163], v[56:59], v[40:43]
  buffer_store_dwordx4 v[32:35], v0, s[4:7], s14 offen offset:1024 sc1
  v_mfma_f32_16x16x32_bf16 v[44:47], v[168:171], v[56:59], v[44:47]
  s_waitcnt lgkmcnt(4)
  ds_read_b128 v[56:59], v3 offset:18432
  v_mfma_f32_16x16x32_bf16 v[48:51], v[160:163], v[60:63], v[48:51]
  ds_write_b128 v4, v[8:11] offset:8192
  v_mfma_f32_16x16x32_bf16 v[52:55], v[168:171], v[60:63], v[52:55]
  s_waitcnt lgkmcnt(5)
  ds_read_b128 v[60:63], v3 offset:19456
  v_mfma_f32_16x16x32_bf16 v[40:43], v[164:167], v[64:67], v[40:43]
  v_mfma_f32_16x16x32_bf16 v[44:47], v[172:175], v[64:67], v[44:47]
  s_waitcnt lgkmcnt(5)
  ds_read_b128 v[64:67], v3 offset:20480
  v_mfma_f32_16x16x32_bf16 v[48:51], v[164:167], v[68:71], v[48:51]
  v_mfma_f32_16x16x32_bf16 v[52:55], v[172:175], v[68:71], v[52:55]
  s_waitcnt lgkmcnt(5)
  ds_read_b128 v[68:71], v3 offset:21504
  v_mfma_f32_16x16x32_bf16 v[40:43], v[176:179], v[72:75], v[40:43]
  ds_write_b128 v4, v[16:19] offset:12288
  v_mfma_f32_16x16x32_bf16 v[44:47], v[184:187], v[72:75], v[44:47]
  s_waitcnt lgkmcnt(6)
  ds_read_b128 v[72:75], v3 offset:22528
  v_mfma_f32_16x16x32_bf16 v[48:51], v[176:179], v[76:79], v[48:51]
  v_mfma_f32_16x16x32_bf16 v[52:55], v[184:187], v[76:79], v[52:55]
  s_waitcnt lgkmcnt(6)
  ds_read_b128 v[76:79], v3 offset:23552
  v_mfma_f32_16x16x32_bf16 v[40:43], v[180:183], v[56:59], v[40:43]
  v_mfma_f32_16x16x32_bf16 v[44:47], v[188:191], v[56:59], v[44:47]
  s_waitcnt lgkmcnt(5)
  ds_read_b128 v[56:59], v3 offset:24576
  v_mfma_f32_16x16x32_bf16 v[48:51], v[180:183], v[60:63], v[48:51]
  ds_write_b128 v5, v[24:27] offset:16384
  v_mfma_f32_16x16x32_bf16 v[52:55], v[188:191], v[60:63], v[52:55]
  s_waitcnt lgkmcnt(6)
  ds_read_b128 v[60:63], v3 offset:25600
  v_mfma_f32_16x16x32_bf16 v[40:43], v[192:195], v[64:67], v[40:43]
  v_mfma_f32_16x16x32_bf16 v[44:47], v[200:203], v[64:67], v[44:47]
  s_waitcnt lgkmcnt(6)
  ds_read_b128 v[64:67], v3 offset:26624
  v_mfma_f32_16x16x32_bf16 v[48:51], v[192:195], v[68:71], v[48:51]
  v_mfma_f32_16x16x32_bf16 v[52:55], v[200:203], v[68:71], v[52:55]
  s_waitcnt lgkmcnt(5)
  ds_read_b128 v[68:71], v3 offset:27648
  v_mfma_f32_16x16x32_bf16 v[40:43], v[196:199], v[72:75], v[40:43]
  ds_write_b128 v5, v[32:35] offset:17408
  v_mfma_f32_16x16x32_bf16 v[44:47], v[204:207], v[72:75], v[44:47]
  s_waitcnt lgkmcnt(6)
  ds_read_b128 v[72:75], v3 offset:28672
  v_mfma_f32_16x16x32_bf16 v[48:51], v[196:199], v[76:79], v[48:51]
  v_bfe_u32 v7, v0, 4, s27
  v_lshlrev_b32 v7, 7, v7
  v_mfma_f32_16x16x32_bf16 v[52:55], v[204:207], v[76:79], v[52:55]
  s_waitcnt lgkmcnt(6)
  ds_read_b128 v[76:79], v3 offset:29696
  v_mfma_f32_16x16x32_bf16 v[40:43], v[208:211], v[56:59], v[40:43]
  buffer_load_dword v7, v7, s[4:7], s23 offen sc1
  v_mfma_f32_16x16x32_bf16 v[44:47], v[216:219], v[56:59], v[44:47]
  s_waitcnt lgkmcnt(5)
  ds_read_b128 v[56:59], v3 offset:30720
  v_mfma_f32_16x16x32_bf16 v[48:51], v[208:211], v[60:63], v[48:51]
  v_mfma_f32_16x16x32_bf16 v[52:55], v[216:219], v[60:63], v[52:55]
  s_waitcnt lgkmcnt(5)
  ds_read_b128 v[60:63], v3 offset:31744
  v_mfma_f32_16x16x32_bf16 v[40:43], v[212:215], v[64:67], v[40:43]
  buffer_load_dwordx4 v[12:15], v0, s[4:7], s55 offen sc1
  v_mfma_f32_16x16x32_bf16 v[44:47], v[220:223], v[64:67], v[44:47]
  s_waitcnt lgkmcnt(5)
  ds_read_b128 v[64:67], v3 offset:32768
  v_mfma_f32_16x16x32_bf16 v[48:51], v[212:215], v[68:71], v[48:51]
  v_mfma_f32_16x16x32_bf16 v[52:55], v[220:223], v[68:71], v[52:55]
  s_waitcnt lgkmcnt(4)
  ds_read_b128 v[68:71], v3 offset:33792
  v_mfma_f32_16x16x32_bf16 v[40:43], v[224:227], v[72:75], v[40:43]
  v_mfma_f32_16x16x32_bf16 v[44:47], v[232:235], v[72:75], v[44:47]
  s_waitcnt lgkmcnt(4)
  ds_read_b128 v[72:75], v3 offset:34816
  v_mfma_f32_16x16x32_bf16 v[48:51], v[224:227], v[76:79], v[48:51]
  v_mfma_f32_16x16x32_bf16 v[52:55], v[232:235], v[76:79], v[52:55]
  s_waitcnt lgkmcnt(4)
  ds_read_b128 v[76:79], v3 offset:35840
  v_mfma_f32_16x16x32_bf16 v[40:43], v[228:231], v[56:59], v[40:43]
  v_mfma_f32_16x16x32_bf16 v[44:47], v[236:239], v[56:59], v[44:47]
  s_waitcnt lgkmcnt(4)
  v_mfma_f32_16x16x32_bf16 v[48:51], v[228:231], v[60:63], v[48:51]
  v_mfma_f32_16x16x32_bf16 v[52:55], v[236:239], v[60:63], v[52:55]
  s_waitcnt lgkmcnt(3)
  v_mfma_f32_16x16x32_bf16 v[40:43], v[240:243], v[64:67], v[40:43]
  v_mfma_f32_16x16x32_bf16 v[44:47], v[248:251], v[64:67], v[44:47]
  s_waitcnt lgkmcnt(2)
  v_mfma_f32_16x16x32_bf16 v[48:51], v[240:243], v[68:71], v[48:51]
  s_add_u32 s61, s52, 1
  v_mfma_f32_16x16x32_bf16 v[52:55], v[248:251], v[68:71], v[52:55]
  s_waitcnt lgkmcnt(1)
  v_mfma_f32_16x16x32_bf16 v[40:43], v[244:247], v[72:75], v[40:43]
  v_mfma_f32_16x16x32_bf16 v[44:47], v[252:255], v[72:75], v[44:47]
  s_waitcnt lgkmcnt(0)
  v_mfma_f32_16x16x32_bf16 v[48:51], v[244:247], v[76:79], v[48:51]
  v_mfma_f32_16x16x32_bf16 v[52:55], v[252:255], v[76:79], v[52:55]
  s_waitcnt vmcnt(2)
  v_mov_b32 v6, s61
  s_mov_b64 exec, 1
  buffer_store_short v6, v0, s[4:7], s57 offen sc1
  s_mov_b64 exec, -1
  v_cvt_pk_bf16_f32 v40, v40, v41
  v_cvt_pk_bf16_f32 v41, v42, v43
  v_cvt_pk_bf16_f32 v42, v44, v45
  v_cvt_pk_bf16_f32 v43, v46, v47
  ds_write_b128 v4, v[40:43] offset:0
  v_cvt_pk_bf16_f32 v48, v48, v49
  v_cvt_pk_bf16_f32 v49, v50, v51
  v_cvt_pk_bf16_f32 v50, v52, v53
  v_cvt_pk_bf16_f32 v51, v54, v55
  ds_write_b128 v4, v[48:51] offset:4096
  s_add_u32 s54, s54, 32768
  s_and_b32 s14, s52, 1
  s_mul_i32 s14, s14, -73728
  s_add_u32 s14, s14, 36864
  v_add_u32 v3, s14, v3
  s_add_u32 s62, s62, 24576
  s_cmp_eq_u32 s62, 147456
  s_cselect_b32 s62, 73728, s62
.qnp_38:
  s_waitcnt lgkmcnt(0)
  s_barrier
  s_add_u32 s52, s52, 1
  s_cmp_lt_u32 s19, 32
  s_cbranch_scc1 .ql_35
  s_endpgm
.qna_37w:
  s_waitcnt vmcnt(0)
  s_branch .qna_37
op:
  s_sub_u32 s59, s8, 6
  s_cmp_ge_u32 s9, 12
  s_cselect_b32 s11, 1, 0
  s_mul_i32 s14, s11, 12
  s_sub_u32 s57, s9, s14
  s_mul_i32 s12, s57, 43
  s_lshr_b32 s12, s12, 7
  s_mul_i32 s14, s12, 3
  s_sub_u32 s16, s57, s14
  s_mul_i32 s13, s3, 36864
  v_lshrrev_b32 v20, 4, v0
  v_lshlrev_b32 v20, 9, v20
  v_bfe_u32 v24, v0, 2, 2
  v_lshl_add_u32 v20, v24, 6, v20
  v_and_b32 v24, 3, v0
  v_lshl_add_u32 v20, v24, 3, v20
  v_add_u32 v20, s13, v20
  v_bfe_u32 v21, v0, 4, 1
  v_lshlrev_b32 v21, 4, v21
  v_bfe_u32 v24, v0, 5, 1
  v_lshl_add_u32 v21, v24, 2, v21
  v_bfe_u32 v24, v0, 2, 2
  v_lshl_add_u32 v21, v24, 0, v21
  v_mul_u32_u24 v21, 1152, v21
  v_and_b32 v24, 3, v0
  v_lshl_add_u32 v21, v24, 4, v21
  s_mul_i32 s15, s12, 1179648
  s_mul_i32 s14, s16, 384
  s_add_u32 s15, s15, s14
  s_mul_i32 s14, s3, 96
  s_add_u32 s15, s15, s14
  v_and_b32 v24, 2, v0
  v_mul_u32_u24 v24, 36848, v24
  v_add_u32 v22, v21, v24
  s_add_u32 m0, s13, 0
  s_add_u32 s14, s15, 0x0
  buffer_load_dwordx4 v21, s[44:47], s14 offen lds
  s_add_u32 m0, s13, 1024
  s_add_u32 s14, s15, 0x2400
  buffer_load_dwordx4 v21, s[44:47], s14 offen lds
  s_add_u32 m0, s13, 2048
  s_add_u32 s14, s15, 0x9000
  buffer_load_dwordx4 v21, s[44:47], s14 offen lds
  s_add_u32 m0, s13, 3072
  s_add_u32 s14, s15, 0xb400
  buffer_load_dwordx4 v21, s[44:47], s14 offen lds
  s_add_u32 m0, s13, 4096
  s_add_u32 s14, s15, 0x12000
  buffer_load_dwordx4 v21, s[44:47], s14 offen lds
  s_add_u32 m0, s13, 5120
  s_add_u32 s14, s15, 0x14400
  buffer_load_dwordx4 v21, s[44:47], s14 offen lds
  s_add_u32 m0, s13, 6144
  s_add_u32 s14, s15, 0x1b000
  buffer_load_dwordx4 v21, s[44:47], s14 offen lds
  s_add_u32 m0, s13, 7168
  s_add_u32 s14, s15, 0x1d400
  buffer_load_dwordx4 v21, s[44:47], s14 offen lds
  s_waitcnt lgkmcnt(0)
  s_add_u32 m0, s13, 8192
  s_add_u32 s14, s15, 0x40
  buffer_load_dwordx4 v22, s[44:47], s14 offen lds
  s_waitcnt vmcnt(5)
  ds_read_b64_tr_b16 a[0:1], v20 offset:0
  ds_read_b64_tr_b16 a[2:3], v20 offset:256
  ds_read_b64_tr_b16 a[4:5], v20 offset:2048
  ds_read_b64_tr_b16 a[6:7], v20 offset:2304
  ds_read_b64_tr_b16 a[8:9], v20 offset:32
  ds_read_b64_tr_b16 a[10:11], v20 offset:288
  ds_read_b64_tr_b16 a[12:13], v20 offset:2080
  ds_read_b64_tr_b16 a[14:15], v20 offset:2336
  s_add_u32 m0, s13, 9216
  s_add_u32 s14, s15, 0x2440
  buffer_load_dwordx4 v22, s[44:47], s14 offen lds
  s_add_u32 m0, s13, 10240
  s_add_u32 s14, s15, 0x9040
  buffer_load_dwordx4 v22, s[44:47], s14 offen lds
  s_add_u32 m0, s13, 11264
  s_add_u32 s14, s15, 0xb440
  buffer_load_dwordx4 v22, s[44:47], s14 offen lds
  s_waitcnt lgkmcnt(0)
  s_add_u32 m0, s13, 12288
  s_add_u32 s14, s15, 0x24000
  buffer_load_dwordx4 v21, s[44:47], s14 offen lds
  s_waitcnt vmcnt(5)
  ds_read_b64_tr_b16 a[16:17], v20 offset:4096
  ds_read_b64_tr_b16 a[18:19], v20 offset:4352
  ds_read_b64_tr_b16 a[20:21], v20 offset:6144
  ds_read_b64_tr_b16 a[22:23], v20 offset:6400
  ds_read_b64_tr_b16 a[24:25], v20 offset:4128
  ds_read_b64_tr_b16 a[26:27], v20 offset:4384
  ds_read_b64_tr_b16 a[28:29], v20 offset:6176
  ds_read_b64_tr_b16 a[30:31], v20 offset:6432
  s_add_u32 m0, s13, 13312
  s_add_u32 s14, s15, 0x26400
  buffer_load_dwordx4 v21, s[44:47], s14 offen lds
  s_add_u32 m0, s13, 14336
  s_add_u32 s14, s15, 0x2d000
  buffer_load_dwordx4 v21, s[44:47], s14 offen lds
  s_add_u32 m0, s13, 15360
  s_add_u32 s14, s15, 0x2f400
  buffer_load_dwordx4 v21, s[44:47], s14 offen lds
  s_waitcnt lgkmcnt(0)
  s_add_u32 m0, s13, 16384
  s_add_u32 s14, s15, 0x36000
  buffer_load_dwordx4 v21, s[44:47], s14 offen lds
  s_waitcnt vmcnt(5)
  ds_read_b64_tr_b16 a[32:33], v20 offset:8192
  ds_read_b64_tr_b16 a[34:35], v20 offset:8448
  ds_read_b64_tr_b16 a[36:37], v20 offset:10240
  ds_read_b64_tr_b16 a[38:39], v20 offset:10496
  ds_read_b64_tr_b16 a[40:41], v20 offset:8224
  ds_read_b64_tr_b16 a[42:43], v20 offset:8480
  ds_read_b64_tr_b16 a[44:45], v20 offset:10272
  ds_read_b64_tr_b16 a[46:47], v20 offset:10528
  s_add_u32 m0, s13, 17408
  s_add_u32 s14, s15, 0x38400
  buffer_load_dwordx4 v21, s[44:47], s14 offen lds
  s_add_u32 m0, s13, 18432
  s_add_u32 s14, s15, 0x3f000
  buffer_load_dwordx4 v21, s[44:47], s14 offen lds
  s_add_u32 m0, s13, 19456
  s_add_u32 s14, s15, 0x41400
  buffer_load_dwordx4 v21, s[44:47], s14 offen lds
  s_waitcnt lgkmcnt(0)
  s_add_u32 m0, s13, 20480
  s_add_u32 s14, s15, 0x24040
  buffer_load_dwordx4 v22, s[44:47], s14 offen lds
  s_waitcnt vmcnt(5)
  ds_read_b64_tr_b16 a[48:49], v20 offset:12288
  ds_read_b64_tr_b16 a[50:51], v20 offset:12544
  ds_read_b64_tr_b16 a[52:53], v20 offset:14336
  ds_read_b64_tr_b16 a[54:55], v20 offset:14592
  ds_read_b64_tr_b16 a[56:57], v20 offset:12320
  ds_read_b64_tr_b16 a[58:59], v20 offset:12576
  ds_read_b64_tr_b16 a[60:61], v20 offset:14368
  ds_read_b64_tr_b16 a[62:63], v20 offset:14624
  s_add_u32 m0, s13, 21504
  s_add_u32 s14, s15, 0x26440
  buffer_load_dwordx4 v22, s[44:47], s14 offen lds
  s_add_u32 m0, s13, 22528
  s_add_u32 s14, s15, 0x2d040
  buffer_load_dwordx4 v22, s[44:47], s14 offen lds
  s_add_u32 m0, s13, 23552
  s_add_u32 s14, s15, 0x2f440
  buffer_load_dwordx4 v22, s[44:47], s14 offen lds
  s_waitcnt lgkmcnt(0)
  s_add_u32 m0, s13, 24576
  s_add_u32 s14, s15, 0x48000
  buffer_load_dwordx4 v21, s[44:47], s14 offen lds
  s_waitcnt vmcnt(5)
  ds_read_b64_tr_b16 a[64:65], v20 offset:16384
  ds_read_b64_tr_b16 a[66:67], v20 offset:16640
  ds_read_b64_tr_b16 a[68:69], v20 offset:18432
  ds_read_b64_tr_b16 a[70:71], v20 offset:18688
  ds_read_b64_tr_b16 a[72:73], v20 offset:16416
  ds_read_b64_tr_b16 a[74:75], v20 offset:16672
  ds_read_b64_tr_b16 a[76:77], v20 offset:18464
  ds_read_b64_tr_b16 a[78:79], v20 offset:18720
  s_add_u32 m0, s13, 25600
  s_add_u32 s14, s15, 0x4a400
  buffer_load_dwordx4 v21, s[44:47], s14 offen lds
  s_add_u32 m0, s13, 26624
  s_add_u32 s14, s15, 0x51000
  buffer_load_dwordx4 v21, s[44:47], s14 offen lds
  s_add_u32 m0, s13, 27648
  s_add_u32 s14, s15, 0x53400
  buffer_load_dwordx4 v21, s[44:47], s14 offen lds
  s_waitcnt lgkmcnt(0)
  s_add_u32 m0, s13, 28672
  s_add_u32 s14, s15, 0x5a000
  buffer_load_dwordx4 v21, s[44:47], s14 offen lds
  s_waitcnt vmcnt(5)
  ds_read_b64_tr_b16 a[80:81], v20 offset:20480
  ds_read_b64_tr_b16 a[82:83], v20 offset:20736
  ds_read_b64_tr_b16 a[84:85], v20 offset:22528
  ds_read_b64_tr_b16 a[86:87], v20 offset:22784
  ds_read_b64_tr_b16 a[88:89], v20 offset:20512
  ds_read_b64_tr_b16 a[90:91], v20 offset:20768
  ds_read_b64_tr_b16 a[92:93], v20 offset:22560
  ds_read_b64_tr_b16 a[94:95], v20 offset:22816
  s_add_u32 m0, s13, 29696
  s_add_u32 s14, s15, 0x5c400
  buffer_load_dwordx4 v21, s[44:47], s14 offen lds
  s_add_u32 m0, s13, 30720
  s_add_u32 s14, s15, 0x63000
  buffer_load_dwordx4 v21, s[44:47], s14 offen lds
  s_add_u32 m0, s13, 31744
  s_add_u32 s14, s15, 0x65400
  buffer_load_dwordx4 v21, s[44:47], s14 offen lds
  s_waitcnt lgkmcnt(0)
  s_add_u32 m0, s13, 32768
  s_add_u32 s14, s15, 0x48040
  buffer_load_dwordx4 v22, s[44:47], s14 offen lds
  s_waitcnt vmcnt(5)
  ds_read_b64_tr_b16 a[96:97], v20 offset:24576
  ds_read_b64_tr_b16 a[98:99], v20 offset:24832
  ds_read_b64_tr_b16 a[100:101], v20 offset:26624
  ds_read_b64_tr_b16 a[102:103], v20 offset:26880
  ds_read_b64_tr_b16 a[104:105], v20 offset:24608
  ds_read_b64_tr_b16 a[106:107], v20 offset:24864
  ds_read_b64_tr_b16 a[108:109], v20 offset:26656
  ds_read_b64_tr_b16 a[110:111], v20 offset:26912
  s_add_u32 m0, s13, 33792
  s_add_u32 s14, s15, 0x4a440
  buffer_load_dwordx4 v22, s[44:47], s14 offen lds
  s_add_u32 m0, s13, 34816
  s_add_u32 s14, s15, 0x51040
  buffer_load_dwordx4 v22, s[44:47], s14 offen lds
  s_add_u32 m0, s13, 35840
  s_add_u32 s14, s15, 0x53440
  buffer_load_dwordx4 v22, s[44:47], s14 offen lds
  s_waitcnt lgkmcnt(0)
  s_add_u32 m0, s13, 0
  s_add_u32 s14, s15, 0x6c000
  buffer_load_dwordx4 v21, s[44:47], s14 offen lds
  s_waitcnt vmcnt(5)
  ds_read_b64_tr_b16 a[112:113], v20 offset:28672
  ds_read_b64_tr_b16 a[114:115], v20 offset:28928
  ds_read_b64_tr_b16 a[116:117], v20 offset:30720
  ds_read_b64_tr_b16 a[118:119], v20 offset:30976
  ds_read_b64_tr_b16 a[120:121], v20 offset:28704
  ds_read_b64_tr_b16 a[122:123], v20 offset:28960
  ds_read_b64_tr_b16 a[124:125], v20 offset:30752
  ds_read_b64_tr_b16 a[126:127], v20 offset:31008
  s_add_u32 m0, s13, 1024
  s_add_u32 s14, s15, 0x6e400
  buffer_load_dwordx4 v21, s[44:47], s14 offen lds
  s_add_u32 m0, s13, 2048
  s_add_u32 s14, s15, 0x75000
  buffer_load_dwordx4 v21, s[44:47], s14 offen lds
  s_add_u32 m0, s13, 3072
  s_add_u32 s14, s15, 0x77400
  buffer_load_dwordx4 v21, s[44:47], s14 offen lds
  s_waitcnt lgkmcnt(0)
  s_add_u32 m0, s13, 4096
  s_add_u32 s14, s15, 0x7e000
  buffer_load_dwordx4 v21, s[44:47], s14 offen lds
  s_waitcnt vmcnt(5)
  ds_read_b64_tr_b16 a[128:129], v20 offset:32768
  ds_read_b64_tr_b16 a[130:131], v20 offset:33024
  ds_read_b64_tr_b16 a[132:133], v20 offset:34816
  ds_read_b64_tr_b16 a[134:135], v20 offset:35072
  ds_read_b64_tr_b16 a[136:137], v20 offset:32800
  ds_read_b64_tr_b16 a[138:139], v20 offset:33056
  ds_read_b64_tr_b16 a[140:141], v20 offset:34848
  ds_read_b64_tr_b16 a[142:143], v20 offset:35104
  s_add_u32 m0, s13, 5120
  s_add_u32 s14, s15, 0x80400
  buffer_load_dwordx4 v21, s[44:47], s14 offen lds
  s_add_u32 m0, s13, 6144
  s_add_u32 s14, s15, 0x87000
  buffer_load_dwordx4 v21, s[44:47], s14 offen lds
  s_add_u32 m0, s13, 7168
  s_add_u32 s14, s15, 0x89400
  buffer_load_dwordx4 v21, s[44:47], s14 offen lds
  s_waitcnt lgkmcnt(0)
  s_add_u32 m0, s13, 8192
  s_add_u32 s14, s15, 0x6c040
  buffer_load_dwordx4 v22, s[44:47], s14 offen lds
  s_waitcnt vmcnt(5)
  ds_read_b64_tr_b16 a[144:145], v20 offset:0
  ds_read_b64_tr_b16 a[146:147], v20 offset:256
  ds_read_b64_tr_b16 a[148:149], v20 offset:2048
  ds_read_b64_tr_b16 a[150:151], v20 offset:2304
  ds_read_b64_tr_b16 a[152:153], v20 offset:32
  ds_read_b64_tr_b16 a[154:155], v20 offset:288
  ds_read_b64_tr_b16 a[156:157], v20 offset:2080
  ds_read_b64_tr_b16 a[158:159], v20 offset:2336
  s_add_u32 m0, s13, 9216
  s_add_u32 s14, s15, 0x6e440
  buffer_load_dwordx4 v22, s[44:47], s14 offen lds
  s_add_u32 m0, s13, 10240
  s_add_u32 s14, s15, 0x75040
  buffer_load_dwordx4 v22, s[44:47], s14 offen lds
  s_add_u32 m0, s13, 11264
  s_add_u32 s14, s15, 0x77440
  buffer_load_dwordx4 v22, s[44:47], s14 offen lds
  s_waitcnt lgkmcnt(0)
  s_add_u32 m0, s13, 12288
  s_add_u32 s14, s15, 0x90000
  buffer_load_dwordx4 v21, s[44:47], s14 offen lds
  s_waitcnt vmcnt(5)
  ds_read_b64_tr_b16 a[160:161], v20 offset:4096
  ds_read_b64_tr_b16 a[162:163], v20 offset:4352
  ds_read_b64_tr_b16 a[164:165], v20 offset:6144
  ds_read_b64_tr_b16 a[166:167], v20 offset:6400
  ds_read_b64_tr_b16 a[168:169], v20 offset:4128
  ds_read_b64_tr_b16 a[170:171], v20 offset:4384
  ds_read_b64_tr_b16 a[172:173], v20 offset:6176
  ds_read_b64_tr_b16 a[174:175], v20 offset:6432
  s_add_u32 m0, s13, 13312
  s_add_u32 s14, s15, 0x92400
  buffer_load_dwordx4 v21, s[44:47], s14 offen lds
  s_add_u32 m0, s13, 14336
  s_add_u32 s14, s15, 0x99000
  buffer_load_dwordx4 v21, s[44:47], s14 offen lds
  s_add_u32 m0, s13, 15360
  s_add_u32 s14, s15, 0x9b400
  buffer_load_dwordx4 v21, s[44:47], s14 offen lds
  s_waitcnt lgkmcnt(0)
  s_add_u32 m0, s13, 16384
  s_add_u32 s14, s15, 0xa2000
  buffer_load_dwordx4 v21, s[44:47], s14 offen lds
  s_waitcnt vmcnt(5)
  ds_read_b64_tr_b16 a[176:177], v20 offset:8192
  ds_read_b64_tr_b16 a[178:179], v20 offset:8448
  ds_read_b64_tr_b16 a[180:181], v20 offset:10240
  ds_read_b64_tr_b16 a[182:183], v20 offset:10496
  ds_read_b64_tr_b16 a[184:185], v20 offset:8224
  ds_read_b64_tr_b16 a[186:187], v20 offset:8480
  ds_read_b64_tr_b16 a[188:189], v20 offset:10272
  ds_read_b64_tr_b16 a[190:191], v20 offset:10528
  s_add_u32 m0, s13, 17408
  s_add_u32 s14, s15, 0xa4400
  buffer_load_dwordx4 v21, s[44:47], s14 offen lds
  s_add_u32 m0, s13, 18432
  s_add_u32 s14, s15, 0xab000
  buffer_load_dwordx4 v21, s[44:47], s14 offen lds
  s_add_u32 m0, s13, 19456
  s_add_u32 s14, s15, 0xad400
  buffer_load_dwordx4 v21, s[44:47], s14 offen lds
  s_waitcnt lgkmcnt(0)
  s_add_u32 m0, s13, 20480
  s_add_u32 s14, s15, 0x90040
  buffer_load_dwordx4 v22, s[44:47], s14 offen lds
  s_waitcnt vmcnt(5)
  ds_read_b64_tr_b16 a[192:193], v20 offset:12288
  ds_read_b64_tr_b16 a[194:195], v20 offset:12544
  ds_read_b64_tr_b16 a[196:197], v20 offset:14336
  ds_read_b64_tr_b16 a[198:199], v20 offset:14592
  ds_read_b64_tr_b16 a[200:201], v20 offset:12320
  ds_read_b64_tr_b16 a[202:203], v20 offset:12576
  ds_read_b64_tr_b16 a[204:205], v20 offset:14368
  ds_read_b64_tr_b16 a[206:207], v20 offset:14624
  s_add_u32 m0, s13, 21504
  s_add_u32 s14, s15, 0x92440
  buffer_load_dwordx4 v22, s[44:47], s14 offen lds
  s_add_u32 m0, s13, 22528
  s_add_u32 s14, s15, 0x99040
  buffer_load_dwordx4 v22, s[44:47], s14 offen lds
  s_add_u32 m0, s13, 23552
  s_add_u32 s14, s15, 0x9b440
  buffer_load_dwordx4 v22, s[44:47], s14 offen lds
  s_waitcnt lgkmcnt(0)
  s_add_u32 m0, s13, 24576
  s_add_u32 s14, s15, 0xb4000
  buffer_load_dwordx4 v21, s[44:47], s14 offen lds
  s_waitcnt vmcnt(5)
  ds_read_b64_tr_b16 a[208:209], v20 offset:16384
  ds_read_b64_tr_b16 a[210:211], v20 offset:16640
  ds_read_b64_tr_b16 a[212:213], v20 offset:18432
  ds_read_b64_tr_b16 a[214:215], v20 offset:18688
  ds_read_b64_tr_b16 a[216:217], v20 offset:16416
  ds_read_b64_tr_b16 a[218:219], v20 offset:16672
  ds_read_b64_tr_b16 a[220:221], v20 offset:18464
  ds_read_b64_tr_b16 a[222:223], v20 offset:18720
  s_add_u32 m0, s13, 25600
  s_add_u32 s14, s15, 0xb6400
  buffer_load_dwordx4 v21, s[44:47], s14 offen lds
  s_add_u32 m0, s13, 26624
  s_add_u32 s14, s15, 0xbd000
  buffer_load_dwordx4 v21, s[44:47], s14 offen lds
  s_add_u32 m0, s13, 27648
  s_add_u32 s14, s15, 0xbf400
  buffer_load_dwordx4 v21, s[44:47], s14 offen lds
  s_waitcnt lgkmcnt(0)
  s_add_u32 m0, s13, 28672
  s_add_u32 s14, s15, 0xc6000
  buffer_load_dwordx4 v21, s[44:47], s14 offen lds
  s_waitcnt vmcnt(5)
  ds_read_b64_tr_b16 a[224:225], v20 offset:20480
  ds_read_b64_tr_b16 a[226:227], v20 offset:20736
  ds_read_b64_tr_b16 a[228:229], v20 offset:22528
  ds_read_b64_tr_b16 a[230:231], v20 offset:22784
  ds_read_b64_tr_b16 a[232:233], v20 offset:20512
  ds_read_b64_tr_b16 a[234:235], v20 offset:20768
  ds_read_b64_tr_b16 a[236:237], v20 offset:22560
  ds_read_b64_tr_b16 a[238:239], v20 offset:22816
  s_add_u32 m0, s13, 29696
  s_add_u32 s14, s15, 0xc8400
  buffer_load_dwordx4 v21, s[44:47], s14 offen lds
  s_add_u32 m0, s13, 30720
  s_add_u32 s14, s15, 0xcf000
  buffer_load_dwordx4 v21, s[44:47], s14 offen lds
  s_add_u32 m0, s13, 31744
  s_add_u32 s14, s15, 0xd1400
  buffer_load_dwordx4 v21, s[44:47], s14 offen lds
  s_waitcnt lgkmcnt(0)
  s_add_u32 m0, s13, 32768
  s_add_u32 s14, s15, 0xb4040
  buffer_load_dwordx4 v22, s[44:47], s14 offen lds
  s_waitcnt vmcnt(5)
  ds_read_b64_tr_b16 a[240:241], v20 offset:24576
  ds_read_b64_tr_b16 a[242:243], v20 offset:24832
  ds_read_b64_tr_b16 a[244:245], v20 offset:26624
  ds_read_b64_tr_b16 a[246:247], v20 offset:26880
  ds_read_b64_tr_b16 a[248:249], v20 offset:24608
  ds_read_b64_tr_b16 a[250:251], v20 offset:24864
  ds_read_b64_tr_b16 a[252:253], v20 offset:26656
  ds_read_b64_tr_b16 a[254:255], v20 offset:26912
  s_add_u32 m0, s13, 33792
  s_add_u32 s14, s15, 0xb6440
  buffer_load_dwordx4 v22, s[44:47], s14 offen lds
  s_add_u32 m0, s13, 34816
  s_add_u32 s14, s15, 0xbd040
  buffer_load_dwordx4 v22, s[44:47], s14 offen lds
  s_add_u32 m0, s13, 35840
  s_add_u32 s14, s15, 0xbf440
  buffer_load_dwordx4 v22, s[44:47], s14 offen lds
  s_waitcnt lgkmcnt(0)
  s_add_u32 m0, s13, 0
  s_add_u32 s14, s15, 0xd8000
  buffer_load_dwordx4 v21, s[44:47], s14 offen lds
  s_waitcnt vmcnt(5)
  ds_read_b64_tr_b16 v[128:129], v20 offset:28672
  ds_read_b64_tr_b16 v[130:131], v20 offset:28928
  ds_read_b64_tr_b16 v[132:133], v20 offset:30720
  ds_read_b64_tr_b16 v[134:135], v20 offset:30976
  ds_read_b64_tr_b16 v[136:137], v20 offset:28704
  ds_read_b64_tr_b16 v[138:139], v20 offset:28960
  ds_read_b64_tr_b16 v[140:141], v20 offset:30752
  ds_read_b64_tr_b16 v[142:143], v20 offset:31008
  s_add_u32 m0, s13, 1024
  s_add_u32 s14, s15, 0xda400
  buffer_load_dwordx4 v21, s[44:47], s14 offen lds
  s_add_u32 m0, s13, 2048
  s_add_u32 s14, s15, 0xe1000
  buffer_load_dwordx4 v21, s[44:47], s14 offen lds
  s_add_u32 m0, s13, 3072
  s_add_u32 s14, s15, 0xe3400
  buffer_load_dwordx4 v21, s[44:47], s14 offen lds
  s_waitcnt lgkmcnt(0)
  s_add_u32 m0, s13, 4096
  s_add_u32 s14, s15, 0xea000
  buffer_load_dwordx4 v21, s[44:47], s14 offen lds
  s_waitcnt vmcnt(5)
  ds_read_b64_tr_b16 v[144:145], v20 offset:32768
  ds_read_b64_tr_b16 v[146:147], v20 offset:33024
  ds_read_b64_tr_b16 v[148:149], v20 offset:34816
  ds_read_b64_tr_b16 v[150:151], v20 offset:35072
  ds_read_b64_tr_b16 v[152:153], v20 offset:32800
  ds_read_b64_tr_b16 v[154:155], v20 offset:33056
  ds_read_b64_tr_b16 v[156:157], v20 offset:34848
  ds_read_b64_tr_b16 v[158:159], v20 offset:35104
  s_add_u32 m0, s13, 5120
  s_add_u32 s14, s15, 0xec400
  buffer_load_dwordx4 v21, s[44:47], s14 offen lds
  s_add_u32 m0, s13, 6144
  s_add_u32 s14, s15, 0xf3000
  buffer_load_dwordx4 v21, s[44:47], s14 offen lds
  s_add_u32 m0, s13, 7168
  s_add_u32 s14, s15, 0xf5400
  buffer_load_dwordx4 v21, s[44:47], s14 offen lds
  s_waitcnt lgkmcnt(0)
  s_add_u32 m0, s13, 8192
  s_add_u32 s14, s15, 0xd8040
  buffer_load_dwordx4 v22, s[44:47], s14 offen lds
  s_waitcnt vmcnt(5)
  ds_read_b64_tr_b16 v[160:161], v20 offset:0
  ds_read_b64_tr_b16 v[162:163], v20 offset:256
  ds_read_b64_tr_b16 v[164:165], v20 offset:2048
  ds_read_b64_tr_b16 v[166:167], v20 offset:2304
  ds_read_b64_tr_b16 v[168:169], v20 offset:32
  ds_read_b64_tr_b16 v[170:171], v20 offset:288
  ds_read_b64_tr_b16 v[172:173], v20 offset:2080
  ds_read_b64_tr_b16 v[174:175], v20 offset:2336
  s_add_u32 m0, s13, 9216
  s_add_u32 s14, s15, 0xda440
  buffer_load_dwordx4 v22, s[44:47], s14 offen lds
  s_add_u32 m0, s13, 10240
  s_add_u32 s14, s15, 0xe1040
  buffer_load_dwordx4 v22, s[44:47], s14 offen lds
  s_add_u32 m0, s13, 11264
  s_add_u32 s14, s15, 0xe3440
  buffer_load_dwordx4 v22, s[44:47], s14 offen lds
  s_waitcnt lgkmcnt(0)
  s_add_u32 m0, s13, 12288
  s_add_u32 s14, s15, 0xfc000
  buffer_load_dwordx4 v21, s[44:47], s14 offen lds
  s_waitcnt vmcnt(5)
  ds_read_b64_tr_b16 v[176:177], v20 offset:4096
  ds_read_b64_tr_b16 v[178:179], v20 offset:4352
  ds_read_b64_tr_b16 v[180:181], v20 offset:6144
  ds_read_b64_tr_b16 v[182:183], v20 offset:6400
  ds_read_b64_tr_b16 v[184:185], v20 offset:4128
  ds_read_b64_tr_b16 v[186:187], v20 offset:4384
  ds_read_b64_tr_b16 v[188:189], v20 offset:6176
  ds_read_b64_tr_b16 v[190:191], v20 offset:6432
  s_add_u32 m0, s13, 13312
  s_add_u32 s14, s15, 0xfe400
  buffer_load_dwordx4 v21, s[44:47], s14 offen lds
  s_add_u32 m0, s13, 14336
  s_add_u32 s14, s15, 0x105000
  buffer_load_dwordx4 v21, s[44:47], s14 offen lds
  s_add_u32 m0, s13, 15360
  s_add_u32 s14, s15, 0x107400
  buffer_load_dwordx4 v21, s[44:47], s14 offen lds
  s_waitcnt lgkmcnt(0)
  s_add_u32 m0, s13, 16384
  s_add_u32 s14, s15, 0x10e000
  buffer_load_dwordx4 v21, s[44:47], s14 offen lds
  s_waitcnt vmcnt(5)
  ds_read_b64_tr_b16 v[192:193], v20 offset:8192
  ds_read_b64_tr_b16 v[194:195], v20 offset:8448
  ds_read_b64_tr_b16 v[196:197], v20 offset:10240
  ds_read_b64_tr_b16 v[198:199], v20 offset:10496
  ds_read_b64_tr_b16 v[200:201], v20 offset:8224
  ds_read_b64_tr_b16 v[202:203], v20 offset:8480
  ds_read_b64_tr_b16 v[204:205], v20 offset:10272
  ds_read_b64_tr_b16 v[206:207], v20 offset:10528
  s_add_u32 m0, s13, 17408
  s_add_u32 s14, s15, 0x110400
  buffer_load_dwordx4 v21, s[44:47], s14 offen lds
  s_add_u32 m0, s13, 18432
  s_add_u32 s14, s15, 0x117000
  buffer_load_dwordx4 v21, s[44:47], s14 offen lds
  s_add_u32 m0, s13, 19456
  s_add_u32 s14, s15, 0x119400
  buffer_load_dwordx4 v21, s[44:47], s14 offen lds
  s_waitcnt lgkmcnt(0)
  s_add_u32 m0, s13, 20480
  s_add_u32 s14, s15, 0xfc040
  buffer_load_dwordx4 v22, s[44:47], s14 offen lds
  s_waitcnt vmcnt(5)
  ds_read_b64_tr_b16 v[208:209], v20 offset:12288
  ds_read_b64_tr_b16 v[210:211], v20 offset:12544
  ds_read_b64_tr_b16 v[212:213], v20 offset:14336
  ds_read_b64_tr_b16 v[214:215], v20 offset:14592
  ds_read_b64_tr_b16 v[216:217], v20 offset:12320
  ds_read_b64_tr_b16 v[218:219], v20 offset:12576
  ds_read_b64_tr_b16 v[220:221], v20 offset:14368
  ds_read_b64_tr_b16 v[222:223], v20 offset:14624
  s_add_u32 m0, s13, 21504
  s_add_u32 s14, s15, 0xfe440
  buffer_load_dwordx4 v22, s[44:47], s14 offen lds
  s_add_u32 m0, s13, 22528
  s_add_u32 s14, s15, 0x105040
  buffer_load_dwordx4 v22, s[44:47], s14 offen lds
  s_add_u32 m0, s13, 23552
  s_add_u32 s14, s15, 0x107440
  buffer_load_dwordx4 v22, s[44:47], s14 offen lds
  s_waitcnt lgkmcnt(0)
  s_waitcnt vmcnt(4)
  ds_read_b64_tr_b16 v[224:225], v20 offset:16384
  ds_read_b64_tr_b16 v[226:227], v20 offset:16640
  ds_read_b64_tr_b16 v[228:229], v20 offset:18432
  ds_read_b64_tr_b16 v[230:231], v20 offset:18688
  ds_read_b64_tr_b16 v[232:233], v20 offset:16416
  ds_read_b64_tr_b16 v[234:235], v20 offset:16672
  ds_read_b64_tr_b16 v[236:237], v20 offset:18464
  ds_read_b64_tr_b16 v[238:239], v20 offset:18720
  s_waitcnt lgkmcnt(0)
  s_waitcnt vmcnt(0)
  ds_read_b64_tr_b16 v[240:241], v20 offset:20480
  ds_read_b64_tr_b16 v[242:243], v20 offset:20736
  ds_read_b64_tr_b16 v[244:245], v20 offset:22528
  ds_read_b64_tr_b16 v[246:247], v20 offset:22784
  ds_read_b64_tr_b16 v[248:249], v20 offset:20512
  ds_read_b64_tr_b16 v[250:251], v20 offset:20768
  ds_read_b64_tr_b16 v[252:253], v20 offset:22560
  ds_read_b64_tr_b16 v[254:255], v20 offset:22816
  s_waitcnt lgkmcnt(0)
  s_load_dwordx2 s[100:101], s[0:1], 112
  v_and_b32 v12, 7, v0
  v_lshlrev_b32 v12, 5, v12
  s_waitcnt lgkmcnt(0)
.cw_46:
  global_load_dword v13, v12, s[100:101] offset:4 sc1
  s_waitcnt vmcnt(0)
  v_cmp_gt_u32 vcc, 32, v13
  s_cbranch_vccz .cd_47
  s_sleep 2
  s_sub_u32 s10, s10, 1
  s_cbranch_scc0 .cw_46
  s_mov_b32 s10, 0
.cd_47:
  v_lshrrev_b32 v1, 4, v0
  v_mul_u32_u24 v1, 3072, v1
  v_and_b32 v24, 15, v0
  v_lshl_add_u32 v1, v24, 2, v1
  v_bfe_u32 v2, v0, 0, 2
  v_lshlrev_b32 v2, 7, v2
  v_bfe_u32 v24, v0, 2, 1
  v_lshl_add_u32 v2, v24, 11, v2
  v_lshlrev_b32 v0, 4, v0
  s_mov_b32 s52, 0
  s_lshl_b32 s57, s12, 3
  s_add_u32 s57, s57, s3
  s_lshl_b32 s14, s11, 5
  s_add_u32 s14, s14, s57
  s_lshl_b32 s14, s14, 6
  s_add_u32 s14, s14, s59
  s_lshl_b32 s53, s14, 13
  s_add_u32 s53, s53, 0x2000000
  s_lshl_b32 s14, s11, 1
  s_add_u32 s14, s14, s59
  s_lshl_b32 s14, s14, 5
  s_add_u32 s14, s14, s57
  s_lshl_b32 s54, s14, 9
  s_add_u32 s54, s54, 0x20000
  s_lshl_b32 s55, s9, 2
  s_add_u32 s55, s55, s3
  s_lshl_b32 s55, s55, 1
  s_lshl_b32 s14, s11, 5
  s_add_u32 s55, s55, s14
  s_lshl_b32 s14, s59, 8
  s_add_u32 s55, s55, s14
  s_add_u32 s55, s55, 0xa000
  s_lshl_b32 s56, s59, 1
  s_add_u32 s56, s56, s11
  s_lshl_b32 s62, s56, 7
  s_add_u32 s62, s62, 0xa200
  s_mul_i32 s56, s56, 24
  s_add_u32 s56, s56, s9
  s_mul_i32 s14, s11, 12
  s_sub_u32 s56, s56, s14
  s_mul_i32 s56, s56, 24576
  s_mul_i32 s14, s3, 192
  s_add_u32 s56, s56, s14
  s_add_u32 s56, s56, 0x8000000
  s_mov_b32 s58, 0
  s_add_u32 s63, s56, 294912
  s_xor_b32 s63, s63, s56
  s_barrier
  s_add_u32 s14, s56, 12288
  buffer_store_dword v0, v1, s[4:7], s56 offen offset:0
  buffer_store_dword v0, v1, s[4:7], s56 offen offset:768
  buffer_store_dword v0, v1, s[4:7], s56 offen offset:1536
  buffer_store_dword v0, v1, s[4:7], s56 offen offset:2304
  buffer_store_dword v0, v1, s[4:7], s56 offen offset:64
  buffer_store_dword v0, v1, s[4:7], s56 offen offset:832
  buffer_store_dword v0, v1, s[4:7], s56 offen offset:1600
  buffer_store_dword v0, v1, s[4:7], s56 offen offset:2368
  buffer_store_dword v0, v1, s[4:7], s56 offen offset:128
  buffer_store_dword v0, v1, s[4:7], s56 offen offset:896
  buffer_store_dword v0, v1, s[4:7], s56 offen offset:1664
  buffer_store_dword v0, v1, s[4:7], s56 offen offset:2432
  buffer_store_dword v0, v1, s[4:7], s14 offen offset:0
  buffer_store_dword v0, v1, s[4:7], s14 offen offset:768
  buffer_store_dword v0, v1, s[4:7], s14 offen offset:1536
  buffer_store_dword v0, v1, s[4:7], s14 offen offset:2304
  buffer_store_dword v0, v1, s[4:7], s14 offen offset:64
  buffer_store_dword v0, v1, s[4:7], s14 offen offset:832
  buffer_store_dword v0, v1, s[4:7], s14 offen offset:1600
  buffer_store_dword v0, v1, s[4:7], s14 offen offset:2368
  buffer_store_dword v0, v1, s[4:7], s14 offen offset:128
  buffer_store_dword v0, v1, s[4:7], s14 offen offset:896
  buffer_store_dword v0, v1, s[4:7], s14 offen offset:1664
  buffer_store_dword v0, v1, s[4:7], s14 offen offset:2432
  s_xor_b32 s56, s56, s63
  s_add_u32 s14, s56, 12288
  buffer_store_dword v0, v1, s[4:7], s56 offen offset:0
  buffer_store_dword v0, v1, s[4:7], s56 offen offset:768
  buffer_store_dword v0, v1, s[4:7], s56 offen offset:1536
  buffer_store_dword v0, v1, s[4:7], s56 offen offset:2304
  buffer_store_dword v0, v1, s[4:7], s56 offen offset:64
  buffer_store_dword v0, v1, s[4:7], s56 offen offset:832
  buffer_store_dword v0, v1, s[4:7], s56 offen offset:1600
  buffer_store_dword v0, v1, s[4:7], s56 offen offset:2368
  buffer_store_dword v0, v1, s[4:7], s56 offen offset:128
  buffer_store_dword v0, v1, s[4:7], s56 offen offset:896
  buffer_store_dword v0, v1, s[4:7], s56 offen offset:1664
  buffer_store_dword v0, v1, s[4:7], s56 offen offset:2432
  buffer_store_dword v0, v1, s[4:7], s14 offen offset:0
  buffer_store_dword v0, v1, s[4:7], s14 offen offset:768
  buffer_store_dword v0, v1, s[4:7], s14 offen offset:1536
  buffer_store_dword v0, v1, s[4:7], s14 offen offset:2304
  buffer_store_dword v0, v1, s[4:7], s14 offen offset:64
  buffer_store_dword v0, v1, s[4:7], s14 offen offset:832
  buffer_store_dword v0, v1, s[4:7], s14 offen offset:1600
  buffer_store_dword v0, v1, s[4:7], s14 offen offset:2368
  buffer_store_dword v0, v1, s[4:7], s14 offen offset:128
  buffer_store_dword v0, v1, s[4:7], s14 offen offset:896
  buffer_store_dword v0, v1, s[4:7], s14 offen offset:1664
  buffer_store_dword v0, v1, s[4:7], s14 offen offset:2432
  s_xor_b32 s56, s56, s63
  v_lshrrev_b32 v5, 3, v0
  v_and_b32 v5, 62, v5
  s_mov_b32 s64, 0
.ol_48:
  s_add_u32 s52, s52, 1
  s_lshl_b32 s57, s3, 13
  s_add_u32 s57, s57, s58
  v_add_u32 v3, s58, v0
  s_cmp_eq_u32 s64, 1
  s_cbranch_scc1 .os_49
.pl_50:
  buffer_load_dword v8, v2, s[4:7], s54 offen offset:0 sc1
  s_waitcnt vmcnt(0)
  v_cmp_gt_u32 vcc, s52, v8
  s_cbranch_vccz .pd_51
  s_sleep 1
  s_sub_u32 s10, s10, 1
  s_cbranch_scc0 .pl_50
  s_mov_b32 s10, 0
.pd_51:
  s_add_u32 m0, s57, 0
  s_add_u32 s61, s53, 0x0
  buffer_load_dwordx4 v0, s[4:7], s61 offen offset:0 sc1 lds
  buffer_load_dwordx4 v0, s[4:7], s61 offen offset:1024 sc1 lds
  buffer_load_dwordx4 v0, s[4:7], s61 offen offset:2048 sc1 lds
  buffer_load_dwordx4 v0, s[4:7], s61 offen offset:3072 sc1 lds
  s_add_u32 m0, s57, 4096
  s_add_u32 s61, s53, 0x1000
  buffer_load_dwordx4 v0, s[4:7], s61 offen offset:0 sc1 lds
  buffer_load_dwordx4 v0, s[4:7], s61 offen offset:1024 sc1 lds
  buffer_load_dwordx4 v0, s[4:7], s61 offen offset:2048 sc1 lds
  buffer_load_dwordx4 v0, s[4:7], s61 offen offset:3072 sc1 lds
  s_add_u32 m0, s57, 32768
  s_add_u32 s61, s53, 0x200000
  buffer_load_dwordx4 v0, s[4:7], s61 offen offset:0 sc1 lds
  buffer_load_dwordx4 v0, s[4:7], s61 offen offset:1024 sc1 lds
  buffer_load_dwordx4 v0, s[4:7], s61 offen offset:2048 sc1 lds
  buffer_load_dwordx4 v0, s[4:7], s61 offen offset:3072 sc1 lds
  s_add_u32 m0, s57, 36864
  s_add_u32 s61, s53, 0x201000
  buffer_load_dwordx4 v0, s[4:7], s61 offen offset:0 sc1 lds
  buffer_load_dwordx4 v0, s[4:7], s61 offen offset:1024 sc1 lds
  buffer_load_dwordx4 v0, s[4:7], s61 offen offset:2048 sc1 lds
  buffer_load_dwordx4 v0, s[4:7], s61 offen offset:3072 sc1 lds
  s_waitcnt vmcnt(8)
.os_49:
  s_xor_b32 s57, s57, 65536
  s_barrier
  ds_read_b128 v[32:35], v3 offset:0
  ds_read_b128 v[36:39], v3 offset:1024
  ds_read_b128 v[40:43], v3 offset:2048
  ds_read_b128 v[44:47], v3 offset:3072
  ds_read_b128 v[48:51], v3 offset:4096
  ds_read_b128 v[52:55], v3 offset:5120
  s_waitcnt lgkmcnt(5)
  v_mfma_f32_16x16x32_bf16 v[8:11], v[32:35], a[0:3], 0
  v_mfma_f32_16x16x32_bf16 v[12:15], v[32:35], a[8:11], 0
  v_mfma_f32_16x16x32_bf16 v[16:19], v[32:35], a[32:35], 0
  s_waitcnt lgkmcnt(4)
  ds_read_b128 v[32:35], v3 offset:6144
  v_mfma_f32_16x16x32_bf16 v[20:23], v[36:39], a[0:3], 0
  v_mfma_f32_16x16x32_bf16 v[24:27], v[36:39], a[8:11], 0
  v_mfma_f32_16x16x32_bf16 v[28:31], v[36:39], a[32:35], 0
  s_waitcnt lgkmcnt(4)
  ds_read_b128 v[36:39], v3 offset:7168
  v_mfma_f32_16x16x32_bf16 v[8:11], v[40:43], a[4:7], v[8:11]
  v_mfma_f32_16x16x32_bf16 v[12:15], v[40:43], a[12:15], v[12:15]
  v_mfma_f32_16x16x32_bf16 v[16:19], v[40:43], a[36:39], v[16:19]
  s_waitcnt lgkmcnt(4)
  ds_read_b128 v[40:43], v3 offset:8192
  v_mfma_f32_16x16x32_bf16 v[20:23], v[44:47], a[4:7], v[20:23]
  v_mfma_f32_16x16x32_bf16 v[24:27], v[44:47], a[12:15], v[24:27]
  v_mfma_f32_16x16x32_bf16 v[28:31], v[44:47], a[36:39], v[28:31]
  s_waitcnt lgkmcnt(4)
  ds_read_b128 v[44:47], v3 offset:9216
  v_mfma_f32_16x16x32_bf16 v[8:11], v[48:51], a[16:19], v[8:11]
  v_mfma_f32_16x16x32_bf16 v[12:15], v[48:51], a[24:27], v[12:15]
  v_mfma_f32_16x16x32_bf16 v[16:19], v[48:51], a[40:43], v[16:19]
  s_waitcnt lgkmcnt(4)
  ds_read_b128 v[48:51], v3 offset:10240
  v_mfma_f32_16x16x32_bf16 v[20:23], v[52:55], a[16:19], v[20:23]
  v_mfma_f32_16x16x32_bf16 v[24:27], v[52:55], a[24:27], v[24:27]
  v_mfma_f32_16x16x32_bf16 v[28:31], v[52:55], a[40:43], v[28:31]
  s_waitcnt lgkmcnt(4)
  ds_read_b128 v[52:55], v3 offset:11264
  v_mfma_f32_16x16x32_bf16 v[8:11], v[32:35], a[20:23], v[8:11]
  v_mfma_f32_16x16x32_bf16 v[12:15], v[32:35], a[28:31], v[12:15]
  v_mfma_f32_16x16x32_bf16 v[16:19], v[32:35], a[44:47], v[16:19]
  s_waitcnt lgkmcnt(4)
  ds_read_b128 v[32:35], v3 offset:12288
  v_mfma_f32_16x16x32_bf16 v[20:23], v[36:39], a[20:23], v[20:23]
  v_mfma_f32_16x16x32_bf16 v[24:27], v[36:39], a[28:31], v[24:27]
  v_mfma_f32_16x16x32_bf16 v[28:31], v[36:39], a[44:47], v[28:31]
  s_waitcnt lgkmcnt(4)
  ds_read_b128 v[36:39], v3 offset:13312
  v_mfma_f32_16x16x32_bf16 v[8:11], v[40:43], a[48:51], v[8:11]
  v_mfma_f32_16x16x32_bf16 v[12:15], v[40:43], a[56:59], v[12:15]
  v_mfma_f32_16x16x32_bf16 v[16:19], v[40:43], a[80:83], v[16:19]
  s_waitcnt lgkmcnt(4)
  ds_read_b128 v[40:43], v3 offset:14336
  v_mfma_f32_16x16x32_bf16 v[20:23], v[44:47], a[48:51], v[20:23]
  v_mfma_f32_16x16x32_bf16 v[24:27], v[44:47], a[56:59], v[24:27]
  v_mfma_f32_16x16x32_bf16 v[28:31], v[44:47], a[80:83], v[28:31]
  s_waitcnt lgkmcnt(4)
  ds_read_b128 v[44:47], v3 offset:15360
  v_mfma_f32_16x16x32_bf16 v[8:11], v[48:51], a[52:55], v[8:11]
  v_mfma_f32_16x16x32_bf16 v[12:15], v[48:51], a[60:63], v[12:15]
  v_mfma_f32_16x16x32_bf16 v[16:19], v[48:51], a[84:87], v[16:19]
  s_waitcnt lgkmcnt(4)
  ds_read_b128 v[48:51], v3 offset:16384
  v_mfma_f32_16x16x32_bf16 v[20:23], v[52:55], a[52:55], v[20:23]
  v_mfma_f32_16x16x32_bf16 v[24:27], v[52:55], a[60:63], v[24:27]
  v_mfma_f32_16x16x32_bf16 v[28:31], v[52:55], a[84:87], v[28:31]
  s_waitcnt lgkmcnt(4)
  ds_read_b128 v[52:55], v3 offset:17408
  v_mfma_f32_16x16x32_bf16 v[8:11], v[32:35], a[64:67], v[8:11]
  v_mfma_f32_16x16x32_bf16 v[12:15], v[32:35], a[72:75], v[12:15]
  v_mfma_f32_16x16x32_bf16 v[16:19], v[32:35], a[88:91], v[16:19]
  s_waitcnt lgkmcnt(4)
  ds_read_b128 v[32:35], v3 offset:18432
  v_mfma_f32_16x16x32_bf16 v[20:23], v[36:39], a[64:67], v[20:23]
  v_mfma_f32_16x16x32_bf16 v[24:27], v[36:39], a[72:75], v[24:27]
  v_mfma_f32_16x16x32_bf16 v[28:31], v[36:39], a[88:91], v[28:31]
  s_waitcnt lgkmcnt(4)
  ds_read_b128 v[36:39], v3 offset:19456
  v_mfma_f32_16x16x32_bf16 v[8:11], v[40:43], a[68:71], v[8:11]
  v_mfma_f32_16x16x32_bf16 v[12:15], v[40:43], a[76:79], v[12:15]
  v_mfma_f32_16x16x32_bf16 v[16:19], v[40:43], a[92:95], v[16:19]
  s_waitcnt lgkmcnt(4)
  ds_read_b128 v[40:43], v3 offset:20480
  v_mfma_f32_16x16x32_bf16 v[20:23], v[44:47], a[68:71], v[20:23]
  v_mfma_f32_16x16x32_bf16 v[24:27], v[44:47], a[76:79], v[24:27]
  v_mfma_f32_16x16x32_bf16 v[28:31], v[44:47], a[92:95], v[28:31]
  s_waitcnt lgkmcnt(4)
  ds_read_b128 v[44:47], v3 offset:21504
  v_mfma_f32_16x16x32_bf16 v[8:11], v[48:51], a[96:99], v[8:11]
  v_mfma_f32_16x16x32_bf16 v[12:15], v[48:51], a[104:107], v[12:15]
  v_mfma_f32_16x16x32_bf16 v[16:19], v[48:51], a[128:131], v[16:19]
  s_waitcnt lgkmcnt(4)
  ds_read_b128 v[48:51], v3 offset:22528
  v_mfma_f32_16x16x32_bf16 v[20:23], v[52:55], a[96:99], v[20:23]
  v_mfma_f32_16x16x32_bf16 v[24:27], v[52:55], a[104:107], v[24:27]
  v_mfma_f32_16x16x32_bf16 v[28:31], v[52:55], a[128:131], v[28:31]
  s_waitcnt lgkmcnt(4)
  ds_read_b128 v[52:55], v3 offset:23552
  v_mfma_f32_16x16x32_bf16 v[8:11], v[32:35], a[100:103], v[8:11]
  v_mfma_f32_16x16x32_bf16 v[12:15], v[32:35], a[108:111], v[12:15]
  v_mfma_f32_16x16x32_bf16 v[16:19], v[32:35], a[132:135], v[16:19]
  s_waitcnt lgkmcnt(4)
  ds_read_b128 v[32:35], v3 offset:24576
  v_mfma_f32_16x16x32_bf16 v[20:23], v[36:39], a[100:103], v[20:23]
  v_mfma_f32_16x16x32_bf16 v[24:27], v[36:39], a[108:111], v[24:27]
  v_mfma_f32_16x16x32_bf16 v[28:31], v[36:39], a[132:135], v[28:31]
  s_waitcnt lgkmcnt(4)
  ds_read_b128 v[36:39], v3 offset:25600
  v_mfma_f32_16x16x32_bf16 v[8:11], v[40:43], a[112:115], v[8:11]
  v_mfma_f32_16x16x32_bf16 v[12:15], v[40:43], a[120:123], v[12:15]
  v_mfma_f32_16x16x32_bf16 v[16:19], v[40:43], a[136:139], v[16:19]
  s_waitcnt lgkmcnt(4)
  ds_read_b128 v[40:43], v3 offset:26624
  v_mfma_f32_16x16x32_bf16 v[20:23], v[44:47], a[112:115], v[20:23]
  v_mfma_f32_16x16x32_bf16 v[24:27], v[44:47], a[120:123], v[24:27]
  v_mfma_f32_16x16x32_bf16 v[28:31], v[44:47], a[136:139], v[28:31]
  s_waitcnt lgkmcnt(4)
  ds_read_b128 v[44:47], v3 offset:27648
  v_mfma_f32_16x16x32_bf16 v[8:11], v[48:51], a[116:119], v[8:11]
  v_mfma_f32_16x16x32_bf16 v[12:15], v[48:51], a[124:127], v[12:15]
  v_mfma_f32_16x16x32_bf16 v[16:19], v[48:51], a[140:143], v[16:19]
  s_waitcnt lgkmcnt(4)
  ds_read_b128 v[48:51], v3 offset:28672
  v_mfma_f32_16x16x32_bf16 v[20:23], v[52:55], a[116:119], v[20:23]
  v_mfma_f32_16x16x32_bf16 v[24:27], v[52:55], a[124:127], v[24:27]
  v_mfma_f32_16x16x32_bf16 v[28:31], v[52:55], a[140:143], v[28:31]
  s_waitcnt lgkmcnt(4)
  ds_read_b128 v[52:55], v3 offset:29696
  v_mfma_f32_16x16x32_bf16 v[8:11], v[32:35], a[144:147], v[8:11]
  v_mfma_f32_16x16x32_bf16 v[12:15], v[32:35], a[152:155], v[12:15]
  v_mfma_f32_16x16x32_bf16 v[16:19], v[32:35], a[176:179], v[16:19]
  s_waitcnt lgkmcnt(4)
  ds_read_b128 v[32:35], v3 offset:30720
  v_mfma_f32_16x16x32_bf16 v[20:23], v[36:39], a[144:147], v[20:23]
  v_mfma_f32_16x16x32_bf16 v[24:27], v[36:39], a[152:155], v[24:27]
  v_mfma_f32_16x16x32_bf16 v[28:31], v[36:39], a[176:179], v[28:31]
  s_waitcnt lgkmcnt(4)
  ds_read_b128 v[36:39], v3 offset:31744
  v_mfma_f32_16x16x32_bf16 v[8:11], v[40:43], a[148:151], v[8:11]
  s_waitcnt vmcnt(0)
  s_barrier
  v_mfma_f32_16x16x32_bf16 v[12:15], v[40:43], a[156:159], v[12:15]
  buffer_load_dword v7, v2, s[4:7], s54 offen sc1
  v_mfma_f32_16x16x32_bf16 v[16:19], v[40:43], a[180:183], v[16:19]
  s_waitcnt lgkmcnt(4)
  ds_read_b128 v[40:43], v3 offset:32768
  v_mfma_f32_16x16x32_bf16 v[20:23], v[44:47], a[148:151], v[20:23]
  buffer_load_ushort v6, v5, s[4:7], s62 offen sc1
  v_mfma_f32_16x16x32_bf16 v[24:27], v[44:47], a[156:159], v[24:27]
  v_mfma_f32_16x16x32_bf16 v[28:31], v[44:47], a[180:183], v[28:31]
  s_waitcnt lgkmcnt(4)
  ds_read_b128 v[44:47], v3 offset:33792
  v_mfma_f32_16x16x32_bf16 v[8:11], v[48:51], a[160:163], v[8:11]
  v_mfma_f32_16x16x32_bf16 v[12:15], v[48:51], a[168:171], v[12:15]
  v_mfma_f32_16x16x32_bf16 v[16:19], v[48:51], a[184:187], v[16:19]
  s_waitcnt lgkmcnt(4)
  ds_read_b128 v[48:51], v3 offset:34816
  v_mfma_f32_16x16x32_bf16 v[20:23], v[52:55], a[160:163], v[20:23]
  v_mfma_f32_16x16x32_bf16 v[24:27], v[52:55], a[168:171], v[24:27]
  v_mfma_f32_16x16x32_bf16 v[28:31], v[52:55], a[184:187], v[28:31]
  s_waitcnt lgkmcnt(4)
  ds_read_b128 v[52:55], v3 offset:35840
  v_mfma_f32_16x16x32_bf16 v[8:11], v[32:35], a[164:167], v[8:11]
  v_mfma_f32_16x16x32_bf16 v[12:15], v[32:35], a[172:175], v[12:15]
  v_mfma_f32_16x16x32_bf16 v[16:19], v[32:35], a[188:191], v[16:19]
  s_waitcnt lgkmcnt(4)
  ds_read_b128 v[32:35], v3 offset:36864
  v_mfma_f32_16x16x32_bf16 v[20:23], v[36:39], a[164:167], v[20:23]
  v_mfma_f32_16x16x32_bf16 v[24:27], v[36:39], a[172:175], v[24:27]
  v_mfma_f32_16x16x32_bf16 v[28:31], v[36:39], a[188:191], v[28:31]
  s_waitcnt lgkmcnt(4)
  ds_read_b128 v[36:39], v3 offset:37888
  v_mfma_f32_16x16x32_bf16 v[8:11], v[40:43], a[192:195], v[8:11]
  v_mfma_f32_16x16x32_bf16 v[12:15], v[40:43], a[200:203], v[12:15]
  v_mfma_f32_16x16x32_bf16 v[16:19], v[40:43], a[224:227], v[16:19]
  s_waitcnt lgkmcnt(4)
  ds_read_b128 v[40:43], v3 offset:38912
  v_mfma_f32_16x16x32_bf16 v[20:23], v[44:47], a[192:195], v[20:23]
  v_mfma_f32_16x16x32_bf16 v[24:27], v[44:47], a[200:203], v[24:27]
  s_add_u32 s14, s56, 12288
  v_mfma_f32_16x16x32_bf16 v[28:31], v[44:47], a[224:227], v[28:31]
  s_waitcnt lgkmcnt(4)
  ds_read_b128 v[44:47], v3 offset:39936
  v_mfma_f32_16x16x32_bf16 v[8:11], v[48:51], a[196:199], v[8:11]
  s_sub_u32 s60, s52, 2
  v_mfma_f32_16x16x32_bf16 v[12:15], v[48:51], a[204:207], v[12:15]
  s_max_i32 s60, s60, 0
  v_mfma_f32_16x16x32_bf16 v[16:19], v[48:51], a[228:231], v[16:19]
  s_waitcnt lgkmcnt(4)
  ds_read_b128 v[48:51], v3 offset:40960
  v_mfma_f32_16x16x32_bf16 v[20:23], v[52:55], a[196:199], v[20:23]
  v_mfma_f32_16x16x32_bf16 v[24:27], v[52:55], a[204:207], v[24:27]
  v_mfma_f32_16x16x32_bf16 v[28:31], v[52:55], a[228:231], v[28:31]
  s_waitcnt lgkmcnt(4)
  ds_read_b128 v[52:55], v3 offset:41984
  v_mfma_f32_16x16x32_bf16 v[8:11], v[32:35], a[208:211], v[8:11]
  s_waitcnt vmcnt(1)
  v_cmp_ge_u32 vcc, s52, v7
  v_mfma_f32_16x16x32_bf16 v[12:15], v[32:35], a[216:219], v[12:15]
  s_add_u32 s65, s53, 16384
  v_mfma_f32_16x16x32_bf16 v[16:19], v[32:35], a[232:235], v[16:19]
  s_waitcnt lgkmcnt(4)
  ds_read_b128 v[32:35], v3 offset:43008
  v_mfma_f32_16x16x32_bf16 v[20:23], v[36:39], a[208:211], v[20:23]
  s_cmp_eq_u64 vcc, 0
  s_cselect_b32 s64, 1, 0
  v_mfma_f32_16x16x32_bf16 v[24:27], v[36:39], a[216:219], v[24:27]
  s_cselect_b32 s65, s65, s53
  v_mfma_f32_16x16x32_bf16 v[28:31], v[36:39], a[232:235], v[28:31]
  s_waitcnt lgkmcnt(4)
  ds_read_b128 v[36:39], v3 offset:44032
  v_mfma_f32_16x16x32_bf16 v[8:11], v[40:43], a[212:215], v[8:11]
  s_add_u32 m0, s57, 0
  s_add_u32 s61, s65, 0x0
  v_mfma_f32_16x16x32_bf16 v[12:15], v[40:43], a[220:223], v[12:15]
  buffer_load_dwordx4 v0, s[4:7], s61 offen offset:0 sc1 lds
  v_mfma_f32_16x16x32_bf16 v[16:19], v[40:43], a[236:239], v[16:19]
  s_waitcnt lgkmcnt(4)
  ds_read_b128 v[40:43], v3 offset:45056
  v_mfma_f32_16x16x32_bf16 v[20:23], v[44:47], a[212:215], v[20:23]
  v_mfma_f32_16x16x32_bf16 v[24:27], v[44:47], a[220:223], v[24:27]
  buffer_load_dwordx4 v0, s[4:7], s61 offen offset:1024 sc1 lds
  v_mfma_f32_16x16x32_bf16 v[28:31], v[44:47], a[236:239], v[28:31]
  s_waitcnt lgkmcnt(4)
  ds_read_b128 v[44:47], v3 offset:46080
  v_mfma_f32_16x16x32_bf16 v[8:11], v[48:51], a[240:243], v[8:11]
  v_mfma_f32_16x16x32_bf16 v[12:15], v[48:51], a[248:251], v[12:15]
  v_mfma_f32_16x16x32_bf16 v[16:19], v[48:51], v[144:147], v[16:19]
  s_waitcnt lgkmcnt(4)
  ds_read_b128 v[48:51], v3 offset:47104
  v_mfma_f32_16x16x32_bf16 v[20:23], v[52:55], a[240:243], v[20:23]
  v_mfma_f32_16x16x32_bf16 v[24:27], v[52:55], a[248:251], v[24:27]
  buffer_load_dwordx4 v0, s[4:7], s61 offen offset:2048 sc1 lds
  v_mfma_f32_16x16x32_bf16 v[28:31], v[52:55], v[144:147], v[28:31]
  s_waitcnt lgkmcnt(4)
  ds_read_b128 v[52:55], v3 offset:48128
  v_mfma_f32_16x16x32_bf16 v[8:11], v[32:35], a[244:247], v[8:11]
  v_mfma_f32_16x16x32_bf16 v[12:15], v[32:35], a[252:255], v[12:15]
  buffer_load_dwordx4 v0, s[4:7], s61 offen offset:3072 sc1 lds
  v_mfma_f32_16x16x32_bf16 v[16:19], v[32:35], v[148:151], v[16:19]
  s_waitcnt lgkmcnt(4)
  ds_read_b128 v[32:35], v3 offset:49152
  v_mfma_f32_16x16x32_bf16 v[20:23], v[36:39], a[244:247], v[20:23]
  v_mfma_f32_16x16x32_bf16 v[24:27], v[36:39], a[252:255], v[24:27]
  v_mfma_f32_16x16x32_bf16 v[28:31], v[36:39], v[148:151], v[28:31]
  s_waitcnt lgkmcnt(4)
  ds_read_b128 v[36:39], v3 offset:50176
  v_mfma_f32_16x16x32_bf16 v[8:11], v[40:43], v[128:131], v[8:11]
  s_add_u32 m0, s57, 4096
  s_add_u32 s61, s65, 0x1000
  v_mfma_f32_16x16x32_bf16 v[12:15], v[40:43], v[136:139], v[12:15]
  buffer_load_dwordx4 v0, s[4:7], s61 offen offset:0 sc1 lds
  v_mfma_f32_16x16x32_bf16 v[16:19], v[40:43], v[152:155], v[16:19]
  s_waitcnt lgkmcnt(4)
  ds_read_b128 v[40:43], v3 offset:51200
  v_mfma_f32_16x16x32_bf16 v[20:23], v[44:47], v[128:131], v[20:23]
  v_mfma_f32_16x16x32_bf16 v[24:27], v[44:47], v[136:139], v[24:27]
  buffer_load_dwordx4 v0, s[4:7], s61 offen offset:1024 sc1 lds
  v_mfma_f32_16x16x32_bf16 v[28:31], v[44:47], v[152:155], v[28:31]
  s_waitcnt lgkmcnt(4)
  ds_read_b128 v[44:47], v3 offset:52224
  v_mfma_f32_16x16x32_bf16 v[8:11], v[48:51], v[132:135], v[8:11]
  v_mfma_f32_16x16x32_bf16 v[12:15], v[48:51], v[140:143], v[12:15]
  v_mfma_f32_16x16x32_bf16 v[16:19], v[48:51], v[156:159], v[16:19]
  s_waitcnt lgkmcnt(4)
  ds_read_b128 v[48:51], v3 offset:53248
  v_mfma_f32_16x16x32_bf16 v[20:23], v[52:55], v[132:135], v[20:23]
  v_mfma_f32_16x16x32_bf16 v[24:27], v[52:55], v[140:143], v[24:27]
  buffer_load_dwordx4 v0, s[4:7], s61 offen offset:2048 sc1 lds
  v_mfma_f32_16x16x32_bf16 v[28:31], v[52:55], v[156:159], v[28:31]
  s_waitcnt lgkmcnt(4)
  ds_read_b128 v[52:55], v3 offset:54272
  v_mfma_f32_16x16x32_bf16 v[8:11], v[32:35], v[160:163], v[8:11]
  v_mfma_f32_16x16x32_bf16 v[12:15], v[32:35], v[168:171], v[12:15]
  buffer_load_dwordx4 v0, s[4:7], s61 offen offset:3072 sc1 lds
  v_mfma_f32_16x16x32_bf16 v[16:19], v[32:35], v[192:195], v[16:19]
  s_waitcnt lgkmcnt(4)
  ds_read_b128 v[32:35], v3 offset:55296
  v_mfma_f32_16x16x32_bf16 v[20:23], v[36:39], v[160:163], v[20:23]
  v_mfma_f32_16x16x32_bf16 v[24:27], v[36:39], v[168:171], v[24:27]
  v_mfma_f32_16x16x32_bf16 v[28:31], v[36:39], v[192:195], v[28:31]
  s_waitcnt lgkmcnt(4)
  ds_read_b128 v[36:39], v3 offset:56320
  v_mfma_f32_16x16x32_bf16 v[8:11], v[40:43], v[164:167], v[8:11]
  s_add_u32 m0, s57, 32768
  s_add_u32 s61, s65, 0x200000
  v_mfma_f32_16x16x32_bf16 v[12:15], v[40:43], v[172:175], v[12:15]
  buffer_load_dwordx4 v0, s[4:7], s61 offen offset:0 sc1 lds
  v_mfma_f32_16x16x32_bf16 v[16:19], v[40:43], v[196:199], v[16:19]
  s_waitcnt lgkmcnt(4)
  ds_read_b128 v[40:43], v3 offset:57344
  v_mfma_f32_16x16x32_bf16 v[20:23], v[44:47], v[164:167], v[20:23]
  v_mfma_f32_16x16x32_bf16 v[24:27], v[44:47], v[172:175], v[24:27]
  buffer_load_dwordx4 v0, s[4:7], s61 offen offset:1024 sc1 lds
  v_mfma_f32_16x16x32_bf16 v[28:31], v[44:47], v[196:199], v[28:31]
  s_waitcnt lgkmcnt(4)
  ds_read_b128 v[44:47], v3 offset:58368
  v_mfma_f32_16x16x32_bf16 v[8:11], v[48:51], v[176:179], v[8:11]
  v_mfma_f32_16x16x32_bf16 v[12:15], v[48:51], v[184:187], v[12:15]
  v_mfma_f32_16x16x32_bf16 v[16:19], v[48:51], v[200:203], v[16:19]
  s_waitcnt lgkmcnt(4)
  ds_read_b128 v[48:51], v3 offset:59392
  v_mfma_f32_16x16x32_bf16 v[20:23], v[52:55], v[176:179], v[20:23]
  v_mfma_f32_16x16x32_bf16 v[24:27], v[52:55], v[184:187], v[24:27]
  buffer_load_dwordx4 v0, s[4:7], s61 offen offset:2048 sc1 lds
  v_mfma_f32_16x16x32_bf16 v[28:31], v[52:55], v[200:203], v[28:31]
  s_waitcnt lgkmcnt(4)
  ds_read_b128 v[52:55], v3 offset:60416
  v_mfma_f32_16x16x32_bf16 v[8:11], v[32:35], v[180:183], v[8:11]
  v_mfma_f32_16x16x32_bf16 v[12:15], v[32:35], v[188:191], v[12:15]
  buffer_load_dwordx4 v0, s[4:7], s61 offen offset:3072 sc1 lds
  v_mfma_f32_16x16x32_bf16 v[16:19], v[32:35], v[204:207], v[16:19]
  s_waitcnt lgkmcnt(4)
  ds_read_b128 v[32:35], v3 offset:61440
  v_mfma_f32_16x16x32_bf16 v[20:23], v[36:39], v[180:183], v[20:23]
  v_mfma_f32_16x16x32_bf16 v[24:27], v[36:39], v[188:191], v[24:27]
  v_mfma_f32_16x16x32_bf16 v[28:31], v[36:39], v[204:207], v[28:31]
  s_waitcnt lgkmcnt(4)
  ds_read_b128 v[36:39], v3 offset:62464
  v_mfma_f32_16x16x32_bf16 v[8:11], v[40:43], v[208:211], v[8:11]
  s_add_u32 m0, s57, 36864
  s_add_u32 s61, s65, 0x201000
  v_mfma_f32_16x16x32_bf16 v[12:15], v[40:43], v[216:219], v[12:15]
  buffer_load_dwordx4 v0, s[4:7], s61 offen offset:0 sc1 lds
  v_mfma_f32_16x16x32_bf16 v[16:19], v[40:43], v[240:243], v[16:19]
  s_waitcnt lgkmcnt(4)
  ds_read_b128 v[40:43], v3 offset:63488
  v_mfma_f32_16x16x32_bf16 v[20:23], v[44:47], v[208:211], v[20:23]
  v_mfma_f32_16x16x32_bf16 v[24:27], v[44:47], v[216:219], v[24:27]
  buffer_load_dwordx4 v0, s[4:7], s61 offen offset:1024 sc1 lds
  v_mfma_f32_16x16x32_bf16 v[28:31], v[44:47], v[240:243], v[28:31]
  s_waitcnt lgkmcnt(4)
  ds_read_b128 v[44:47], v3 offset:64512
  v_mfma_f32_16x16x32_bf16 v[8:11], v[48:51], v[212:215], v[8:11]
  v_mfma_f32_16x16x32_bf16 v[12:15], v[48:51], v[220:223], v[12:15]
  v_mfma_f32_16x16x32_bf16 v[16:19], v[48:51], v[244:247], v[16:19]
  s_waitcnt lgkmcnt(4)
  v_mfma_f32_16x16x32_bf16 v[20:23], v[52:55], v[212:215], v[20:23]
  v_mfma_f32_16x16x32_bf16 v[24:27], v[52:55], v[220:223], v[24:27]
  buffer_load_dwordx4 v0, s[4:7], s61 offen offset:2048 sc1 lds
  v_mfma_f32_16x16x32_bf16 v[28:31], v[52:55], v[244:247], v[28:31]
  s_waitcnt lgkmcnt(3)
  v_mfma_f32_16x16x32_bf16 v[8:11], v[32:35], v[224:227], v[8:11]
  v_mfma_f32_16x16x32_bf16 v[12:15], v[32:35], v[232:235], v[12:15]
  buffer_load_dwordx4 v0, s[4:7], s61 offen offset:3072 sc1 lds
  v_mfma_f32_16x16x32_bf16 v[16:19], v[32:35], v[248:251], v[16:19]
  s_waitcnt lgkmcnt(2)
  v_mfma_f32_16x16x32_bf16 v[20:23], v[36:39], v[224:227], v[20:23]
  v_mfma_f32_16x16x32_bf16 v[24:27], v[36:39], v[232:235], v[24:27]
  v_mfma_f32_16x16x32_bf16 v[28:31], v[36:39], v[248:251], v[28:31]
  s_waitcnt lgkmcnt(1)
  v_mfma_f32_16x16x32_bf16 v[8:11], v[40:43], v[228:231], v[8:11]
  s_waitcnt vmcnt(16)
  v_cmp_gt_u32 vcc, s60, v6
  v_mfma_f32_16x16x32_bf16 v[12:15], v[40:43], v[236:239], v[12:15]
  v_mfma_f32_16x16x32_bf16 v[16:19], v[40:43], v[252:255], v[16:19]
  s_waitcnt lgkmcnt(0)
  v_mfma_f32_16x16x32_bf16 v[20:23], v[44:47], v[228:231], v[20:23]
  s_cbranch_vccnz .bp_52
.bp_52b:
  v_mfma_f32_16x16x32_bf16 v[24:27], v[44:47], v[236:239], v[24:27]
  v_mfma_f32_16x16x32_bf16 v[28:31], v[44:47], v[252:255], v[28:31]
  buffer_store_dword v8, v1, s[4:7], s56 offen offset:0
  buffer_store_dword v9, v1, s[4:7], s56 offen offset:768
  buffer_store_dword v10, v1, s[4:7], s56 offen offset:1536
  buffer_store_dword v11, v1, s[4:7], s56 offen offset:2304
  buffer_store_dword v12, v1, s[4:7], s56 offen offset:64
  buffer_store_dword v13, v1, s[4:7], s56 offen offset:832
  buffer_store_dword v14, v1, s[4:7], s56 offen offset:1600
  buffer_store_dword v15, v1, s[4:7], s56 offen offset:2368
  buffer_store_dword v16, v1, s[4:7], s56 offen offset:128
  buffer_store_dword v17, v1, s[4:7], s56 offen offset:896
  buffer_store_dword v18, v1, s[4:7], s56 offen offset:1664
  buffer_store_dword v19, v1, s[4:7], s56 offen offset:2432
  buffer_store_dword v20, v1, s[4:7], s14 offen offset:0
  buffer_store_dword v21, v1, s[4:7], s14 offen offset:768
  buffer_store_dword v22, v1, s[4:7], s14 offen offset:1536
  buffer_store_dword v23, v1, s[4:7], s14 offen offset:2304
  buffer_store_dword v24, v1, s[4:7], s14 offen offset:64
  buffer_store_dword v25, v1, s[4:7], s14 offen offset:832
  buffer_store_dword v26, v1, s[4:7], s14 offen offset:1600
  buffer_store_dword v27, v1, s[4:7], s14 offen offset:2368
  buffer_store_dword v28, v1, s[4:7], s14 offen offset:128
  buffer_store_dword v29, v1, s[4:7], s14 offen offset:896
  buffer_store_dword v30, v1, s[4:7], s14 offen offset:1664
  buffer_store_dword v31, v1, s[4:7], s14 offen offset:2432
  v_mov_b32 v4, s52
  s_add_u32 s53, s53, 16384
  s_xor_b32 s56, s56, s63
  s_xor_b32 s58, s58, 65536
  s_waitcnt vmcnt(0)
  s_mov_b64 exec, 1
  buffer_store_short v4, v0, s[4:7], s55 offen
  s_mov_b64 exec, -1
  s_cmp_lt_u32 s52, 32
  s_cbranch_scc1 .ol_48
  s_endpgm
.bp_52:
  buffer_load_ushort v6, v5, s[4:7], s62 offen sc1
  s_waitcnt vmcnt(0)
  v_cmp_gt_u32 vcc, s60, v6
  s_cbranch_vccz .bp_52b
  s_sub_u32 s10, s10, 1
  s_cbranch_scc0 .bp_52
  s_mov_b32 s10, 0
  s_branch .bp_52b
red:
  s_sub_u32 s11, s8, 6
  s_sub_u32 s12, s9, 24
  s_lshl_b32 s12, s12, 2
  s_add_u32 s12, s12, s3
  s_mov_b32 s52, 0
  s_mov_b32 s53, 0
  s_mul_i32 s54, s11, 0x120000
  s_mul_i32 s14, s12, 768
  s_add_u32 s54, s54, s14
  s_add_u32 s54, s54, 0x8000000
  s_lshl_b32 s55, s11, 8
  s_add_u32 s55, s55, 0xa000
  s_lshl_b32 s61, s12, 1
  s_add_u32 s61, s61, s55
  s_lshl_b32 s14, s11, 5
  s_add_u32 s14, s14, s12
  s_mul_i32 s56, s14, 1152
  s_lshl_b32 s58, s14, 7
  s_add_u32 s58, s58, 0x14000
  s_load_dwordx2 s[100:101], s[0:1], 112
  v_and_b32 v12, 7, v0
  v_lshlrev_b32 v12, 5, v12
  s_waitcnt lgkmcnt(0)
.cw_53:
  global_load_dword v13, v12, s[100:101] offset:4 sc1
  s_waitcnt vmcnt(0)
  v_cmp_gt_u32 vcc, 32, v13
  s_cbranch_vccz .cd_54
  s_sleep 2
  s_sub_u32 s10, s10, 1
  s_cbranch_scc0 .cw_53
  s_mov_b32 s10, 0
.cd_54:
  s_mov_b32 s24, -1
  s_mov_b32 s25, 0xffff
  v_lshlrev_b32 v1, 4, v0
  v_lshlrev_b32 v2, 3, v0
  v_mov_b32 v4, 0x80000000
  v_cndmask_b32 v1, v4, v1, s[24:25]
  v_cndmask_b32 v2, v4, v2, s[24:25]
  v_lshlrev_b32 v3, 1, v0
  v_min_u32 v16, 47, v0
  v_lshlrev_b32 v16, 3, v16
  s_mul_i32 s14, s3, 36864
  v_add_u32 v16, s14, v16
  s_lshl_b32 s14, s11, 3
  s_add_u32 s14, s14, s9
  s_sub_u32 s14, s14, 24
  s_lshl_b32 s14, s14, 7
  s_add_u32 s59, s14, 0x10000
  v_mov_b32 v5, 0
  s_mov_b32 s60, s56
.pl_55:
  buffer_load_dword v4, v5, s[4:7], s59 offen offset:0 sc1
  s_waitcnt vmcnt(0)
  v_cmp_gt_u32 vcc, 1, v4
  s_cbranch_vccz .pd_56
  s_sleep 3
  s_sub_u32 s10, s10, 1
  s_cbranch_scc0 .pl_55
  s_mov_b32 s10, 0
.pd_56:
  s_add_u32 s14, s60, 0x480000
  s_add_u32 s57, s60, 0x200000
  buffer_load_dwordx2 v[80:81], v2, s[4:7], s14 offen offset:0 sc1
  buffer_load_dwordx2 v[82:83], v2, s[4:7], s14 offen offset:384 sc1
  buffer_load_dwordx2 v[84:85], v2, s[4:7], s14 offen offset:768 sc1
  buffer_load_dwordx2 v[86:87], v2, s[4:7], s57 offen offset:0 sc1
  buffer_load_dwordx2 v[88:89], v2, s[4:7], s57 offen offset:384 sc1
  buffer_load_dwordx2 v[90:91], v2, s[4:7], s57 offen offset:768 sc1
.rl_57:
  s_add_u32 s14, s52, s53
  s_cmp_ge_u32 s14, 64
  s_cbranch_scc1 .re_60
  buffer_load_ushort v4, v3, s[4:7], s55 offen sc1
  buffer_load_ushort v5, v3, s[4:7], s55 offen offset:128 sc1
  s_waitcnt vmcnt(1)
  v_cmp_ge_u32 vcc, s52, v4
  s_and_b64 vcc, vcc, s[24:25]
  s_cbranch_vccz .r0_58
  s_waitcnt vmcnt(0)
  v_cmp_ge_u32 vcc, s53, v5
  s_and_b64 vcc, vcc, s[24:25]
  s_cbranch_vccz .r1_59
  s_sub_u32 s10, s10, 1
  s_cbranch_scc0 .rl_57
.re_60:
  s_endpgm
.r0_58:
  s_and_b32 s59, s52, 1
  s_mul_i32 s59, s59, 294912
  s_add_u32 s59, s59, s54
  s_mul_i32 s60, s52, 73728
  s_add_u32 s60, s60, s56
  s_add_u32 s14, s59, 0x0
  buffer_load_dwordx4 v[100:103], v1, s[4:7], s14 offen sc1
  s_add_u32 s14, s59, 0x6000
  buffer_load_dwordx4 v[104:107], v1, s[4:7], s14 offen sc1
  s_add_u32 s14, s59, 0xc000
  buffer_load_dwordx4 v[108:111], v1, s[4:7], s14 offen sc1
  s_add_u32 s14, s59, 0x12000
  buffer_load_dwordx4 v[112:115], v1, s[4:7], s14 offen sc1
  s_add_u32 s14, s59, 0x18000
  buffer_load_dwordx4 v[116:119], v1, s[4:7], s14 offen sc1
  s_add_u32 s14, s59, 0x1e000
  buffer_load_dwordx4 v[120:123], v1, s[4:7], s14 offen sc1
  s_add_u32 s14, s59, 0x24000
  buffer_load_dwordx4 v[124:127], v1, s[4:7], s14 offen sc1
  s_add_u32 s14, s59, 0x2a000
  buffer_load_dwordx4 v[128:131], v1, s[4:7], s14 offen sc1
  s_add_u32 s14, s59, 0x30000
  buffer_load_dwordx4 v[132:135], v1, s[4:7], s14 offen sc1
  s_add_u32 s14, s59, 0x36000
  buffer_load_dwordx4 v[136:139], v1, s[4:7], s14 offen sc1
  s_add_u32 s14, s59, 0x3c000
  buffer_load_dwordx4 v[140:143], v1, s[4:7], s14 offen sc1
  s_add_u32 s14, s59, 0x42000
  buffer_load_dwordx4 v[144:147], v1, s[4:7], s14 offen sc1
  s_mul_i32 s14, s52, 1152
  v_add_u32 v17, s14, v16
  v_lshlrev_b32 v20, 16, v80
  v_and_b32 v21, 0xffff0000, v80
  v_lshlrev_b32 v22, 16, v81
  v_and_b32 v23, 0xffff0000, v81
  v_lshlrev_b32 v24, 16, v82
  v_and_b32 v25, 0xffff0000, v82
  v_lshlrev_b32 v26, 16, v83
  v_and_b32 v27, 0xffff0000, v83
  v_lshlrev_b32 v28, 16, v84
  v_and_b32 v29, 0xffff0000, v84
  v_lshlrev_b32 v30, 16, v85
  v_and_b32 v31, 0xffff0000, v85
  v_mov_b64 v[10:11], v[86:87]
  v_mov_b64 v[12:13], v[88:89]
  v_mov_b64 v[14:15], v[90:91]
  s_add_u32 s52, s52, 1
  v_mov_b32 v18, s52
  s_waitcnt vmcnt(8)
  v_pk_add_f32 v[100:101], v[100:101], v[112:113]
  v_pk_add_f32 v[102:103], v[102:103], v[114:115]
  s_waitcnt vmcnt(7)
  v_pk_add_f32 v[104:105], v[104:105], v[116:117]
  v_pk_add_f32 v[106:107], v[106:107], v[118:119]
  s_waitcnt vmcnt(6)
  v_pk_add_f32 v[108:109], v[108:109], v[120:121]
  v_pk_add_f32 v[110:111], v[110:111], v[122:123]
  s_waitcnt vmcnt(2)
  v_pk_add_f32 v[124:125], v[124:125], v[136:137]
  v_pk_add_f32 v[126:127], v[126:127], v[138:139]
  s_waitcnt vmcnt(1)
  v_pk_add_f32 v[128:129], v[128:129], v[140:141]
  v_pk_add_f32 v[130:131], v[130:131], v[142:143]
  s_waitcnt vmcnt(0)
  v_pk_add_f32 v[132:133], v[132:133], v[144:145]
  v_pk_add_f32 v[134:135], v[134:135], v[146:147]
  s_mov_b64 exec, 1
  buffer_store_short v18, v3, s[4:7], s61 offen offset:512
  s_mov_b64 exec, -1
  s_add_u32 s14, s60, 0x492000
  s_add_u32 s57, s60, 0x212000
  buffer_load_dwordx2 v[80:81], v2, s[4:7], s14 offen offset:0 sc1
  buffer_load_dwordx2 v[82:83], v2, s[4:7], s14 offen offset:384 sc1
  buffer_load_dwordx2 v[84:85], v2, s[4:7], s14 offen offset:768 sc1
  buffer_load_dwordx2 v[86:87], v2, s[4:7], s57 offen offset:0 sc1
  buffer_load_dwordx2 v[88:89], v2, s[4:7], s57 offen offset:384 sc1
  buffer_load_dwordx2 v[90:91], v2, s[4:7], s57 offen offset:768 sc1
  v_pk_add_f32 v[100:101], v[100:101], v[124:125]
  v_pk_add_f32 v[102:103], v[102:103], v[126:127]
  v_pk_add_f32 v[104:105], v[104:105], v[128:129]
  v_pk_add_f32 v[106:107], v[106:107], v[130:131]
  v_pk_add_f32 v[108:109], v[108:109], v[132:133]
  v_pk_add_f32 v[110:111], v[110:111], v[134:135]
  v_cvt_pk_bf16_f32 v112, v100, v101
  v_cvt_pk_bf16_f32 v113, v102, v103
  v_cvt_pk_bf16_f32 v114, v104, v105
  v_cvt_pk_bf16_f32 v115, v106, v107
  v_cvt_pk_bf16_f32 v116, v108, v109
  v_cvt_pk_bf16_f32 v117, v110, v111
  v_lshlrev_b32 v100, 16, v112
  v_and_b32 v101, 0xffff0000, v112
  v_lshlrev_b32 v102, 16, v113
  v_and_b32 v103, 0xffff0000, v113
  v_lshlrev_b32 v104, 16, v114
  v_and_b32 v105, 0xffff0000, v114
  v_lshlrev_b32 v106, 16, v115
  v_and_b32 v107, 0xffff0000, v115
  v_lshlrev_b32 v108, 16, v116
  v_and_b32 v109, 0xffff0000, v116
  v_lshlrev_b32 v110, 16, v117
  v_and_b32 v111, 0xffff0000, v117
  v_pk_add_f32 v[20:21], v[20:21], v[100:101]
  v_pk_add_f32 v[22:23], v[22:23], v[102:103]
  v_pk_add_f32 v[24:25], v[24:25], v[104:105]
  v_pk_add_f32 v[26:27], v[26:27], v[106:107]
  v_pk_add_f32 v[28:29], v[28:29], v[108:109]
  v_pk_add_f32 v[30:31], v[30:31], v[110:111]
  v_cvt_pk_bf16_f32 v4, v20, v21
  v_cvt_pk_bf16_f32 v5, v22, v23
  v_cvt_pk_bf16_f32 v6, v24, v25
  v_cvt_pk_bf16_f32 v7, v26, v27
  v_cvt_pk_bf16_f32 v8, v28, v29
  v_cvt_pk_bf16_f32 v9, v30, v31
  v_lshlrev_b32 v20, 16, v4
  v_and_b32 v21, 0xffff0000, v4
  v_lshlrev_b32 v22, 16, v5
  v_and_b32 v23, 0xffff0000, v5
  v_lshlrev_b32 v24, 16, v6
  v_and_b32 v25, 0xffff0000, v6
  v_lshlrev_b32 v26, 16, v7
  v_and_b32 v27, 0xffff0000, v7
  v_lshlrev_b32 v28, 16, v8
  v_and_b32 v29, 0xffff0000, v8
  v_lshlrev_b32 v30, 16, v9
  v_and_b32 v31, 0xffff0000, v9
  v_lshlrev_b32 v56, 16, v10
  v_and_b32 v57, 0xffff0000, v10
  v_lshlrev_b32 v58, 16, v11
  v_and_b32 v59, 0xffff0000, v11
  v_lshlrev_b32 v60, 16, v12
  v_and_b32 v61, 0xffff0000, v12
  v_lshlrev_b32 v62, 16, v13
  v_and_b32 v63, 0xffff0000, v13
  v_lshlrev_b32 v64, 16, v14
  v_and_b32 v65, 0xffff0000, v14
  v_lshlrev_b32 v66, 16, v15
  v_and_b32 v67, 0xffff0000, v15
  v_readfirstlane_b32 s57, v20
  s_xor_b32 s57, s57, 0x80000000
  s_nop 0
  v_mov_b32 v50, s57
  v_pk_add_f32 v[32:33], v[20:21], v[50:51] op_sel_hi:[1,0]
  v_pk_add_f32 v[34:35], v[22:23], v[50:51] op_sel_hi:[1,0]
  v_pk_add_f32 v[36:37], v[24:25], v[50:51] op_sel_hi:[1,0]
  v_pk_add_f32 v[38:39], v[26:27], v[50:51] op_sel_hi:[1,0]
  v_pk_add_f32 v[40:41], v[28:29], v[50:51] op_sel_hi:[1,0]
  v_pk_add_f32 v[42:43], v[30:31], v[50:51] op_sel_hi:[1,0]
  v_pk_mul_f32 v[52:53], v[32:33], v[32:33]
  v_pk_add_f32 v[50:51], v[32:33], v[34:35]
  v_pk_fma_f32 v[52:53], v[34:35], v[34:35], v[52:53]
  v_pk_fma_f32 v[52:53], v[36:37], v[36:37], v[52:53]
  v_pk_add_f32 v[50:51], v[50:51], v[36:37]
  v_pk_fma_f32 v[52:53], v[38:39], v[38:39], v[52:53]
  v_pk_add_f32 v[50:51], v[50:51], v[38:39]
  v_pk_fma_f32 v[52:53], v[40:41], v[40:41], v[52:53]
  v_pk_add_f32 v[50:51], v[50:51], v[40:41]
  v_pk_fma_f32 v[52:53], v[42:43], v[42:43], v[52:53]
  v_pk_add_f32 v[50:51], v[50:51], v[42:43]
  v_add_f32 v50, v50, v51
  v_add_f32 v52, v52, v53
  v_cndmask_b32 v50, 0, v50, s[24:25]
  v_cndmask_b32 v52, 0, v52, s[24:25]
  s_nop 0
  v_add_f32_dpp v50, v50, v50 row_ror:8 row_mask:0xf bank_mask:0xf
  v_add_f32_dpp v52, v52, v52 row_ror:8 row_mask:0xf bank_mask:0xf
  s_nop 0
  v_add_f32_dpp v50, v50, v50 row_ror:4 row_mask:0xf bank_mask:0xf
  v_add_f32_dpp v52, v52, v52 row_ror:4 row_mask:0xf bank_mask:0xf
  s_nop 0
  v_add_f32_dpp v50, v50, v50 row_ror:2 row_mask:0xf bank_mask:0xf
  v_add_f32_dpp v52, v52, v52 row_ror:2 row_mask:0xf bank_mask:0xf
  s_nop 0
  v_add_f32_dpp v50, v50, v50 row_ror:1 row_mask:0xf bank_mask:0xf
  v_add_f32_dpp v52, v52, v52 row_ror:1 row_mask:0xf bank_mask:0xf
  v_mov_b32 v54, v50
  v_mov_b32 v55, v52
  s_nop 0
  v_permlane16_swap_b32 v54, v50
  v_permlane16_swap_b32 v55, v52
  v_add_f32 v50, v50, v54
  v_add_f32 v52, v52, v55
  v_mov_b32 v54, v50
  v_mov_b32 v55, v52
  s_nop 0
  v_permlane32_swap_b32 v54, v50
  v_permlane32_swap_b32 v55, v52
  v_add_f32 v50, v50, v54
  v_add_f32 v52, v52, v55
  v_mul_f32 v50, 0x3ae38e39, v50
  v_mul_f32 v52, 0x3ae38e39, v52
  v_fma_f32 v52, -v50, v50, v52
  v_max_f32 v52, 0, v52
  v_sub_f32 v50, s57, v50
  v_cvt_pk_bf16_f32 v52, v52, v52
  v_and_b32 v52, 0xffff0000, v52
  v_cvt_pk_bf16_f32 v50, v50, v50
  v_and_b32 v50, 0xffff0000, v50
  v_add_f32 v52, 0x3727c5ac, v52
  v_cvt_pk_bf16_f32 v52, v52, v52
  v_and_b32 v52, 0xffff0000, v52
  v_sqrt_f32 v52, v52
  s_nop 0
  v_cvt_pk_bf16_f32 v52, v52, v52
  v_and_b32 v52, 0xffff0000, v52
  v_rcp_f32 v52, v52
  v_pk_add_f32 v[32:33], v[20:21], v[50:51] op_sel_hi:[1,0]
  v_pk_add_f32 v[34:35], v[22:23], v[50:51] op_sel_hi:[1,0]
  v_pk_add_f32 v[36:37], v[24:25], v[50:51] op_sel_hi:[1,0]
  v_pk_add_f32 v[38:39], v[26:27], v[50:51] op_sel_hi:[1,0]
  v_pk_add_f32 v[40:41], v[28:29], v[50:51] op_sel_hi:[1,0]
  v_pk_add_f32 v[42:43], v[30:31], v[50:51] op_sel_hi:[1,0]
  v_pk_mul_f32 v[56:57], v[56:57], v[52:53] op_sel_hi:[1,0]
  v_pk_mul_f32 v[58:59], v[58:59], v[52:53] op_sel_hi:[1,0]
  v_pk_mul_f32 v[60:61], v[60:61], v[52:53] op_sel_hi:[1,0]
  v_pk_mul_f32 v[62:63], v[62:63], v[52:53] op_sel_hi:[1,0]
  v_pk_mul_f32 v[64:65], v[64:65], v[52:53] op_sel_hi:[1,0]
  v_pk_mul_f32 v[66:67], v[66:67], v[52:53] op_sel_hi:[1,0]
  v_pk_fma_f32 v[20:21], v[32:33], v[56:57], v[20:21]
  v_pk_fma_f32 v[22:23], v[34:35], v[58:59], v[22:23]
  v_pk_fma_f32 v[24:25], v[36:37], v[60:61], v[24:25]
  v_pk_fma_f32 v[26:27], v[38:39], v[62:63], v[26:27]
  v_pk_fma_f32 v[28:29], v[40:41], v[64:65], v[28:29]
  v_pk_fma_f32 v[30:31], v[42:43], v[66:67], v[30:31]
  v_cvt_pk_bf16_f32 v56, v20, v21
  v_cvt_pk_bf16_f32 v57, v22, v23
  v_cvt_pk_bf16_f32 v58, v24, v25
  v_cvt_pk_bf16_f32 v59, v26, v27
  v_cvt_pk_bf16_f32 v60, v28, v29
  v_cvt_pk_bf16_f32 v61, v30, v31
  v_lshlrev_b32 v20, 16, v56
  v_and_b32 v21, 0xffff0000, v56
  v_lshlrev_b32 v22, 16, v57
  v_and_b32 v23, 0xffff0000, v57
  v_lshlrev_b32 v24, 16, v58
  v_and_b32 v25, 0xffff0000, v58
  v_lshlrev_b32 v26, 16, v59
  v_and_b32 v27, 0xffff0000, v59
  v_lshlrev_b32 v28, 16, v60
  v_and_b32 v29, 0xffff0000, v60
  v_lshlrev_b32 v30, 16, v61
  v_and_b32 v31, 0xffff0000, v61
  s_mov_b64 exec, s[24:25]
  ds_write_b64 v17, v[56:57] offset:0
  ds_write_b64 v17, v[58:59] offset:384
  ds_write_b64 v17, v[60:61] offset:768
  s_mov_b64 exec, -1
  v_readfirstlane_b32 s57, v20
  s_xor_b32 s57, s57, 0x80000000
  s_nop 0
  v_mov_b32 v50, s57
  v_pk_add_f32 v[32:33], v[20:21], v[50:51] op_sel_hi:[1,0]
  v_pk_add_f32 v[34:35], v[22:23], v[50:51] op_sel_hi:[1,0]
  v_pk_add_f32 v[36:37], v[24:25], v[50:51] op_sel_hi:[1,0]
  v_pk_add_f32 v[38:39], v[26:27], v[50:51] op_sel_hi:[1,0]
  v_pk_add_f32 v[40:41], v[28:29], v[50:51] op_sel_hi:[1,0]
  v_pk_add_f32 v[42:43], v[30:31], v[50:51] op_sel_hi:[1,0]
  v_pk_mul_f32 v[52:53], v[32:33], v[32:33]
  v_pk_add_f32 v[50:51], v[32:33], v[34:35]
  v_pk_fma_f32 v[52:53], v[34:35], v[34:35], v[52:53]
  v_pk_fma_f32 v[52:53], v[36:37], v[36:37], v[52:53]
  v_pk_add_f32 v[50:51], v[50:51], v[36:37]
  v_pk_fma_f32 v[52:53], v[38:39], v[38:39], v[52:53]
  v_pk_add_f32 v[50:51], v[50:51], v[38:39]
  v_pk_fma_f32 v[52:53], v[40:41], v[40:41], v[52:53]
  v_pk_add_f32 v[50:51], v[50:51], v[40:41]
  v_pk_fma_f32 v[52:53], v[42:43], v[42:43], v[52:53]
  v_pk_add_f32 v[50:51], v[50:51], v[42:43]
  v_add_f32 v50, v50, v51
  v_add_f32 v52, v52, v53
  v_cndmask_b32 v50, 0, v50, s[24:25]
  v_cndmask_b32 v52, 0, v52, s[24:25]
  s_nop 0
  v_add_f32_dpp v50, v50, v50 row_ror:8 row_mask:0xf bank_mask:0xf
  v_add_f32_dpp v52, v52, v52 row_ror:8 row_mask:0xf bank_mask:0xf
  s_nop 0
  v_add_f32_dpp v50, v50, v50 row_ror:4 row_mask:0xf bank_mask:0xf
  v_add_f32_dpp v52, v52, v52 row_ror:4 row_mask:0xf bank_mask:0xf
  s_nop 0
  v_add_f32_dpp v50, v50, v50 row_ror:2 row_mask:0xf bank_mask:0xf
  v_add_f32_dpp v52, v52, v52 row_ror:2 row_mask:0xf bank_mask:0xf
  s_nop 0
  v_add_f32_dpp v50, v50, v50 row_ror:1 row_mask:0xf bank_mask:0xf
  v_add_f32_dpp v52, v52, v52 row_ror:1 row_mask:0xf bank_mask:0xf
  v_mov_b32 v54, v50
  v_mov_b32 v55, v52
  s_nop 0
  v_permlane16_swap_b32 v54, v50
  v_permlane16_swap_b32 v55, v52
  v_add_f32 v50, v50, v54
  v_add_f32 v52, v52, v55
  v_mov_b32 v54, v50
  v_mov_b32 v55, v52
  s_nop 0
  v_permlane32_swap_b32 v54, v50
  v_permlane32_swap_b32 v55, v52
  v_add_f32 v50, v50, v54
  v_add_f32 v52, v52, v55
  v_mul_f32 v50, 0x3ae38e39, v50
  v_mul_f32 v52, 0x3ae38e39, v52
  v_fma_f32 v52, -v50, v50, v52
  v_max_f32 v52, 0, v52
  v_sub_f32 v50, s57, v50
  v_cvt_pk_bf16_f32 v52, v52, v52
  v_and_b32 v52, 0xffff0000, v52
  v_cvt_pk_bf16_f32 v50, v50, v50
  v_and_b32 v50, 0xffff0000, v50
  v_add_f32 v52, 0x3727c5ac, v52
  v_cvt_pk_bf16_f32 v52, v52, v52
  v_and_b32 v52, 0xffff0000, v52
  v_sqrt_f32 v52, v52
  s_nop 0
  v_cvt_pk_bf16_f32 v52, v52, v52
  v_and_b32 v52, 0xffff0000, v52
  v_rcp_f32 v52, v52
  v_pk_add_f32 v[32:33], v[20:21], v[50:51] op_sel_hi:[1,0]
  v_pk_add_f32 v[34:35], v[22:23], v[50:51] op_sel_hi:[1,0]
  v_pk_add_f32 v[36:37], v[24:25], v[50:51] op_sel_hi:[1,0]
  v_pk_add_f32 v[38:39], v[26:27], v[50:51] op_sel_hi:[1,0]
  v_pk_add_f32 v[40:41], v[28:29], v[50:51] op_sel_hi:[1,0]
  v_pk_add_f32 v[42:43], v[30:31], v[50:51] op_sel_hi:[1,0]
  v_cvt_pk_bf16_f32 v44, v32, v33
  v_cvt_pk_bf16_f32 v45, v34, v35
  v_cvt_pk_bf16_f32 v46, v36, v37
  v_cvt_pk_bf16_f32 v47, v38, v39
  v_cvt_pk_bf16_f32 v48, v40, v41
  v_cvt_pk_bf16_f32 v49, v42, v43
  v_lshlrev_b32 v32, 16, v44
  v_and_b32 v33, 0xffff0000, v44
  v_lshlrev_b32 v34, 16, v45
  v_and_b32 v35, 0xffff0000, v45
  v_lshlrev_b32 v36, 16, v46
  v_and_b32 v37, 0xffff0000, v46
  v_lshlrev_b32 v38, 16, v47
  v_and_b32 v39, 0xffff0000, v47
  v_lshlrev_b32 v40, 16, v48
  v_and_b32 v41, 0xffff0000, v48
  v_lshlrev_b32 v42, 16, v49
  v_and_b32 v43, 0xffff0000, v49
  v_pk_mul_f32 v[32:33], v[32:33], v[52:53] op_sel_hi:[1,0]
  v_pk_mul_f32 v[34:35], v[34:35], v[52:53] op_sel_hi:[1,0]
  v_pk_mul_f32 v[36:37], v[36:37], v[52:53] op_sel_hi:[1,0]
  v_pk_mul_f32 v[38:39], v[38:39], v[52:53] op_sel_hi:[1,0]
  v_pk_mul_f32 v[40:41], v[40:41], v[52:53] op_sel_hi:[1,0]
  v_pk_mul_f32 v[42:43], v[42:43], v[52:53] op_sel_hi:[1,0]
  v_cvt_pk_bf16_f32 v44, v32, v33
  v_cvt_pk_bf16_f32 v45, v34, v35
  v_cvt_pk_bf16_f32 v46, v36, v37
  v_cvt_pk_bf16_f32 v47, v38, v39
  v_cvt_pk_bf16_f32 v48, v40, v41
  v_cvt_pk_bf16_f32 v49, v42, v43
  s_add_u32 s14, s60, 0xc00000
  buffer_store_dwordx2 v[44:45], v2, s[4:7], s14 offen offset:0 sc1
  buffer_store_dwordx2 v[46:47], v2, s[4:7], s14 offen offset:384 sc1
  buffer_store_dwordx2 v[48:49], v2, s[4:7], s14 offen offset:768 sc1
  s_waitcnt vmcnt(0)
  s_mov_b64 exec, 1
  buffer_store_dword v18, v3, s[4:7], s58 offen sc1
  s_mov_b64 exec, -1
  s_branch .rl_57
.r1_59:
  s_and_b32 s59, s53, 1
  s_mul_i32 s59, s59, 294912
  s_add_u32 s59, s59, s54
  s_mul_i32 s60, s53, 73728
  s_add_u32 s60, s60, s56
  s_add_u32 s14, s59, 0x90000
  buffer_load_dwordx4 v[100:103], v1, s[4:7], s14 offen sc1
  s_add_u32 s14, s59, 0x96000
  buffer_load_dwordx4 v[104:107], v1, s[4:7], s14 offen sc1
  s_add_u32 s14, s59, 0x9c000
  buffer_load_dwordx4 v[108:111], v1, s[4:7], s14 offen sc1
  s_add_u32 s14, s59, 0xa2000
  buffer_load_dwordx4 v[112:115], v1, s[4:7], s14 offen sc1
  s_add_u32 s14, s59, 0xa8000
  buffer_load_dwordx4 v[116:119], v1, s[4:7], s14 offen sc1
  s_add_u32 s14, s59, 0xae000
  buffer_load_dwordx4 v[120:123], v1, s[4:7], s14 offen sc1
  s_add_u32 s14, s59, 0xb4000
  buffer_load_dwordx4 v[124:127], v1, s[4:7], s14 offen sc1
  s_add_u32 s14, s59, 0xba000
  buffer_load_dwordx4 v[128:131], v1, s[4:7], s14 offen sc1
  s_add_u32 s14, s59, 0xc0000
  buffer_load_dwordx4 v[132:135], v1, s[4:7], s14 offen sc1
  s_add_u32 s14, s59, 0xc6000
  buffer_load_dwordx4 v[136:139], v1, s[4:7], s14 offen sc1
  s_add_u32 s14, s59, 0xcc000
  buffer_load_dwordx4 v[140:143], v1, s[4:7], s14 offen sc1
  s_add_u32 s14, s59, 0xd2000
  buffer_load_dwordx4 v[144:147], v1, s[4:7], s14 offen sc1
  s_mul_i32 s14, s53, 1152
  v_add_u32 v17, s14, v16
  ds_read_b64 v[4:5], v17 offset:0
  ds_read_b64 v[6:7], v17 offset:384
  ds_read_b64 v[8:9], v17 offset:768
  s_waitcnt lgkmcnt(2)
  v_lshlrev_b32 v20, 16, v4
  v_and_b32 v21, 0xffff0000, v4
  v_lshlrev_b32 v22, 16, v5
  v_and_b32 v23, 0xffff0000, v5
  s_waitcnt lgkmcnt(1)
  v_lshlrev_b32 v24, 16, v6
  v_and_b32 v25, 0xffff0000, v6
  v_lshlrev_b32 v26, 16, v7
  v_and_b32 v27, 0xffff0000, v7
  s_waitcnt lgkmcnt(0)
  v_lshlrev_b32 v28, 16, v8
  v_and_b32 v29, 0xffff0000, v8
  v_lshlrev_b32 v30, 16, v9
  v_and_b32 v31, 0xffff0000, v9
  s_add_u32 s53, s53, 1
  v_mov_b32 v18, s53
  s_waitcnt vmcnt(8)
  v_pk_add_f32 v[100:101], v[100:101], v[112:113]
  v_pk_add_f32 v[102:103], v[102:103], v[114:115]
  s_waitcnt vmcnt(7)
  v_pk_add_f32 v[104:105], v[104:105], v[116:117]
  v_pk_add_f32 v[106:107], v[106:107], v[118:119]
  s_waitcnt vmcnt(6)
  v_pk_add_f32 v[108:109], v[108:109], v[120:121]
  v_pk_add_f32 v[110:111], v[110:111], v[122:123]
  s_waitcnt vmcnt(2)
  v_pk_add_f32 v[124:125], v[124:125], v[136:137]
  v_pk_add_f32 v[126:127], v[126:127], v[138:139]
  s_waitcnt vmcnt(1)
  v_pk_add_f32 v[128:129], v[128:129], v[140:141]
  v_pk_add_f32 v[130:131], v[130:131], v[142:143]
  s_waitcnt vmcnt(0)
  v_pk_add_f32 v[132:133], v[132:133], v[144:145]
  v_pk_add_f32 v[134:135], v[134:135], v[146:147]
  s_mov_b64 exec, 1
  buffer_store_short v18, v3, s[4:7], s61 offen offset:640
  s_mov_b64 exec, -1
  v_pk_add_f32 v[100:101], v[100:101], v[124:125]
  v_pk_add_f32 v[102:103], v[102:103], v[126:127]
  v_pk_add_f32 v[104:105], v[104:105], v[128:129]
  v_pk_add_f32 v[106:107], v[106:107], v[130:131]
  v_pk_add_f32 v[108:109], v[108:109], v[132:133]
  v_pk_add_f32 v[110:111], v[110:111], v[134:135]
  v_cvt_pk_bf16_f32 v112, v100, v101
  v_cvt_pk_bf16_f32 v113, v102, v103
  v_cvt_pk_bf16_f32 v114, v104, v105
  v_cvt_pk_bf16_f32 v115, v106, v107
  v_cvt_pk_bf16_f32 v116, v108, v109
  v_cvt_pk_bf16_f32 v117, v110, v111
  v_lshlrev_b32 v100, 16, v112
  v_and_b32 v101, 0xffff0000, v112
  v_lshlrev_b32 v102, 16, v113
  v_and_b32 v103, 0xffff0000, v113
  v_lshlrev_b32 v104, 16, v114
  v_and_b32 v105, 0xffff0000, v114
  v_lshlrev_b32 v106, 16, v115
  v_and_b32 v107, 0xffff0000, v115
  v_lshlrev_b32 v108, 16, v116
  v_and_b32 v109, 0xffff0000, v116
  v_lshlrev_b32 v110, 16, v117
  v_and_b32 v111, 0xffff0000, v117
  v_pk_add_f32 v[20:21], v[20:21], v[100:101]
  v_pk_add_f32 v[22:23], v[22:23], v[102:103]
  v_pk_add_f32 v[24:25], v[24:25], v[104:105]
  v_pk_add_f32 v[26:27], v[26:27], v[106:107]
  v_pk_add_f32 v[28:29], v[28:29], v[108:109]
  v_pk_add_f32 v[30:31], v[30:31], v[110:111]
  v_cvt_pk_bf16_f32 v4, v20, v21
  v_cvt_pk_bf16_f32 v5, v22, v23
  v_cvt_pk_bf16_f32 v6, v24, v25
  v_cvt_pk_bf16_f32 v7, v26, v27
  v_cvt_pk_bf16_f32 v8, v28, v29
  v_cvt_pk_bf16_f32 v9, v30, v31
  buffer_store_dwordx2 v[4:5], v2, s[48:51], s60 offen offset:0
  buffer_store_dwordx2 v[6:7], v2, s[48:51], s60 offen offset:384
  buffer_store_dwordx2 v[8:9], v2, s[48:51], s60 offen offset:768
  s_branch .rl_57
.code_end:
.section .rodata,"a"
.p2align 6
.amdhsa_kernel interleave_layers__ssm_conv_h3__memory_aug_recurrent_mem_tr__prompt_kernel
  .amdhsa_next_free_vgpr 512
  .amdhsa_next_free_sgpr 102
  .amdhsa_accum_offset 256
  .amdhsa_group_segment_fixed_size 0
  .amdhsa_kernarg_size 128
  .amdhsa_user_sgpr_count 2
  .amdhsa_user_sgpr_kernarg_segment_ptr 1
  .amdhsa_system_sgpr_workgroup_id_x 1
  .amdhsa_float_denorm_mode_32 3
.end_amdhsa_kernel
```
